```python
import torch

def _softmax(x, axis=-1):
    return torch.softmax(x, dim=axis)
def _gelu(x):
    return torch.nn.functional.gelu(x, approximate="tanh")
def _silu(x):
    return torch.nn.functional.silu(x)
def _sigmoid(x):
    return torch.sigmoid(x)
def _layernorm(x, axis=-1, eps=1e-5):
    m = x.mean(dim=axis, keepdim=True)
    v = x.var(dim=axis, keepdim=True, unbiased=False)
    return (x - m) / torch.sqrt(v + eps)
def _scatter_add(tgt, idx, src, axis=0):
    return tgt.clone().index_add_(axis, idx, src)
def _segment_sum(src, seg, n):
    out = torch.zeros((n,) + src.shape[1:], dtype=src.dtype)
    return out.index_add_(0, seg, src)
def _pad(x, pw):
    flat = tuple(v for pair in reversed(pw) for v in pair)
    return torch.nn.functional.pad(x, flat)

kernel_name = 'interleave_layers__linear_attn_block__glu_gated_swiglu__prompt'

def setup_inputs():

    _w = (lambda a: (lambda t: t.to(torch.bfloat16) if t.is_floating_point() else t)(torch.as_tensor(a)))
    def _A_setup():
        B, S, D = 1, 2048, 640
        return {
            "x": _w((lambda *s: torch.randn(*s, dtype=torch.bfloat16) * 0.05)(B, S, D)),
            "wqkv": _w((lambda *s: torch.randn(*s, dtype=torch.bfloat16) * 0.05)(D, 3 * D)),
            "wo": _w((lambda *s: torch.randn(*s, dtype=torch.bfloat16) * 0.05)(D, D)),
        }
    _A_in = _A_setup()

    def _B_setup():
        B, S, D, F = 1, 2048, 640, 1536
        return {
            "x": _w((lambda *s: torch.randn(*s, dtype=torch.bfloat16) * 0.05)(B, S, D)),
            "w1": _w((lambda *s: torch.randn(*s, dtype=torch.bfloat16) * 0.4)(D, F) * (2.0 / D) ** 0.5),
            "w3": _w((lambda *s: torch.randn(*s, dtype=torch.bfloat16) * 0.4)(D, F) * (2.0 / D) ** 0.5),
            "w2": _w((lambda *s: torch.randn(*s, dtype=torch.bfloat16) * 0.4)(F, D) * (2.0 / F) ** 0.5),
        }
    _B_in = _B_setup()

    return {
        "A_x": _A_in["x"],
        "A_wqkv": _A_in["wqkv"],
        "A_wo": _A_in["wo"],
        "B_x": _B_in["x"],
        "B_w1": _B_in["w1"],
        "B_w3": _B_in["w3"],
        "B_w2": _B_in["w2"],
    }

def reference(A_x, A_wqkv, A_wo, B_x, B_w1, B_w3, B_w2):
    def _A_ref(x, wqkv, wo):
        B, S, D = x.shape
        H = 32; Dh = D // H
        qkv = (lambda x, *d: x.permute(*d))((x @ wqkv).reshape(B, S, 3, H, Dh), 2, 0, 3, 1, 4)
        q, k, v = qkv[0], qkv[1], qkv[2]
        phi = lambda t: torch.where(t > 0, t + 1, torch.exp(t)) + 1e-6
        pq, pk = phi(q), phi(k)
        kv = torch.einsum("bhsd,bhse->bhde", pk, v)
        z = torch.einsum("bhsd->bhd", pk)
        num = torch.einsum("bhqd,bhde->bhqe", pq, kv)
        den = torch.einsum("bhqd,bhd->bhq", pq, z)[..., None] + 1e-6
        o = num / den
        return (lambda x, *d: x.permute(*d))(o, 0, 2, 1, 3).reshape(B, S, D) @ wo

    def _B_ref(x, w1, w3, w2):
        gate = torch.einsum("bsd,df->bsf", x, w1)
        up = torch.einsum("bsd,df->bsf", x, w3)
        h = _silu(gate) * up
        out = torch.einsum("bsf,fd->bsd", h, w2)
        return out

    x = A_x
    x = x + _A_ref(_layernorm(x, axis=-1), A_wqkv, A_wo)
    x = x + _B_ref(_layernorm(x, axis=-1), B_w1, B_w3, B_w2)
    x = x + _A_ref(_layernorm(x, axis=-1), A_wqkv, A_wo)
    x = x + _B_ref(_layernorm(x, axis=-1), B_w1, B_w3, B_w2)
    return x
```

```asm
; @launch kernel=main_kernel grid=(256,1,1) block=(512,1,1) lds=163840
.amdgcn_target "amdgcn-amd-amdhsa--gfx950"
.text
.globl main_kernel
.p2align 8
.type main_kernel,@function
main_kernel:
    s_cmp_ge_u32 s2, 256
    s_cbranch_scc1 main_kernel_end
    s_getpc_b64 s[86:87]
    s_bfe_u32 s3, s2, 0x30003
    s_lshl_b32 s3, s3, 10
    v_lshl_add_u32 v2, v0, 1, s3
    v_and_b32 v2, 0xff80, v2
    global_load_dword v255, v2, s[86:87]
    s_load_dwordx2 s[4:5], s[0:1], 72
    s_load_dwordx2 s[6:7], s[0:1], 56
    s_load_dwordx8 s[76:83], s[0:1], 0
    s_load_dwordx2 s[84:85], s[0:1], 64
    v_lshrrev_b32 v1, 6, v0
    s_nop 0
    v_readfirstlane_b32 s16, v1
    v_and_b32 v1, 63, v0
    v_lshlrev_b32 v1, 4, v1
    s_and_b32 s20, s2, 7
    s_lshr_b32 s21, s2, 3
    s_mov_b32 s19, 0
    s_and_b32 s22, s20, 3
    s_lshl_b32 s22, s22, 2
    s_and_b32 s23, s21, 3
    s_add_u32 s17, s22, s23
    s_lshr_b32 s22, s20, 2
    s_lshl_b32 s22, s22, 3
    s_lshr_b32 s23, s21, 2
    s_add_u32 s18, s22, s23
    s_mov_b32 s10, 268435456
    s_mov_b32 s11, 0x20000
    s_mov_b32 s14, 2621440
    s_mov_b32 s15, 0x20000
    s_waitcnt lgkmcnt(0)
    s_mov_b32 s8, s4
    s_and_b32 s9, s5, 0xffff
    s_mov_b32 s12, s6
    s_and_b32 s13, s7, 0xffff
    s_mov_b32 s88, s76
    s_and_b32 s89, s77, 0xffff
    s_mov_b32 s90, 2621440
    s_mov_b32 s91, 0x20000
    s_cmp_lt_u32 s16, 4
    s_cbranch_scc1 main_kernel_comp
    s_setprio 3
    v_lshrrev_b32 v16, 7, v1
    v_and_b32 v17, 0x70, v1
    v_mov_b32 v28, 0
    s_sub_u32 s21, s16, 4
    v_bfe_u32 v6, v1, 8, 2
    s_lshl_b32 s22, s2, 1
    s_add_u32 s22, s22, s21
    s_mov_b32 s23, 0
    s_mov_b32 s95, 0x20000
    s_cmp_ge_u32 s21, 2
    s_cbranch_scc1 p0_st
    s_cmp_ge_u32 s22, 480
    s_cbranch_scc1 p0_ib
    s_mov_b32 s23, 1
    s_mul_i32 s24, s22, 2731
    s_lshr_b32 s24, s24, 16
    s_mul_i32 s25, s24, 24
    s_sub_u32 s25, s22, s25
    s_mul_i32 s26, s25, 160
    s_mul_i32 s27, s24, 122880
    v_mul_u32_u24 v20, 3840, v16
    v_add_u32 v20, v20, v17
    v_add_u32 v21, 30720, v20
    v_add_u32 v22, 61440, v20
    v_add_u32 v23, 92160, v20
    s_mov_b32 s92, s78
    s_and_b32 s93, s79, 0xffff
    s_mov_b32 s94, 2457600
    s_and_b32 s28, s26, 0xffffff80
    s_add_u32 s27, s27, s28
    s_and_b32 s26, s26, 127
    s_lshl_b32 s28, s21, 13
    s_add_u32 s28, s28, 65536
    s_add_u32 m0, s28, 0
    s_nop 0
    buffer_load_dwordx4 v20, s[92:95], s27 offen offset:0 nt lds
    s_add_u32 m0, s28, 896
    s_nop 0
    buffer_load_dwordx4 v20, s[92:95], s27 offen offset:128 nt lds
    s_add_u32 m0, s28, 2048
    s_nop 0
    buffer_load_dwordx4 v21, s[92:95], s27 offen offset:0 nt lds
    s_add_u32 m0, s28, 2944
    s_nop 0
    buffer_load_dwordx4 v21, s[92:95], s27 offen offset:128 nt lds
    s_add_u32 m0, s28, 4096
    s_nop 0
    buffer_load_dwordx4 v22, s[92:95], s27 offen offset:0 nt lds
    s_add_u32 m0, s28, 4992
    s_nop 0
    buffer_load_dwordx4 v22, s[92:95], s27 offen offset:128 nt lds
    s_add_u32 m0, s28, 6144
    s_nop 0
    buffer_load_dwordx4 v23, s[92:95], s27 offen offset:0 nt lds
    s_add_u32 m0, s28, 7040
    s_nop 0
    buffer_load_dwordx4 v23, s[92:95], s27 offen offset:128 nt lds
    s_barrier
    v_bfe_u32 v24, v1, 6, 2
    v_lshlrev_b32 v24, 7, v24
    v_lshl_add_u32 v24, v6, 11, v24
    v_add_u32 v24, s28, v24
    v_bfe_u32 v25, v1, 4, 2
    v_lshl_add_u32 v26, v25, 3, s26
    v_and_b32 v27, 1, v25
    v_mul_u32_u24 v27, 40, v27
    v_add_u32 v27, s26, v27
    v_add_u32 v29, 0, v26
    v_lshrrev_b32 v30, 7, v29
    v_mul_u32_u24 v30, 896, v30
    v_add3_u32 v30, v30, v29, v24
    v_add_u32 v29, 40, v26
    v_lshrrev_b32 v31, 7, v29
    v_mul_u32_u24 v31, 896, v31
    v_add3_u32 v31, v31, v29, v24
    v_add_u32 v29, 32, v27
    v_lshrrev_b32 v32, 7, v29
    v_mul_u32_u24 v32, 896, v32
    v_add3_u32 v32, v32, v29, v24
    v_add_u32 v29, 80, v26
    v_lshrrev_b32 v33, 7, v29
    v_mul_u32_u24 v33, 896, v33
    v_add3_u32 v33, v33, v29, v24
    v_add_u32 v29, 120, v26
    v_lshrrev_b32 v34, 7, v29
    v_mul_u32_u24 v34, 896, v34
    v_add3_u32 v34, v34, v29, v24
    v_add_u32 v29, 112, v27
    v_lshrrev_b32 v35, 7, v29
    v_mul_u32_u24 v35, 896, v35
    v_add3_u32 v35, v35, v29, v24
    s_lshr_b32 s29, s25, 3
    s_and_b32 s30, s25, 7
    s_lshl_b32 s30, s30, 1
    s_mul_i32 s31, s30, 163840
    s_add_u32 s31, s31, 30146560
    s_mul_i32 s32, s24, 3072
    s_add_u32 s32, s32, 102400
    s_mul_i32 s33, s24, 5120
    s_cmp_eq_u32 s29, 0
    s_cselect_b32 s32, s32, s33
    s_cselect_b32 s34, 2, 4
    s_lshl_b32 s34, s34, 10
    s_add_u32 s31, s31, s32
    s_add_u32 s34, s34, s31
    s_cmp_eq_u32 s29, 2
    s_cselect_b32 s32, 2, 0
    s_lshl_b32 s32, s32, 10
    s_add_u32 s31, s31, s32
    s_lshl_b32 s35, s22, 9
    s_add_u32 s35, s35, 39518208
    s_mov_b32 s38, 0x00ff00ff
    s_cmp_eq_u32 s29, 2
    s_cselect_b32 s38, 0xff00ff00, s38
    s_mov_b32 s39, s38
    s_cmp_eq_u32 s29, 0
    s_cselect_b64 s[42:43], -1, s[38:39]
    s_lshl_b32 s44, s25, 8
    s_add_u32 s44, s44, 98304
    v_lshlrev_b32 v28, 4, v6
    v_bfe_u32 v40, v1, 4, 4
    v_lshl_add_u32 v28, v40, 6, v28
    s_branch p0_i
p0_st:
    s_cmp_eq_u32 s21, 3
    s_cbranch_scc0 p0_ib
    s_cselect_b32 s23, 3, 0
    s_cselect_b32 s25, 0, 8
    s_lshl_b32 s24, s17, 4
    s_add_u32 s24, s24, s18
    s_xor_b32 s24, s24, s25
    s_mul_i32 s27, s24, 10240
    v_mul_u32_u24 v20, 1280, v16
    v_add_u32 v20, v20, v17
    s_barrier
    buffer_load_dwordx4 v[36:39], v20, s[88:91], s27 offen offset:0
    buffer_load_dwordx4 v[40:43], v20, s[88:91], s27 offen offset:128
    buffer_load_dwordx4 v[44:47], v20, s[88:91], s27 offen offset:256
    buffer_load_dwordx4 v[48:51], v20, s[88:91], s27 offen offset:384
    buffer_load_dwordx4 v[52:55], v20, s[88:91], s27 offen offset:512
    buffer_load_dwordx4 v[56:59], v20, s[88:91], s27 offen offset:640
    buffer_load_dwordx4 v[60:63], v20, s[88:91], s27 offen offset:768
    buffer_load_dwordx4 v[64:67], v20, s[88:91], s27 offen offset:896
    buffer_load_dwordx4 v[68:71], v20, s[88:91], s27 offen offset:1024
    buffer_load_dwordx4 v[72:75], v20, s[88:91], s27 offen offset:1152
    s_lshl_b32 s31, s17, 13
    s_lshl_b32 s32, s18, 6
    s_add_u32 s31, s31, s32
    s_add_u32 s31, s31, 28442624
    v_lshlrev_b32 v28, 6, v17
    v_lshl_add_u32 v28, v16, 3, v28
    s_lshl_b32 s44, s17, 8
    s_add_u32 s44, s44, 106496
    s_branch p0_i
p0_ib:
    s_cmp_lg_u32 s21, 2
    s_cbranch_scc1 p0_ic
    s_cmp_ge_u32 s2, 160
    s_cbranch_scc1 p0_ic
    s_mov_b32 s23, 2
    v_lshrrev_b32 v216, 7, v1
    v_and_b32 v217, 0x70, v1
    s_lshr_b32 s24, s2, 3
    s_and_b32 s25, s2, 7
    s_mul_i32 s26, s25, 160
    s_lshl_b32 s27, s24, 5
    v_add3_u32 v224, v216, s27, 0
    v_mul_u32_u24 v225, 1639, v224
    v_lshrrev_b32 v225, 16, v225
    v_mul_u32_u24 v225, 40, v225
    v_sub_u32 v226, v224, v225
    v_bfe_u32 v227, v226, 2, 1
    v_lshrrev_b32 v228, 3, v226
    v_and_b32 v229, 3, v226
    v_lshl_add_u32 v228, v228, 2, v229
    v_and_b32 v229, 1, v226
    v_bfe_u32 v230, v226, 1, 2
    v_add_u32 v230, 16, v230
    v_cmp_le_u32 vcc, 32, v226
    s_nop 1
    v_cndmask_b32 v227, v227, v229, vcc
    v_cndmask_b32 v228, v228, v230, vcc
    v_mul_u32_u24 v227, 20, v227
    v_add3_u32 v224, v225, v227, v228
    v_mul_u32_u24 v224, 1280, v224
    v_add_u32 v220, v224, v217
    v_add3_u32 v224, v216, s27, 8
    v_mul_u32_u24 v225, 1639, v224
    v_lshrrev_b32 v225, 16, v225
    v_mul_u32_u24 v225, 40, v225
    v_sub_u32 v226, v224, v225
    v_bfe_u32 v227, v226, 2, 1
    v_lshrrev_b32 v228, 3, v226
    v_and_b32 v229, 3, v226
    v_lshl_add_u32 v228, v228, 2, v229
    v_and_b32 v229, 1, v226
    v_bfe_u32 v230, v226, 1, 2
    v_add_u32 v230, 16, v230
    v_cmp_le_u32 vcc, 32, v226
    s_nop 1
    v_cndmask_b32 v227, v227, v229, vcc
    v_cndmask_b32 v228, v228, v230, vcc
    v_mul_u32_u24 v227, 20, v227
    v_add3_u32 v224, v225, v227, v228
    v_mul_u32_u24 v224, 1280, v224
    v_add_u32 v221, v224, v217
    v_add3_u32 v224, v216, s27, 16
    v_mul_u32_u24 v225, 1639, v224
    v_lshrrev_b32 v225, 16, v225
    v_mul_u32_u24 v225, 40, v225
    v_sub_u32 v226, v224, v225
    v_bfe_u32 v227, v226, 2, 1
    v_lshrrev_b32 v228, 3, v226
    v_and_b32 v229, 3, v226
    v_lshl_add_u32 v228, v228, 2, v229
    v_and_b32 v229, 1, v226
    v_bfe_u32 v230, v226, 1, 2
    v_add_u32 v230, 16, v230
    v_cmp_le_u32 vcc, 32, v226
    s_nop 1
    v_cndmask_b32 v227, v227, v229, vcc
    v_cndmask_b32 v228, v228, v230, vcc
    v_mul_u32_u24 v227, 20, v227
    v_add3_u32 v224, v225, v227, v228
    v_mul_u32_u24 v224, 1280, v224
    v_add_u32 v222, v224, v217
    v_add3_u32 v224, v216, s27, 24
    v_mul_u32_u24 v225, 1639, v224
    v_lshrrev_b32 v225, 16, v225
    v_mul_u32_u24 v225, 40, v225
    v_sub_u32 v226, v224, v225
    v_bfe_u32 v227, v226, 2, 1
    v_lshrrev_b32 v228, 3, v226
    v_and_b32 v229, 3, v226
    v_lshl_add_u32 v228, v228, 2, v229
    v_and_b32 v229, 1, v226
    v_bfe_u32 v230, v226, 1, 2
    v_add_u32 v230, 16, v230
    v_cmp_le_u32 vcc, 32, v226
    s_nop 1
    v_cndmask_b32 v227, v227, v229, vcc
    v_cndmask_b32 v228, v228, v230, vcc
    v_mul_u32_u24 v227, 20, v227
    v_add3_u32 v224, v225, v227, v228
    v_mul_u32_u24 v224, 1280, v224
    v_add_u32 v223, v224, v217
    s_and_b32 s27, s26, 0xffffff80
    s_mov_b32 s92, s80
    s_and_b32 s93, s81, 0xffff
    s_mov_b32 s94, 819200
    s_mov_b32 s95, 0x20000
    s_mov_b32 m0, 147456
    s_nop 0
    buffer_load_dwordx4 v220, s[92:95], s27 offen offset:0 nt lds
    s_mov_b32 m0, 148352
    s_nop 0
    buffer_load_dwordx4 v220, s[92:95], s27 offen offset:128 nt lds
    s_mov_b32 m0, 149504
    s_nop 0
    buffer_load_dwordx4 v221, s[92:95], s27 offen offset:0 nt lds
    s_mov_b32 m0, 150400
    s_nop 0
    buffer_load_dwordx4 v221, s[92:95], s27 offen offset:128 nt lds
    s_mov_b32 m0, 151552
    s_nop 0
    buffer_load_dwordx4 v222, s[92:95], s27 offen offset:0 nt lds
    s_mov_b32 m0, 152448
    s_nop 0
    buffer_load_dwordx4 v222, s[92:95], s27 offen offset:128 nt lds
    s_mov_b32 m0, 153600
    s_nop 0
    buffer_load_dwordx4 v223, s[92:95], s27 offen offset:0 nt lds
    s_mov_b32 m0, 154496
    s_nop 0
    buffer_load_dwordx4 v223, s[92:95], s27 offen offset:128 nt lds
    s_barrier
    s_and_b32 s26, s26, 127
    v_bfe_u32 v224, v1, 6, 2
    v_lshlrev_b32 v224, 7, v224
    v_bfe_u32 v225, v1, 8, 2
    v_lshl_add_u32 v224, v225, 11, v224
    v_add_u32 v224, 147456, v224
    v_bfe_u32 v225, v1, 4, 2
    v_lshl_add_u32 v226, v225, 3, s26
    v_lshl_add_u32 v227, v225, 4, s26
    v_add_u32 v229, 0, v227
    v_lshrrev_b32 v208, 7, v229
    v_mul_u32_u24 v208, 896, v208
    v_add3_u32 v208, v208, v229, v224
    v_add_u32 v229, 8, v227
    v_lshrrev_b32 v209, 7, v229
    v_mul_u32_u24 v209, 896, v209
    v_add3_u32 v209, v209, v229, v224
    v_add_u32 v229, 64, v227
    v_lshrrev_b32 v210, 7, v229
    v_mul_u32_u24 v210, 896, v210
    v_add3_u32 v210, v210, v229, v224
    v_add_u32 v229, 72, v227
    v_lshrrev_b32 v211, 7, v229
    v_mul_u32_u24 v211, 896, v211
    v_add3_u32 v211, v211, v229, v224
    v_add_u32 v229, 128, v226
    v_lshrrev_b32 v212, 7, v229
    v_mul_u32_u24 v212, 896, v212
    v_add3_u32 v212, v212, v229, v224
    s_mul_i32 s31, s25, 102400
    s_add_u32 s31, s31, 32768000
    s_mul_i32 s34, s24, 3072
    s_add_u32 s34, s34, s31
    s_add_u32 s34, s34, 40960
    s_lshl_b32 s35, s24, 11
    s_add_u32 s31, s31, s35
    s_lshl_b32 s44, s25, 8
    s_add_u32 s44, s44, 104448
    s_branch p0_i
p0_ic:
    s_barrier
p0_i:
    s_load_dwordx4 s[56:59], s[0:1], 32
    s_load_dwordx2 s[60:61], s[0:1], 48
    s_sub_u32 s62, s16, 4
    v_and_b32 v100, 63, v0
    v_lshrrev_b32 v101, 3, v100
    v_and_b32 v102, 7, v100
    s_mov_b32 s55, 0x20000
    s_mov_b32 s54, 1966080
    s_cmp_ge_u32 s2, 160
    s_cbranch_scc1 cv_7001_w2
    s_and_b32 s63, s2, 3
    s_lshl_b32 s63, s63, 2
    s_add_u32 s63, s63, s62
    s_lshr_b32 s64, s2, 3
    s_mul_i32 s65, s63, 192
    s_mov_b32 s66, 3072
    s_and_b32 s69, s64, 7
    s_mul_i32 s69, s69, 80
    s_lshr_b32 s70, s64, 3
    s_lshl_b32 s70, s70, 5
    s_add_u32 s69, s69, s70
    s_mul_i32 s70, s64, 160
    s_sub_u32 s70, s70, 2496
    s_cmp_ge_u32 s64, 16
    s_cselect_b32 s69, s70, s69
    s_cselect_b32 s70, 196608, 0
    s_bitcmp1_b32 s2, 2
    s_waitcnt lgkmcnt(0)
    s_cselect_b32 s52, s58, s56
    s_cselect_b32 s53, s59, s57
    s_branch cv_7001_c
cv_7001_w2:
    s_sub_u32 s64, s2, 160
    s_and_b32 s63, s64, 1
    s_lshl_b32 s63, s63, 2
    s_add_u32 s63, s63, s62
    s_lshr_b32 s64, s64, 1
    s_mul_i32 s65, s63, 160
    s_mov_b32 s66, 1280
    s_lshl_b32 s69, s64, 5
    s_mov_b32 s70, 0
    s_waitcnt lgkmcnt(0)
    s_mov_b32 s52, s60
    s_mov_b32 s53, s61
cv_7001_c:
    s_and_b32 s53, s53, 0xffff
    s_mul_i32 s67, s69, s66
    s_and_b32 s68, s65, 0xffffff80
    s_add_u32 s67, s67, s68
    s_and_b32 s65, s65, 127
    v_mul_lo_u32 v101, v101, s66
    v_lshl_add_u32 v101, v102, 4, v101
    s_lshl_b32 s66, s66, 3
    s_lshl_b32 s68, s62, 13
    s_add_u32 s68, s68, 32768
    v_lshrrev_b32 v103, 4, v100
    v_bfe_u32 v104, v100, 2, 2
    v_lshlrev_b32 v104, 7, v104
    v_lshl_add_u32 v104, v103, 11, v104
    v_add_u32 v104, s68, v104
    v_and_b32 v105, 3, v100
    v_lshl_add_u32 v106, v105, 3, s65
    v_lshl_add_u32 v107, v105, 4, s65
    v_lshlrev_b32 v108, 4, v100
    v_lshlrev_b32 v109, 4, v103
    v_and_b32 v110, 15, v100
    v_lshl_add_u32 v109, v110, 6, v109
    v_mov_b32 v111, 0x3f803f80
    v_cmp_eq_u32 vcc, 0, v110
    s_nop 1
    v_cndmask_b32 v76, 0, v111, vcc
    v_cndmask_b32 v77, 0, v111, vcc
    v_cndmask_b32 v78, 0, v111, vcc
    v_cndmask_b32 v79, 0, v111, vcc
    v_cmp_eq_u32 vcc, 1, v110
    s_nop 1
    v_cndmask_b32 v80, 0, v111, vcc
    v_cndmask_b32 v81, 0, v111, vcc
    v_cndmask_b32 v82, 0, v111, vcc
    v_cndmask_b32 v83, 0, v111, vcc
    v_cmp_eq_u32 vcc, 2, v110
    s_nop 1
    v_cndmask_b32 v84, 0, v111, vcc
    v_cndmask_b32 v85, 0, v111, vcc
    v_cndmask_b32 v86, 0, v111, vcc
    v_cndmask_b32 v87, 0, v111, vcc
    v_cmp_eq_u32 vcc, 3, v110
    s_nop 1
    v_cndmask_b32 v88, 0, v111, vcc
    v_cndmask_b32 v89, 0, v111, vcc
    v_cndmask_b32 v90, 0, v111, vcc
    v_cndmask_b32 v91, 0, v111, vcc
    v_cmp_eq_u32 vcc, 4, v110
    s_nop 1
    v_cndmask_b32 v92, 0, v111, vcc
    v_cndmask_b32 v93, 0, v111, vcc
    v_cndmask_b32 v94, 0, v111, vcc
    v_cndmask_b32 v95, 0, v111, vcc
    v_cmp_eq_u32 vcc, 5, v110
    s_nop 1
    v_cndmask_b32 v96, 0, v111, vcc
    v_cndmask_b32 v97, 0, v111, vcc
    v_cndmask_b32 v98, 0, v111, vcc
    v_cndmask_b32 v99, 0, v111, vcc
    s_waitcnt vmcnt(0)
    s_cmp_eq_u32 s23, 0
    s_cbranch_scc1 p0_d
    s_cmp_eq_u32 s23, 3
    s_cbranch_scc1 p0_st2
    s_cmp_eq_u32 s23, 2
    s_cbranch_scc1 p0_wo3
    ds_read_b64_tr_b16 v[44:45], v30
    ds_read_b64_tr_b16 v[46:47], v30 offset:512
    ds_read_b64_tr_b16 v[48:49], v31
    ds_read_b64_tr_b16 v[50:51], v31 offset:512
    ds_read_b64_tr_b16 v[52:53], v32
    ds_read_b64_tr_b16 v[54:55], v32 offset:512
    ds_read_b64_tr_b16 v[56:57], v33
    ds_read_b64_tr_b16 v[58:59], v33 offset:512
    ds_read_b64_tr_b16 v[60:61], v34
    ds_read_b64_tr_b16 v[62:63], v34 offset:512
    ds_read_b64_tr_b16 v[64:65], v35
    ds_read_b64_tr_b16 v[66:67], v35 offset:512
    s_waitcnt lgkmcnt(8)
    buffer_store_dwordx4 v[44:47], v1, s[8:11], s31 offen sc1
    buffer_store_dwordx4 v[48:51], v1, s[8:11], s31 offen offset:1024 sc1
    s_waitcnt lgkmcnt(6)
    v_cndmask_b32 v52, 0, v52, s[38:39]
    v_cndmask_b32 v53, 0, v53, s[38:39]
    v_cndmask_b32 v54, 0, v54, s[38:39]
    v_cndmask_b32 v55, 0, v55, s[38:39]
    s_mov_b64 exec, s[42:43]
    buffer_store_dwordx4 v[52:55], v1, s[8:11], s34 offen sc1
    s_mov_b64 exec, -1
    s_add_u32 s31, s31, 163840
    s_add_u32 s34, s34, 163840
    s_waitcnt lgkmcnt(2)
    buffer_store_dwordx4 v[56:59], v1, s[8:11], s31 offen sc1
    buffer_store_dwordx4 v[60:63], v1, s[8:11], s31 offen offset:1024 sc1
    s_waitcnt lgkmcnt(0)
    v_cndmask_b32 v64, 0, v64, s[38:39]
    v_cndmask_b32 v65, 0, v65, s[38:39]
    v_cndmask_b32 v66, 0, v66, s[38:39]
    v_cndmask_b32 v67, 0, v67, s[38:39]
    s_mov_b64 exec, s[42:43]
    buffer_store_dwordx4 v[64:67], v1, s[8:11], s34 offen sc1
    s_mov_b64 exec, -1
    s_nop 1
    v_mfma_f32_16x16x32_bf16 v[68:71], v[44:47], v[76:79], 0
    v_mfma_f32_16x16x32_bf16 v[68:71], v[48:51], v[80:83], v[68:71]
    v_mfma_f32_16x16x32_bf16 v[68:71], v[52:55], v[84:87], v[68:71]
    v_mfma_f32_16x16x32_bf16 v[68:71], v[56:59], v[88:91], v[68:71]
    v_mfma_f32_16x16x32_bf16 v[68:71], v[60:63], v[92:95], v[68:71]
    v_mfma_f32_16x16x32_bf16 v[68:71], v[64:67], v[96:99], v[68:71]
    s_mov_b32 exec_lo, 0xff00ff
    s_mov_b32 exec_hi, 0xff00ff
    s_nop 5
    buffer_store_dwordx4 v[68:71], v28, s[8:11], s35 offen sc1
    s_mov_b64 exec, -1
    s_branch p0_d
p0_wo3:
    ds_read_b64_tr_b16 v[232:233], v208
    ds_read_b64_tr_b16 v[234:235], v208 offset:512
    ds_read_b64_tr_b16 v[236:237], v209
    ds_read_b64_tr_b16 v[238:239], v209 offset:512
    ds_read_b64_tr_b16 v[240:241], v210
    ds_read_b64_tr_b16 v[242:243], v210 offset:512
    ds_read_b64_tr_b16 v[244:245], v211
    ds_read_b64_tr_b16 v[246:247], v211 offset:512
    ds_read_b64_tr_b16 v[248:249], v212
    ds_read_b64_tr_b16 v[250:251], v212 offset:512
    s_waitcnt lgkmcnt(8)
    buffer_store_dwordx4 v[232:235], v1, s[8:11], s31 offen offset:0 sc1
    s_waitcnt lgkmcnt(6)
    buffer_store_dwordx4 v[236:239], v1, s[8:11], s31 offen offset:1024 sc1
    s_waitcnt lgkmcnt(4)
    buffer_store_dwordx4 v[240:243], v1, s[8:11], s34 offen offset:0 sc1
    s_waitcnt lgkmcnt(2)
    buffer_store_dwordx4 v[244:247], v1, s[8:11], s34 offen offset:1024 sc1
    s_waitcnt lgkmcnt(0)
    buffer_store_dwordx4 v[248:251], v1, s[8:11], s34 offen offset:2048 sc1
    s_branch p0_d
p0_st2:
    v_lshlrev_b32 v34, 16, v36
    v_and_b32 v35, 0xffff0000, v36
    v_pk_add_f32 v[30:31], 0, v[34:35]
    v_pk_fma_f32 v[32:33], v[34:35], v[34:35], 0
    v_lshlrev_b32 v34, 16, v37
    v_and_b32 v35, 0xffff0000, v37
    v_pk_add_f32 v[30:31], v[30:31], v[34:35]
    v_pk_fma_f32 v[32:33], v[34:35], v[34:35], v[32:33]
    v_lshlrev_b32 v34, 16, v38
    v_and_b32 v35, 0xffff0000, v38
    v_pk_add_f32 v[30:31], v[30:31], v[34:35]
    v_pk_fma_f32 v[32:33], v[34:35], v[34:35], v[32:33]
    v_lshlrev_b32 v34, 16, v39
    v_and_b32 v35, 0xffff0000, v39
    v_pk_add_f32 v[30:31], v[30:31], v[34:35]
    v_pk_fma_f32 v[32:33], v[34:35], v[34:35], v[32:33]
    v_lshlrev_b32 v34, 16, v40
    v_and_b32 v35, 0xffff0000, v40
    v_pk_add_f32 v[30:31], v[30:31], v[34:35]
    v_pk_fma_f32 v[32:33], v[34:35], v[34:35], v[32:33]
    v_lshlrev_b32 v34, 16, v41
    v_and_b32 v35, 0xffff0000, v41
    v_pk_add_f32 v[30:31], v[30:31], v[34:35]
    v_pk_fma_f32 v[32:33], v[34:35], v[34:35], v[32:33]
    v_lshlrev_b32 v34, 16, v42
    v_and_b32 v35, 0xffff0000, v42
    v_pk_add_f32 v[30:31], v[30:31], v[34:35]
    v_pk_fma_f32 v[32:33], v[34:35], v[34:35], v[32:33]
    v_lshlrev_b32 v34, 16, v43
    v_and_b32 v35, 0xffff0000, v43
    v_pk_add_f32 v[30:31], v[30:31], v[34:35]
    v_pk_fma_f32 v[32:33], v[34:35], v[34:35], v[32:33]
    v_lshlrev_b32 v34, 16, v44
    v_and_b32 v35, 0xffff0000, v44
    v_pk_add_f32 v[30:31], v[30:31], v[34:35]
    v_pk_fma_f32 v[32:33], v[34:35], v[34:35], v[32:33]
    v_lshlrev_b32 v34, 16, v45
    v_and_b32 v35, 0xffff0000, v45
    v_pk_add_f32 v[30:31], v[30:31], v[34:35]
    v_pk_fma_f32 v[32:33], v[34:35], v[34:35], v[32:33]
    v_lshlrev_b32 v34, 16, v46
    v_and_b32 v35, 0xffff0000, v46
    v_pk_add_f32 v[30:31], v[30:31], v[34:35]
    v_pk_fma_f32 v[32:33], v[34:35], v[34:35], v[32:33]
    v_lshlrev_b32 v34, 16, v47
    v_and_b32 v35, 0xffff0000, v47
    v_pk_add_f32 v[30:31], v[30:31], v[34:35]
    v_pk_fma_f32 v[32:33], v[34:35], v[34:35], v[32:33]
    v_lshlrev_b32 v34, 16, v48
    v_and_b32 v35, 0xffff0000, v48
    v_pk_add_f32 v[30:31], v[30:31], v[34:35]
    v_pk_fma_f32 v[32:33], v[34:35], v[34:35], v[32:33]
    v_lshlrev_b32 v34, 16, v49
    v_and_b32 v35, 0xffff0000, v49
    v_pk_add_f32 v[30:31], v[30:31], v[34:35]
    v_pk_fma_f32 v[32:33], v[34:35], v[34:35], v[32:33]
    v_lshlrev_b32 v34, 16, v50
    v_and_b32 v35, 0xffff0000, v50
    v_pk_add_f32 v[30:31], v[30:31], v[34:35]
    v_pk_fma_f32 v[32:33], v[34:35], v[34:35], v[32:33]
    v_lshlrev_b32 v34, 16, v51
    v_and_b32 v35, 0xffff0000, v51
    v_pk_add_f32 v[30:31], v[30:31], v[34:35]
    v_pk_fma_f32 v[32:33], v[34:35], v[34:35], v[32:33]
    v_lshlrev_b32 v34, 16, v52
    v_and_b32 v35, 0xffff0000, v52
    v_pk_add_f32 v[30:31], v[30:31], v[34:35]
    v_pk_fma_f32 v[32:33], v[34:35], v[34:35], v[32:33]
    v_lshlrev_b32 v34, 16, v53
    v_and_b32 v35, 0xffff0000, v53
    v_pk_add_f32 v[30:31], v[30:31], v[34:35]
    v_pk_fma_f32 v[32:33], v[34:35], v[34:35], v[32:33]
    v_lshlrev_b32 v34, 16, v54
    v_and_b32 v35, 0xffff0000, v54
    v_pk_add_f32 v[30:31], v[30:31], v[34:35]
    v_pk_fma_f32 v[32:33], v[34:35], v[34:35], v[32:33]
    v_lshlrev_b32 v34, 16, v55
    v_and_b32 v35, 0xffff0000, v55
    v_pk_add_f32 v[30:31], v[30:31], v[34:35]
    v_pk_fma_f32 v[32:33], v[34:35], v[34:35], v[32:33]
    v_lshlrev_b32 v34, 16, v56
    v_and_b32 v35, 0xffff0000, v56
    v_pk_add_f32 v[30:31], v[30:31], v[34:35]
    v_pk_fma_f32 v[32:33], v[34:35], v[34:35], v[32:33]
    v_lshlrev_b32 v34, 16, v57
    v_and_b32 v35, 0xffff0000, v57
    v_pk_add_f32 v[30:31], v[30:31], v[34:35]
    v_pk_fma_f32 v[32:33], v[34:35], v[34:35], v[32:33]
    v_lshlrev_b32 v34, 16, v58
    v_and_b32 v35, 0xffff0000, v58
    v_pk_add_f32 v[30:31], v[30:31], v[34:35]
    v_pk_fma_f32 v[32:33], v[34:35], v[34:35], v[32:33]
    v_lshlrev_b32 v34, 16, v59
    v_and_b32 v35, 0xffff0000, v59
    v_pk_add_f32 v[30:31], v[30:31], v[34:35]
    v_pk_fma_f32 v[32:33], v[34:35], v[34:35], v[32:33]
    v_lshlrev_b32 v34, 16, v60
    v_and_b32 v35, 0xffff0000, v60
    v_pk_add_f32 v[30:31], v[30:31], v[34:35]
    v_pk_fma_f32 v[32:33], v[34:35], v[34:35], v[32:33]
    v_lshlrev_b32 v34, 16, v61
    v_and_b32 v35, 0xffff0000, v61
    v_pk_add_f32 v[30:31], v[30:31], v[34:35]
    v_pk_fma_f32 v[32:33], v[34:35], v[34:35], v[32:33]
    v_lshlrev_b32 v34, 16, v62
    v_and_b32 v35, 0xffff0000, v62
    v_pk_add_f32 v[30:31], v[30:31], v[34:35]
    v_pk_fma_f32 v[32:33], v[34:35], v[34:35], v[32:33]
    v_lshlrev_b32 v34, 16, v63
    v_and_b32 v35, 0xffff0000, v63
    v_pk_add_f32 v[30:31], v[30:31], v[34:35]
    v_pk_fma_f32 v[32:33], v[34:35], v[34:35], v[32:33]
    v_lshlrev_b32 v34, 16, v64
    v_and_b32 v35, 0xffff0000, v64
    v_pk_add_f32 v[30:31], v[30:31], v[34:35]
    v_pk_fma_f32 v[32:33], v[34:35], v[34:35], v[32:33]
    v_lshlrev_b32 v34, 16, v65
    v_and_b32 v35, 0xffff0000, v65
    v_pk_add_f32 v[30:31], v[30:31], v[34:35]
    v_pk_fma_f32 v[32:33], v[34:35], v[34:35], v[32:33]
    v_lshlrev_b32 v34, 16, v66
    v_and_b32 v35, 0xffff0000, v66
    v_pk_add_f32 v[30:31], v[30:31], v[34:35]
    v_pk_fma_f32 v[32:33], v[34:35], v[34:35], v[32:33]
    v_lshlrev_b32 v34, 16, v67
    v_and_b32 v35, 0xffff0000, v67
    v_pk_add_f32 v[30:31], v[30:31], v[34:35]
    v_pk_fma_f32 v[32:33], v[34:35], v[34:35], v[32:33]
    v_lshlrev_b32 v34, 16, v68
    v_and_b32 v35, 0xffff0000, v68
    v_pk_add_f32 v[30:31], v[30:31], v[34:35]
    v_pk_fma_f32 v[32:33], v[34:35], v[34:35], v[32:33]
    v_lshlrev_b32 v34, 16, v69
    v_and_b32 v35, 0xffff0000, v69
    v_pk_add_f32 v[30:31], v[30:31], v[34:35]
    v_pk_fma_f32 v[32:33], v[34:35], v[34:35], v[32:33]
    v_lshlrev_b32 v34, 16, v70
    v_and_b32 v35, 0xffff0000, v70
    v_pk_add_f32 v[30:31], v[30:31], v[34:35]
    v_pk_fma_f32 v[32:33], v[34:35], v[34:35], v[32:33]
    v_lshlrev_b32 v34, 16, v71
    v_and_b32 v35, 0xffff0000, v71
    v_pk_add_f32 v[30:31], v[30:31], v[34:35]
    v_pk_fma_f32 v[32:33], v[34:35], v[34:35], v[32:33]
    v_lshlrev_b32 v34, 16, v72
    v_and_b32 v35, 0xffff0000, v72
    v_pk_add_f32 v[30:31], v[30:31], v[34:35]
    v_pk_fma_f32 v[32:33], v[34:35], v[34:35], v[32:33]
    v_lshlrev_b32 v34, 16, v73
    v_and_b32 v35, 0xffff0000, v73
    v_pk_add_f32 v[30:31], v[30:31], v[34:35]
    v_pk_fma_f32 v[32:33], v[34:35], v[34:35], v[32:33]
    v_lshlrev_b32 v34, 16, v74
    v_and_b32 v35, 0xffff0000, v74
    v_pk_add_f32 v[30:31], v[30:31], v[34:35]
    v_pk_fma_f32 v[32:33], v[34:35], v[34:35], v[32:33]
    v_lshlrev_b32 v34, 16, v75
    v_and_b32 v35, 0xffff0000, v75
    v_pk_add_f32 v[30:31], v[30:31], v[34:35]
    v_pk_fma_f32 v[32:33], v[34:35], v[34:35], v[32:33]
    v_add_f32 v30, v30, v31
    v_add_f32 v31, v32, v33
    s_nop 0
    v_add_f32_dpp v30, v30, v30 quad_perm:[1,0,3,2] row_mask:0xf bank_mask:0xf
    v_add_f32_dpp v31, v31, v31 quad_perm:[1,0,3,2] row_mask:0xf bank_mask:0xf
    s_nop 0
    v_add_f32_dpp v30, v30, v30 quad_perm:[2,3,0,1] row_mask:0xf bank_mask:0xf
    v_add_f32_dpp v31, v31, v31 quad_perm:[2,3,0,1] row_mask:0xf bank_mask:0xf
    s_nop 0
    v_add_f32_dpp v30, v30, v30 row_half_mirror row_mask:0xf bank_mask:0xf
    v_add_f32_dpp v31, v31, v31 row_half_mirror row_mask:0xf bank_mask:0xf
    v_cmp_eq_u32 vcc, 0, v17
    s_nop 1
    v_cndmask_b32 v30, 0, v30, vcc
    v_cndmask_b32 v31, 0, v31, vcc
    buffer_store_dwordx2 v[30:31], v28, s[8:11], s31 offen sc1
p0_d:
    v_mov_b32 v22, 0
    s_mov_b32 s48, 300000
    s_cmp_eq_u32 s23, 0
    s_cbranch_scc1 p0_np
p0_ck:
    global_load_dword v23, v22, s[84:85] sc1
    s_waitcnt vmcnt(0)
    v_readfirstlane_b32 s49, v23
    s_nop 1
    s_cmp_ge_u32 s49, 16
    s_cbranch_scc1 p0_ck_x
    s_sleep 10
    s_sub_u32 s48, s48, 1
    s_cmp_lg_u32 s48, 0
    s_cbranch_scc1 p0_ck
p0_ck_x:
    s_mov_b32 s45, 1
    s_atomic_add s45, s[4:5], s44
p0_np:
    s_cmp_ge_u32 s16, 6
    s_cbranch_scc1 main_kernel_misc
    s_branch main_kernel_load
main_kernel_comp:
    v_and_b32 v5, 15, v0
    v_bfe_u32 v6, v0, 4, 2
    s_cmp_lg_u32 s16, 0
    s_cbranch_scc1 p0_c1
    s_cmp_ge_u32 s2, 16
    s_cbranch_scc1 p0_c1
    v_lshlrev_b32 v21, 4, v1
    v_mov_b32 v22, 0
    s_mul_i32 s36, s2, 7168
    s_add_u32 s36, s36, 0
    s_mov_b64 exec, 0xfffffff
    buffer_store_dword v22, v21, s[8:11], s36 offen sc1
    s_mov_b64 exec, -1
p0_c1:
    v_lshrrev_b32 v20, 7, v1
    v_lshrrev_b32 v21, 1, v20
    v_bfe_u32 v22, v1, 4, 3
    v_xor_b32 v21, v21, v22
    v_mul_u32_u24 v20, 1280, v20
    v_lshl_add_u32 v20, v21, 4, v20
    v_xor_b32 v21, 64, v20
    v_add_u32 v21, 10240, v21
    s_lshl_b32 s35, s17, 2
    s_add_u32 s35, s35, s16
    s_mul_i32 s35, s35, 40960
    s_lshl_b32 s30, s16, 12
    v_lshrrev_b32 v12, 1, v5
    v_xor_b32 v12, v12, v6
    v_lshlrev_b32 v12, 4, v12
    v_lshl_add_u32 v12, v5, 7, v12
    v_add_u32 v12, s30, v12
    v_xor_b32 v13, 64, v12
    s_lshr_b32 s36, s2, 3
    s_lshl_b32 s36, s36, 2
    s_add_u32 s36, s36, s16
    s_lshl_b32 s36, s36, 9
    s_mov_b32 s37, main_kernel_end-main_kernel-1024
    s_min_u32 s36, s36, s37
    v_lshrrev_b32 v22, 1, v1
    v_add_u32 v22, s36, v22
    s_barrier
    s_cmp_lg_u32 s16, 0
    s_cbranch_scc1 p0_c2
    s_cmp_ge_u32 s2, 16
    s_cbranch_scc1 p0_c2
    s_mov_b32 s37, 1
    s_waitcnt vmcnt(0)
    s_atomic_add s37, s[84:85], 0
p0_c2:
    global_load_dwordx2 v[24:25], v22, s[86:87]
    s_add_u32 m0, s30, 0
    s_add_u32 s31, s35, 0
    buffer_load_dwordx4 v20, s[88:91], s31 offen  lds
    s_add_u32 m0, s30, 1024
    s_add_u32 s31, s35, 0
    buffer_load_dwordx4 v21, s[88:91], s31 offen  lds
    s_add_u32 m0, s30, 2048
    s_add_u32 s31, s35, 20480
    buffer_load_dwordx4 v20, s[88:91], s31 offen  lds
    s_add_u32 m0, s30, 3072
    s_add_u32 s31, s35, 20480
    buffer_load_dwordx4 v21, s[88:91], s31 offen  lds
    s_add_u32 m0, s30, 16384
    s_add_u32 s31, s35, 128
    buffer_load_dwordx4 v20, s[88:91], s31 offen  lds
    s_add_u32 m0, s30, 17408
    s_add_u32 s31, s35, 128
    buffer_load_dwordx4 v21, s[88:91], s31 offen  lds
    s_add_u32 m0, s30, 18432
    s_add_u32 s31, s35, 20608
    buffer_load_dwordx4 v20, s[88:91], s31 offen  lds
    s_add_u32 m0, s30, 19456
    s_add_u32 s31, s35, 20608
    buffer_load_dwordx4 v21, s[88:91], s31 offen  lds
    s_lshl_b32 s22, s16, 11
    v_add_u32 v2, s22, v1
    v_add_u32 v3, 65536, v1
    v_add_u32 v4, 0x10000, v3
    s_lshl_b32 s22, s16, 7
    s_add_u32 s22, s22, 155648
    v_lshl_add_u32 v7, v6, 4, s22
    v_lshl_add_u32 v8, v5, 2, s22
    v_lshlrev_b32 v9, 2, v5
    v_add_u32 v9, 156672, v9
    v_lshlrev_b32 v10, 4, v6
    v_add_u32 v10, 156672, v10
    s_lshl_b32 s22, s16, 12
    s_add_u32 s22, s22, 0
    v_add_u32 v11, s22, v1
    v_cmp_gt_u32 s[36:37], 8, v5
    v_cmp_eq_u32 s[38:39], 1, v5
    v_cmp_le_u32 s[40:41], 12, v5
    s_nop 1
    s_or_b64 s[38:39], s[38:39], s[40:41]
    v_cmp_eq_u32 s[40:41], 1, v6
    v_cmp_eq_u32 s[42:43], 0, v6
    s_mov_b32 s21, 0x358637bd
    s_mov_b32 s26, 0x35c1a2a0
    s_mov_b32 s27, 0x35c1a2a0
    s_mov_b32 s28, 0x3f317218
    s_mov_b32 s29, 0x3f317218
    s_waitcnt vmcnt(4)
    s_waitcnt lgkmcnt(0)
    s_add_u32 m0, s30, 32768
    s_add_u32 s31, s35, 256
    buffer_load_dwordx4 v20, s[88:91], s31 offen  lds
    s_add_u32 m0, s30, 33792
    s_add_u32 s31, s35, 256
    buffer_load_dwordx4 v21, s[88:91], s31 offen  lds
    s_add_u32 m0, s30, 34816
    s_add_u32 s31, s35, 20736
    buffer_load_dwordx4 v20, s[88:91], s31 offen  lds
    s_add_u32 m0, s30, 35840
    s_add_u32 s31, s35, 20736
    buffer_load_dwordx4 v21, s[88:91], s31 offen  lds
    ds_read_b128 v[96:99], v12 offset:0
    ds_read_b128 v[100:103], v12 offset:2048
    ds_read_b128 v[104:107], v13 offset:0
    ds_read_b128 v[108:111], v13 offset:2048
    s_waitcnt vmcnt(4)
    s_waitcnt lgkmcnt(0)
    s_add_u32 m0, s30, 49152
    s_add_u32 s31, s35, 384
    buffer_load_dwordx4 v20, s[88:91], s31 offen  lds
    s_add_u32 m0, s30, 50176
    s_add_u32 s31, s35, 384
    buffer_load_dwordx4 v21, s[88:91], s31 offen  lds
    s_add_u32 m0, s30, 51200
    s_add_u32 s31, s35, 20864
    buffer_load_dwordx4 v20, s[88:91], s31 offen  lds
    s_add_u32 m0, s30, 52224
    s_add_u32 s31, s35, 20864
    buffer_load_dwordx4 v21, s[88:91], s31 offen  lds
    ds_read_b128 v[112:115], v12 offset:16384
    ds_read_b128 v[116:119], v12 offset:18432
    ds_read_b128 v[120:123], v13 offset:16384
    ds_read_b128 v[124:127], v13 offset:18432
    s_waitcnt vmcnt(4)
    s_waitcnt lgkmcnt(0)
    s_add_u32 m0, s30, 0
    s_add_u32 s31, s35, 512
    buffer_load_dwordx4 v20, s[88:91], s31 offen  lds
    s_add_u32 m0, s30, 1024
    s_add_u32 s31, s35, 512
    buffer_load_dwordx4 v21, s[88:91], s31 offen  lds
    s_add_u32 m0, s30, 2048
    s_add_u32 s31, s35, 20992
    buffer_load_dwordx4 v20, s[88:91], s31 offen  lds
    s_add_u32 m0, s30, 3072
    s_add_u32 s31, s35, 20992
    buffer_load_dwordx4 v21, s[88:91], s31 offen  lds
    ds_read_b128 v[128:131], v12 offset:32768
    ds_read_b128 v[132:135], v12 offset:34816
    ds_read_b128 v[136:139], v13 offset:32768
    ds_read_b128 v[140:143], v13 offset:34816
    s_waitcnt vmcnt(4)
    s_waitcnt lgkmcnt(0)
    s_add_u32 m0, s30, 16384
    s_add_u32 s31, s35, 640
    buffer_load_dwordx4 v20, s[88:91], s31 offen  lds
    s_add_u32 m0, s30, 17408
    s_add_u32 s31, s35, 640
    buffer_load_dwordx4 v21, s[88:91], s31 offen  lds
    s_add_u32 m0, s30, 18432
    s_add_u32 s31, s35, 21120
    buffer_load_dwordx4 v20, s[88:91], s31 offen  lds
    s_add_u32 m0, s30, 19456
    s_add_u32 s31, s35, 21120
    buffer_load_dwordx4 v21, s[88:91], s31 offen  lds
    ds_read_b128 v[144:147], v12 offset:49152
    ds_read_b128 v[148:151], v12 offset:51200
    ds_read_b128 v[152:155], v13 offset:49152
    ds_read_b128 v[156:159], v13 offset:51200
    s_waitcnt vmcnt(4)
    s_waitcnt lgkmcnt(0)
    s_add_u32 m0, s30, 32768
    s_add_u32 s31, s35, 768
    buffer_load_dwordx4 v20, s[88:91], s31 offen  lds
    s_add_u32 m0, s30, 33792
    s_add_u32 s31, s35, 768
    buffer_load_dwordx4 v21, s[88:91], s31 offen  lds
    s_add_u32 m0, s30, 34816
    s_add_u32 s31, s35, 21248
    buffer_load_dwordx4 v20, s[88:91], s31 offen  lds
    s_add_u32 m0, s30, 35840
    s_add_u32 s31, s35, 21248
    buffer_load_dwordx4 v21, s[88:91], s31 offen  lds
    ds_read_b128 v[160:163], v12 offset:0
    ds_read_b128 v[164:167], v12 offset:2048
    ds_read_b128 v[168:171], v13 offset:0
    ds_read_b128 v[172:175], v13 offset:2048
    s_waitcnt vmcnt(4)
    s_waitcnt lgkmcnt(0)
    s_add_u32 m0, s30, 49152
    s_add_u32 s31, s35, 896
    buffer_load_dwordx4 v20, s[88:91], s31 offen  lds
    s_add_u32 m0, s30, 50176
    s_add_u32 s31, s35, 896
    buffer_load_dwordx4 v21, s[88:91], s31 offen  lds
    s_add_u32 m0, s30, 51200
    s_add_u32 s31, s35, 21376
    buffer_load_dwordx4 v20, s[88:91], s31 offen  lds
    s_add_u32 m0, s30, 52224
    s_add_u32 s31, s35, 21376
    buffer_load_dwordx4 v21, s[88:91], s31 offen  lds
    ds_read_b128 v[176:179], v12 offset:16384
    ds_read_b128 v[180:183], v12 offset:18432
    ds_read_b128 v[184:187], v13 offset:16384
    ds_read_b128 v[188:191], v13 offset:18432
    s_waitcnt vmcnt(4)
    s_waitcnt lgkmcnt(0)
    s_add_u32 m0, s30, 0
    s_add_u32 s31, s35, 1024
    buffer_load_dwordx4 v20, s[88:91], s31 offen  lds
    s_add_u32 m0, s30, 1024
    s_add_u32 s31, s35, 1024
    buffer_load_dwordx4 v21, s[88:91], s31 offen  lds
    s_add_u32 m0, s30, 2048
    s_add_u32 s31, s35, 21504
    buffer_load_dwordx4 v20, s[88:91], s31 offen  lds
    s_add_u32 m0, s30, 3072
    s_add_u32 s31, s35, 21504
    buffer_load_dwordx4 v21, s[88:91], s31 offen  lds
    ds_read_b128 v[192:195], v12 offset:32768
    ds_read_b128 v[196:199], v12 offset:34816
    ds_read_b128 v[200:203], v13 offset:32768
    ds_read_b128 v[204:207], v13 offset:34816
    s_waitcnt vmcnt(4)
    s_waitcnt lgkmcnt(0)
    s_add_u32 m0, s30, 16384
    s_add_u32 s31, s35, 1152
    buffer_load_dwordx4 v20, s[88:91], s31 offen  lds
    s_add_u32 m0, s30, 17408
    s_add_u32 s31, s35, 1152
    buffer_load_dwordx4 v21, s[88:91], s31 offen  lds
    s_add_u32 m0, s30, 18432
    s_add_u32 s31, s35, 21632
    buffer_load_dwordx4 v20, s[88:91], s31 offen  lds
    s_add_u32 m0, s30, 19456
    s_add_u32 s31, s35, 21632
    buffer_load_dwordx4 v21, s[88:91], s31 offen  lds
    ds_read_b128 v[208:211], v12 offset:49152
    ds_read_b128 v[212:215], v12 offset:51200
    ds_read_b128 v[216:219], v13 offset:49152
    ds_read_b128 v[220:223], v13 offset:51200
    s_waitcnt vmcnt(4)
    ds_read_b128 v[224:227], v12 offset:0
    ds_read_b128 v[228:231], v12 offset:2048
    ds_read_b128 v[232:235], v13 offset:0
    ds_read_b128 v[236:239], v13 offset:2048
    s_waitcnt vmcnt(0)
    s_waitcnt lgkmcnt(0)
    s_branch p1_in
main_kernel_load:
    s_sub_u32 s30, s16, 4
    s_lshl_b32 s30, s30, 10
    v_add_u32 v14, s30, v1
    s_mul_i32 s44, s18, 163840
    s_add_u32 s44, s44, 30146560
    s_mul_i32 s46, s18, 245760
    s_add_u32 s46, s46, 33619968
    s_lshr_b32 s34, s18, 1
    s_mul_i32 s45, s34, 102400
    s_add_u32 s45, s45, 32768000
    s_mul_i32 s47, s34, 245760
    s_add_u32 s47, s47, 37552128
    s_mul_i32 s34, s17, 163840
    s_and_b32 s35, s18, 1
    s_lshl_b32 s35, s35, 12
    s_mul_i32 s40, s19, 2621440
    s_add_u32 s40, s40, 131072
    s_add_u32 s40, s40, s34
    s_mul_i32 s41, s19, 2621440
    s_add_u32 s41, s41, 5373952
    s_add_u32 s41, s41, s34
    s_add_u32 s41, s41, s35
    s_mul_i32 s42, s19, 2621440
    s_add_u32 s42, s42, 10616832
    s_add_u32 s42, s42, s34
    s_mul_i32 s43, s19, 6291456
    s_add_u32 s43, s43, 15859712
    s_mul_i32 s34, s17, 393216
    s_add_u32 s43, s43, s34
    s_add_u32 s43, s43, s35
    s_sub_u32 s34, s16, 4
    v_bfe_u32 v20, v0, 3, 3
    v_lshl_add_u32 v20, s34, 3, v20
    v_lshrrev_b32 v21, 1, v20
    v_and_b32 v22, 7, v0
    v_xor_b32 v21, v21, v22
    v_mul_u32_u24 v20, 1280, v20
    v_lshl_add_u32 v20, v21, 4, v20
    s_mul_i32 s36, s17, 163840
    s_barrier
    s_add_u32 m0, s30, 65536
    s_add_u32 s31, s44, 0
    buffer_load_dwordx4 v14, s[8:11], s31 offen sc1 lds
    buffer_load_dwordx4 v14, s[8:11], s31 offen offset:2048 sc1 lds
    s_add_u32 m0, s30, 69632
    s_add_u32 s31, s44, 4096
    buffer_load_dwordx4 v14, s[8:11], s31 offen sc1 lds
    buffer_load_dwordx4 v14, s[8:11], s31 offen offset:2048 sc1 lds
    s_add_u32 m0, s30, 73728
    s_add_u32 s31, s44, 8192
    buffer_load_dwordx4 v14, s[8:11], s31 offen sc1 lds
    s_add_u32 m0, s30, 75776
    s_add_u32 s31, s44, 10240
    buffer_load_dwordx4 v14, s[8:11], s31 offen sc1 lds
    buffer_load_dwordx4 v14, s[8:11], s31 offen offset:2048 sc1 lds
    s_add_u32 m0, s30, 79872
    s_add_u32 s31, s44, 14336
    buffer_load_dwordx4 v14, s[8:11], s31 offen sc1 lds
    buffer_load_dwordx4 v14, s[8:11], s31 offen offset:2048 sc1 lds
    s_add_u32 m0, s30, 83968
    s_add_u32 s31, s44, 18432
    buffer_load_dwordx4 v14, s[8:11], s31 offen sc1 lds
    s_add_u32 m0, s30, 86016
    s_add_u32 s31, s44, 20480
    buffer_load_dwordx4 v14, s[8:11], s31 offen sc1 lds
    buffer_load_dwordx4 v14, s[8:11], s31 offen offset:2048 sc1 lds
    s_add_u32 m0, s30, 90112
    s_add_u32 s31, s44, 24576
    buffer_load_dwordx4 v14, s[8:11], s31 offen sc1 lds
    buffer_load_dwordx4 v14, s[8:11], s31 offen offset:2048 sc1 lds
    s_add_u32 m0, s30, 94208
    s_add_u32 s31, s44, 28672
    buffer_load_dwordx4 v14, s[8:11], s31 offen sc1 lds
    s_add_u32 m0, s30, 96256
    s_add_u32 s31, s44, 30720
    buffer_load_dwordx4 v14, s[8:11], s31 offen sc1 lds
    buffer_load_dwordx4 v14, s[8:11], s31 offen offset:2048 sc1 lds
    s_add_u32 m0, s30, 100352
    s_add_u32 s31, s44, 34816
    buffer_load_dwordx4 v14, s[8:11], s31 offen sc1 lds
    buffer_load_dwordx4 v14, s[8:11], s31 offen offset:2048 sc1 lds
    s_add_u32 m0, s30, 104448
    s_add_u32 s31, s44, 38912
    buffer_load_dwordx4 v14, s[8:11], s31 offen sc1 lds
    s_waitcnt vmcnt(15)
    s_barrier
    s_add_u32 m0, s30, 106496
    s_add_u32 s31, s44, 40960
    buffer_load_dwordx4 v14, s[8:11], s31 offen sc1 lds
    buffer_load_dwordx4 v14, s[8:11], s31 offen offset:2048 sc1 lds
    s_add_u32 m0, s30, 110592
    s_add_u32 s31, s44, 45056
    buffer_load_dwordx4 v14, s[8:11], s31 offen sc1 lds
    buffer_load_dwordx4 v14, s[8:11], s31 offen offset:2048 sc1 lds
    s_add_u32 m0, s30, 114688
    s_add_u32 s31, s44, 49152
    buffer_load_dwordx4 v14, s[8:11], s31 offen sc1 lds
    s_waitcnt vmcnt(15)
    s_barrier
    s_add_u32 m0, s30, 116736
    s_add_u32 s31, s44, 51200
    buffer_load_dwordx4 v14, s[8:11], s31 offen sc1 lds
    buffer_load_dwordx4 v14, s[8:11], s31 offen offset:2048 sc1 lds
    s_add_u32 m0, s30, 120832
    s_add_u32 s31, s44, 55296
    buffer_load_dwordx4 v14, s[8:11], s31 offen sc1 lds
    buffer_load_dwordx4 v14, s[8:11], s31 offen offset:2048 sc1 lds
    s_add_u32 m0, s30, 124928
    s_add_u32 s31, s44, 59392
    buffer_load_dwordx4 v14, s[8:11], s31 offen sc1 lds
    s_add_u32 m0, s30, 126976
    s_add_u32 s31, s44, 61440
    buffer_load_dwordx4 v14, s[8:11], s31 offen sc1 lds
    buffer_load_dwordx4 v14, s[8:11], s31 offen offset:2048 sc1 lds
    s_add_u32 m0, s30, 131072
    s_add_u32 s31, s44, 65536
    buffer_load_dwordx4 v14, s[8:11], s31 offen sc1 lds
    buffer_load_dwordx4 v14, s[8:11], s31 offen offset:2048 sc1 lds
    s_add_u32 m0, s30, 135168
    s_add_u32 s31, s44, 69632
    buffer_load_dwordx4 v14, s[8:11], s31 offen sc1 lds
    s_waitcnt vmcnt(20)
    s_barrier
    s_add_u32 m0, s30, 137216
    s_add_u32 s31, s44, 71680
    buffer_load_dwordx4 v14, s[8:11], s31 offen sc1 lds
    buffer_load_dwordx4 v14, s[8:11], s31 offen offset:2048 sc1 lds
    s_add_u32 m0, s30, 141312
    s_add_u32 s31, s44, 75776
    buffer_load_dwordx4 v14, s[8:11], s31 offen sc1 lds
    buffer_load_dwordx4 v14, s[8:11], s31 offen offset:2048 sc1 lds
    s_add_u32 m0, s30, 145408
    s_add_u32 s31, s44, 79872
    buffer_load_dwordx4 v14, s[8:11], s31 offen sc1 lds
    s_add_u32 m0, s30, 65536
    s_add_u32 s31, s44, 81920
    buffer_load_dwordx4 v14, s[8:11], s31 offen sc1 lds
    buffer_load_dwordx4 v14, s[8:11], s31 offen offset:2048 sc1 lds
    s_add_u32 m0, s30, 69632
    s_add_u32 s31, s44, 86016
    buffer_load_dwordx4 v14, s[8:11], s31 offen sc1 lds
    buffer_load_dwordx4 v14, s[8:11], s31 offen offset:2048 sc1 lds
    s_add_u32 m0, s30, 73728
    s_add_u32 s31, s44, 90112
    buffer_load_dwordx4 v14, s[8:11], s31 offen sc1 lds
    s_waitcnt vmcnt(25)
    s_barrier
    s_add_u32 m0, s30, 75776
    s_add_u32 s31, s44, 92160
    buffer_load_dwordx4 v14, s[8:11], s31 offen sc1 lds
    buffer_load_dwordx4 v14, s[8:11], s31 offen offset:2048 sc1 lds
    s_add_u32 m0, s30, 79872
    s_add_u32 s31, s44, 96256
    buffer_load_dwordx4 v14, s[8:11], s31 offen sc1 lds
    buffer_load_dwordx4 v14, s[8:11], s31 offen offset:2048 sc1 lds
    s_add_u32 m0, s30, 83968
    s_add_u32 s31, s44, 100352
    buffer_load_dwordx4 v14, s[8:11], s31 offen sc1 lds
    s_waitcnt vmcnt(25)
    s_barrier
    s_add_u32 m0, s30, 86016
    s_add_u32 s31, s44, 102400
    buffer_load_dwordx4 v14, s[8:11], s31 offen sc1 lds
    buffer_load_dwordx4 v14, s[8:11], s31 offen offset:2048 sc1 lds
    s_add_u32 m0, s30, 90112
    s_add_u32 s31, s44, 106496
    buffer_load_dwordx4 v14, s[8:11], s31 offen sc1 lds
    buffer_load_dwordx4 v14, s[8:11], s31 offen offset:2048 sc1 lds
    s_add_u32 m0, s30, 94208
    s_add_u32 s31, s44, 110592
    buffer_load_dwordx4 v14, s[8:11], s31 offen sc1 lds
    buffer_load_dwordx4 v14, s[8:11], s31 offen offset:2048 sc1 lds
    s_waitcnt vmcnt(26)
    s_barrier
    s_add_u32 m0, s30, 98304
    s_add_u32 s31, s44, 114688
    buffer_load_dwordx4 v14, s[8:11], s31 offen sc1 lds
    buffer_load_dwordx4 v14, s[8:11], s31 offen offset:2048 sc1 lds
    s_add_u32 m0, s30, 102400
    s_add_u32 s31, s44, 118784
    buffer_load_dwordx4 v14, s[8:11], s31 offen sc1 lds
    buffer_load_dwordx4 v14, s[8:11], s31 offen offset:2048 sc1 lds
    s_add_u32 m0, s30, 106496
    s_add_u32 s31, s44, 122880
    buffer_load_dwordx4 v14, s[8:11], s31 offen sc1 lds
    buffer_load_dwordx4 v14, s[8:11], s31 offen offset:2048 sc1 lds
    s_waitcnt vmcnt(27)
    s_barrier
    s_add_u32 m0, s30, 110592
    s_add_u32 s31, s44, 126976
    buffer_load_dwordx4 v14, s[8:11], s31 offen sc1 lds
    buffer_load_dwordx4 v14, s[8:11], s31 offen offset:2048 sc1 lds
    s_add_u32 m0, s30, 114688
    s_add_u32 s31, s44, 131072
    buffer_load_dwordx4 v14, s[8:11], s31 offen sc1 lds
    buffer_load_dwordx4 v14, s[8:11], s31 offen offset:2048 sc1 lds
    s_add_u32 m0, s30, 118784
    s_add_u32 s31, s44, 135168
    buffer_load_dwordx4 v14, s[8:11], s31 offen sc1 lds
    buffer_load_dwordx4 v14, s[8:11], s31 offen offset:2048 sc1 lds
    s_waitcnt vmcnt(28)
    s_barrier
    s_add_u32 m0, s30, 122880
    s_add_u32 s31, s44, 139264
    buffer_load_dwordx4 v14, s[8:11], s31 offen sc1 lds
    buffer_load_dwordx4 v14, s[8:11], s31 offen offset:2048 sc1 lds
    s_add_u32 m0, s30, 126976
    s_add_u32 s31, s44, 143360
    buffer_load_dwordx4 v14, s[8:11], s31 offen sc1 lds
    buffer_load_dwordx4 v14, s[8:11], s31 offen offset:2048 sc1 lds
    s_add_u32 m0, s30, 131072
    s_add_u32 s31, s44, 147456
    buffer_load_dwordx4 v14, s[8:11], s31 offen sc1 lds
    buffer_load_dwordx4 v14, s[8:11], s31 offen offset:2048 sc1 lds
    s_waitcnt vmcnt(29)
    s_barrier
    s_add_u32 m0, s30, 135168
    s_add_u32 s31, s44, 151552
    buffer_load_dwordx4 v14, s[8:11], s31 offen sc1 lds
    buffer_load_dwordx4 v14, s[8:11], s31 offen offset:2048 sc1 lds
    s_add_u32 m0, s30, 139264
    s_add_u32 s31, s44, 155648
    buffer_load_dwordx4 v14, s[8:11], s31 offen sc1 lds
    buffer_load_dwordx4 v14, s[8:11], s31 offen offset:2048 sc1 lds
    s_add_u32 m0, s30, 143360
    s_add_u32 s31, s44, 159744
    buffer_load_dwordx4 v14, s[8:11], s31 offen sc1 lds
    buffer_load_dwordx4 v14, s[8:11], s31 offen offset:2048 sc1 lds
    s_add_u32 m0, s68, 0
    s_nop 0
    buffer_load_dwordx4 v101, s[52:55], s67 offen offset:0 nt lds
    s_add_u32 m0, s68, 896
    s_nop 0
    buffer_load_dwordx4 v101, s[52:55], s67 offen offset:128 nt lds
    s_add_u32 s67, s67, s66
    s_add_u32 m0, s68, 2048
    s_nop 0
    buffer_load_dwordx4 v101, s[52:55], s67 offen offset:0 nt lds
    s_add_u32 m0, s68, 2944
    s_nop 0
    buffer_load_dwordx4 v101, s[52:55], s67 offen offset:128 nt lds
    s_add_u32 s67, s67, s66
    s_add_u32 s67, s67, s70
    s_add_u32 m0, s68, 4096
    s_nop 0
    buffer_load_dwordx4 v101, s[52:55], s67 offen offset:0 nt lds
    s_add_u32 m0, s68, 4992
    s_nop 0
    buffer_load_dwordx4 v101, s[52:55], s67 offen offset:128 nt lds
    s_add_u32 s67, s67, s66
    s_add_u32 m0, s68, 6144
    s_nop 0
    buffer_load_dwordx4 v101, s[52:55], s67 offen offset:0 nt lds
    s_add_u32 m0, s68, 7040
    s_nop 0
    buffer_load_dwordx4 v101, s[52:55], s67 offen offset:128 nt lds
    s_add_u32 s67, s67, s66
    s_waitcnt vmcnt(38)
    s_barrier
    s_mul_i32 s20, s19, 524288
    s_add_u32 s20, s20, 29097984
    v_mov_b32 v67, 0x3f80
    s_sub_u32 s26, s16, 4
    s_lshl_b32 s27, s26, 9
    s_lshl_b32 s26, s26, 10
    s_lshl_b32 s21, s18, 15
    s_add_u32 s20, s20, s21
    s_add_u32 s20, s20, s27
    s_lshl_b32 s21, s17, 11
    s_add_u32 s21, s21, s20
    v_and_b32 v3, 63, v0
    v_lshlrev_b32 v3, 3, v3
    v_lshl_add_u32 v2, v3, 1, s26
    v_bfe_u32 v64, v0, 3, 1
    v_bfe_u32 v65, v0, 4, 1
    v_cmp_eq_u32 vcc, v65, v64
    v_and_b32 v66, 1, v0
    v_lshlrev_b32 v66, 4, v66
    v_lshlrev_b32 v66, v66, v67
    v_cndmask_b32 v66, 0, v66, vcc
    v_bfe_u32 v64, v0, 1, 2
    v_cmp_eq_u32 vcc, 0, v64
    s_nop 1
    v_cndmask_b32 v68, 0, v66, vcc
    v_cmp_eq_u32 vcc, 1, v64
    s_nop 1
    v_cndmask_b32 v69, 0, v66, vcc
    v_cmp_eq_u32 vcc, 2, v64
    s_nop 1
    v_cndmask_b32 v70, 0, v66, vcc
    v_cmp_eq_u32 vcc, 3, v64
    s_nop 1
    v_cndmask_b32 v71, 0, v66, vcc
    v_and_b32 v64, 31, v0
    v_lshlrev_b32 v64, 4, v64
    v_bfe_u32 v66, v0, 5, 1
    v_lshl_add_u32 v72, v66, 11, v64
    v_and_b32 v64, 15, v0
    v_lshl_add_u32 v64, v66, 4, v64
    v_lshl_add_u32 v64, v64, 1, v65
    v_lshl_add_u32 v5, v64, 3, s27
    v_add_u32 v5, 158208, v5
    s_lshl_b32 s25, s19, 14
    s_lshl_b32 s22, s26, 2
    s_add_u32 s25, s25, s22
    s_lshl_b32 s22, s18, 8
    s_add_u32 s25, s25, s22
    s_add_u32 s25, s25, 57344
    s_waitcnt vmcnt(8)
    s_barrier
main_kernel_ljoin:
    ds_read_b128 v[16:19], v2 offset:0
    ds_read_b128 v[20:23], v2 offset:4096
    ds_read_b128 v[24:27], v2 offset:8192
    ds_read_b128 v[28:31], v2 offset:12288
    s_waitcnt lgkmcnt(2)
    v_add_f32 v16, v16, v20
    v_add_f32 v17, v17, v21
    v_add_f32 v18, v18, v22
    v_add_f32 v19, v19, v23
    s_waitcnt lgkmcnt(0)
    v_add_f32 v24, v24, v28
    v_add_f32 v25, v25, v29
    v_add_f32 v26, v26, v30
    v_add_f32 v27, v27, v31
    v_add_f32 v16, v16, v24
    v_add_f32 v17, v17, v25
    v_add_f32 v18, v18, v26
    v_add_f32 v19, v19, v27
    v_cvt_pk_bf16_f32 v24, v16, v17
    v_cvt_pk_bf16_f32 v25, v18, v19
    v_min_u32 v24, -2, v24
    v_min_u32 v25, -2, v25
    buffer_store_dwordx2 v[24:25], v3, s[8:11], s21 offen sc1
    s_mov_b32 s72, 1
    s_atomic_add s72, s[4:5], s25
    s_waitcnt vmcnt(10)
    s_add_u32 m0, s30, 65536
    s_add_u32 s31, s45, 0
    buffer_load_dwordx4 v14, s[8:11], s31 offen sc1 lds
    buffer_load_dwordx4 v14, s[8:11], s31 offen offset:2048 sc1 lds
    s_waitcnt vmcnt(10)
    s_add_u32 m0, s30, 69632
    s_add_u32 s31, s45, 4096
    buffer_load_dwordx4 v14, s[8:11], s31 offen sc1 lds
    buffer_load_dwordx4 v14, s[8:11], s31 offen offset:2048 sc1 lds
    s_waitcnt vmcnt(10)
    s_add_u32 m0, s30, 73728
    s_add_u32 s31, s45, 8192
    buffer_load_dwordx4 v14, s[8:11], s31 offen sc1 lds
    buffer_load_dwordx4 v14, s[8:11], s31 offen offset:2048 sc1 lds
    s_waitcnt vmcnt(10)
    s_add_u32 m0, s30, 77824
    s_add_u32 s31, s45, 12288
    buffer_load_dwordx4 v14, s[8:11], s31 offen sc1 lds
    buffer_load_dwordx4 v14, s[8:11], s31 offen offset:2048 sc1 lds
    s_waitcnt vmcnt(10)
    s_add_u32 m0, s30, 81920
    s_add_u32 s31, s45, 16384
    buffer_load_dwordx4 v14, s[8:11], s31 offen sc1 lds
    buffer_load_dwordx4 v14, s[8:11], s31 offen offset:2048 sc1 lds
    s_cmp_lg_u32 s19, 0
    s_cbranch_scc1 cd_2001_e
    s_cmp_ge_u32 s2, 160
    s_cbranch_scc1 cd_2001_w2
    v_add_u32 v110, 0, v106
    v_lshrrev_b32 v112, 7, v110
    v_mul_u32_u24 v112, 896, v112
    v_add3_u32 v112, v112, v110, v104
    v_add_u32 v110, 64, v106
    v_lshrrev_b32 v113, 7, v110
    v_mul_u32_u24 v113, 896, v113
    v_add3_u32 v113, v113, v110, v104
    v_add_u32 v110, 128, v106
    v_lshrrev_b32 v114, 7, v110
    v_mul_u32_u24 v114, 896, v114
    v_add3_u32 v114, v114, v110, v104
    v_add_u32 v110, 32, v106
    v_lshrrev_b32 v115, 7, v110
    v_mul_u32_u24 v115, 896, v115
    v_add3_u32 v115, v115, v110, v104
    v_add_u32 v110, 96, v106
    v_lshrrev_b32 v116, 7, v110
    v_mul_u32_u24 v116, 896, v116
    v_add3_u32 v116, v116, v110, v104
    v_add_u32 v110, 160, v106
    v_lshrrev_b32 v117, 7, v110
    v_mul_u32_u24 v117, 896, v117
    v_add3_u32 v117, v117, v110, v104
    s_bfe_u32 s69, s2, 0x10002
    s_mul_i32 s70, s63, 20
    s_add_u32 s70, s70, s64
    s_mul_i32 s70, s70, 12
    s_add_u32 s70, s70, s69
    s_lshl_b32 s70, s70, 10
    s_add_u32 s70, s70, 33619968
    s_lshl_b32 s71, s64, 4
    s_add_u32 s71, s71, s63
    s_lshl_b32 s71, s71, 1
    s_add_u32 s71, s71, s69
    s_lshl_b32 s71, s71, 9
    s_add_u32 s71, s71, 39780352
    s_waitcnt vmcnt(0)
    ds_read_b64_tr_b16 v[128:129], v112
    ds_read_b64_tr_b16 v[130:131], v112 offset:512
    ds_read_b64_tr_b16 v[132:133], v113
    ds_read_b64_tr_b16 v[134:135], v113 offset:512
    ds_read_b64_tr_b16 v[136:137], v114
    ds_read_b64_tr_b16 v[138:139], v114 offset:512
    ds_read_b64_tr_b16 v[140:141], v115
    ds_read_b64_tr_b16 v[142:143], v115 offset:512
    ds_read_b64_tr_b16 v[144:145], v116
    ds_read_b64_tr_b16 v[146:147], v116 offset:512
    ds_read_b64_tr_b16 v[148:149], v117
    ds_read_b64_tr_b16 v[150:151], v117 offset:512
    s_waitcnt lgkmcnt(10)
    buffer_store_dwordx4 v[128:131], v108, s[8:11], s70 offen offset:0 sc1
    v_mfma_f32_16x16x32_bf16 v[160:163], v[128:131], v[76:79], 0
    s_waitcnt lgkmcnt(8)
    buffer_store_dwordx4 v[132:135], v108, s[8:11], s70 offen offset:2048 sc1
    v_mfma_f32_16x16x32_bf16 v[160:163], v[132:135], v[80:83], v[160:163]
    s_add_u32 s70, s70, 4096
    s_waitcnt lgkmcnt(6)
    buffer_store_dwordx4 v[136:139], v108, s[8:11], s70 offen offset:0 sc1
    v_mfma_f32_16x16x32_bf16 v[160:163], v[136:139], v[84:87], v[160:163]
    s_waitcnt lgkmcnt(4)
    buffer_store_dwordx4 v[140:143], v108, s[8:11], s70 offen offset:2048 sc1
    v_mfma_f32_16x16x32_bf16 v[160:163], v[140:143], v[88:91], v[160:163]
    s_add_u32 s70, s70, 4096
    s_waitcnt lgkmcnt(2)
    buffer_store_dwordx4 v[144:147], v108, s[8:11], s70 offen offset:0 sc1
    v_mfma_f32_16x16x32_bf16 v[160:163], v[144:147], v[92:95], v[160:163]
    s_waitcnt lgkmcnt(0)
    buffer_store_dwordx4 v[148:151], v108, s[8:11], s70 offen offset:2048 sc1
    v_mfma_f32_16x16x32_bf16 v[160:163], v[148:151], v[96:99], v[160:163]
    s_add_u32 s70, s70, 4096
    s_mov_b32 exec_lo, 0xff00ff
    s_mov_b32 exec_hi, 0xff00ff
    s_nop 4
    buffer_store_dwordx4 v[160:163], v109, s[8:11], s71 offen sc1
    s_mov_b64 exec, -1
    s_branch cd_2001_e
cd_2001_w2:
    v_add_u32 v110, 0, v107
    v_lshrrev_b32 v112, 7, v110
    v_mul_u32_u24 v112, 896, v112
    v_add3_u32 v112, v112, v110, v104
    v_add_u32 v110, 8, v107
    v_lshrrev_b32 v113, 7, v110
    v_mul_u32_u24 v113, 896, v113
    v_add3_u32 v113, v113, v110, v104
    v_add_u32 v110, 64, v107
    v_lshrrev_b32 v114, 7, v110
    v_mul_u32_u24 v114, 896, v114
    v_add3_u32 v114, v114, v110, v104
    v_add_u32 v110, 72, v107
    v_lshrrev_b32 v115, 7, v110
    v_mul_u32_u24 v115, 896, v115
    v_add3_u32 v115, v115, v110, v104
    v_add_u32 v110, 128, v106
    v_lshrrev_b32 v116, 7, v110
    v_mul_u32_u24 v116, 896, v116
    v_add3_u32 v116, v116, v110, v104
    s_mul_i32 s69, s64, 43691
    s_lshr_b32 s69, s69, 17
    s_mul_i32 s70, s69, 3
    s_sub_u32 s70, s64, s70
    s_sub_u32 s70, 2, s70
    s_lshl_b32 s70, s70, 4
    s_add_u32 s69, s69, s70
    s_mul_i32 s70, s63, 245760
    s_add_u32 s70, s70, 37552128
    s_lshl_b32 s71, s69, 10
    s_add_u32 s71, s71, s70
    s_lshl_b32 s69, s69, 12
    s_add_u32 s70, s70, s69
    s_add_u32 s70, s70, 49152
    s_waitcnt vmcnt(0)
    ds_read_b64_tr_b16 v[128:129], v112
    ds_read_b64_tr_b16 v[130:131], v112 offset:512
    ds_read_b64_tr_b16 v[132:133], v113
    ds_read_b64_tr_b16 v[134:135], v113 offset:512
    ds_read_b64_tr_b16 v[136:137], v114
    ds_read_b64_tr_b16 v[138:139], v114 offset:512
    ds_read_b64_tr_b16 v[140:141], v115
    ds_read_b64_tr_b16 v[142:143], v115 offset:512
    ds_read_b64_tr_b16 v[144:145], v116
    ds_read_b64_tr_b16 v[146:147], v116 offset:512
    s_waitcnt lgkmcnt(8)
    buffer_store_dwordx4 v[128:131], v108, s[8:11], s70 offen offset:0 sc1
    s_waitcnt lgkmcnt(6)
    buffer_store_dwordx4 v[132:135], v108, s[8:11], s70 offen offset:1024 sc1
    s_waitcnt lgkmcnt(4)
    buffer_store_dwordx4 v[136:139], v108, s[8:11], s70 offen offset:2048 sc1
    s_waitcnt lgkmcnt(2)
    buffer_store_dwordx4 v[140:143], v108, s[8:11], s70 offen offset:3072 sc1
    s_waitcnt lgkmcnt(0)
    buffer_store_dwordx4 v[144:147], v108, s[8:11], s71 offen sc1
cd_2001_e:
    s_mov_b32 s74, 300000
poll_2002:
    s_mov_b32 s75, 0
    s_atomic_add s75, s[4:5], s25 glc
    s_waitcnt lgkmcnt(0)
    s_cmp_ge_u32 s75, 16
    s_cbranch_scc1 poll_2002_x
    s_sub_u32 s74, s74, 1
    s_cmp_lg_u32 s74, 0
    s_cbranch_scc1 poll_2002
poll_2002_x:
    s_mov_b32 s24, 300000
kvp_2003:
    s_mov_b32 s22, s20
    buffer_load_dwordx4 v[32:35], v72, s[8:11], s22 offen sc1
    s_add_u32 s22, s22, 4096
    buffer_load_dwordx4 v[36:39], v72, s[8:11], s22 offen sc1
    s_add_u32 s22, s22, 4096
    buffer_load_dwordx4 v[40:43], v72, s[8:11], s22 offen sc1
    s_add_u32 s22, s22, 4096
    buffer_load_dwordx4 v[44:47], v72, s[8:11], s22 offen sc1
    s_add_u32 s22, s22, 4096
    buffer_load_dwordx4 v[48:51], v72, s[8:11], s22 offen sc1
    s_add_u32 s22, s22, 4096
    buffer_load_dwordx4 v[52:55], v72, s[8:11], s22 offen sc1
    s_add_u32 s22, s22, 4096
    buffer_load_dwordx4 v[56:59], v72, s[8:11], s22 offen sc1
    s_add_u32 s22, s22, 4096
    buffer_load_dwordx4 v[60:63], v72, s[8:11], s22 offen sc1
    s_add_u32 s22, s22, 4096
    v_mov_b32 v6, 0
    s_waitcnt vmcnt(7)
    v_mfma_f32_16x16x32_bf16 v[16:19], v[68:71], v[32:35], 0
    v_max3_u32 v6, v32, v33, v6
    v_max3_u32 v6, v34, v35, v6
    s_waitcnt vmcnt(6)
    v_mfma_f32_16x16x32_bf16 v[16:19], v[68:71], v[36:39], v[16:19]
    v_max3_u32 v6, v36, v37, v6
    v_max3_u32 v6, v38, v39, v6
    s_waitcnt vmcnt(5)
    v_mfma_f32_16x16x32_bf16 v[16:19], v[68:71], v[40:43], v[16:19]
    v_max3_u32 v6, v40, v41, v6
    v_max3_u32 v6, v42, v43, v6
    s_waitcnt vmcnt(4)
    v_mfma_f32_16x16x32_bf16 v[16:19], v[68:71], v[44:47], v[16:19]
    v_max3_u32 v6, v44, v45, v6
    v_max3_u32 v6, v46, v47, v6
    s_waitcnt vmcnt(3)
    v_mfma_f32_16x16x32_bf16 v[16:19], v[68:71], v[48:51], v[16:19]
    v_max3_u32 v6, v48, v49, v6
    v_max3_u32 v6, v50, v51, v6
    s_waitcnt vmcnt(2)
    v_mfma_f32_16x16x32_bf16 v[16:19], v[68:71], v[52:55], v[16:19]
    v_max3_u32 v6, v52, v53, v6
    v_max3_u32 v6, v54, v55, v6
    s_waitcnt vmcnt(1)
    v_mfma_f32_16x16x32_bf16 v[16:19], v[68:71], v[56:59], v[16:19]
    v_max3_u32 v6, v56, v57, v6
    v_max3_u32 v6, v58, v59, v6
    s_waitcnt vmcnt(0)
    v_mfma_f32_16x16x32_bf16 v[16:19], v[68:71], v[60:63], v[16:19]
    v_max3_u32 v6, v60, v61, v6
    v_max3_u32 v6, v62, v63, v6
    s_sub_u32 s24, s24, 1
    s_cmp_eq_u32 s24, 0
    s_cbranch_scc1 kvp_2003_x
    v_cmp_eq_u32 vcc, -1, v6
    s_cbranch_vccnz kvp_2003
kvp_2003_x:
    s_nop 1
    v_cvt_pk_bf16_f32 v24, v16, v17
    v_cvt_pk_bf16_f32 v25, v18, v19
    ds_write_b64 v5, v[24:25]
    s_waitcnt lgkmcnt(0)
    s_cmp_lg_u32 s19, 0
    s_cbranch_scc1 cp_2004
    s_cmp_ge_u32 s2, 160
    s_cselect_b32 s69, 16, 0
    s_add_u32 s69, s69, s63
    s_lshl_b32 s69, s69, 8
    s_add_u32 s69, s69, 90112
    s_waitcnt vmcnt(0)
    s_mov_b32 s72, 1
    s_atomic_add s72, s[4:5], s69
cp_2004:
    s_barrier
    s_barrier
    s_add_u32 m0, s30, 86016
    s_add_u32 s31, s45, 20480
    buffer_load_dwordx4 v14, s[8:11], s31 offen sc1 lds
    buffer_load_dwordx4 v14, s[8:11], s31 offen offset:2048 sc1 lds
    s_add_u32 m0, s30, 90112
    s_add_u32 s31, s45, 24576
    buffer_load_dwordx4 v14, s[8:11], s31 offen sc1 lds
    buffer_load_dwordx4 v14, s[8:11], s31 offen offset:2048 sc1 lds
    s_add_u32 m0, s30, 94208
    s_add_u32 s31, s45, 28672
    buffer_load_dwordx4 v14, s[8:11], s31 offen sc1 lds
    buffer_load_dwordx4 v14, s[8:11], s31 offen offset:2048 sc1 lds
    s_add_u32 m0, s30, 98304
    s_add_u32 s31, s45, 32768
    buffer_load_dwordx4 v14, s[8:11], s31 offen sc1 lds
    buffer_load_dwordx4 v14, s[8:11], s31 offen offset:2048 sc1 lds
    s_add_u32 m0, s30, 102400
    s_add_u32 s31, s45, 36864
    buffer_load_dwordx4 v14, s[8:11], s31 offen sc1 lds
    buffer_load_dwordx4 v14, s[8:11], s31 offen offset:2048 sc1 lds
    s_add_u32 m0, s30, 106496
    s_add_u32 s31, s45, 40960
    buffer_load_dwordx4 v14, s[8:11], s31 offen sc1 lds
    buffer_load_dwordx4 v14, s[8:11], s31 offen offset:2048 sc1 lds
    s_add_u32 m0, s30, 110592
    s_add_u32 s31, s45, 45056
    buffer_load_dwordx4 v14, s[8:11], s31 offen sc1 lds
    buffer_load_dwordx4 v14, s[8:11], s31 offen offset:2048 sc1 lds
    s_add_u32 m0, s30, 114688
    s_add_u32 s31, s45, 49152
    buffer_load_dwordx4 v14, s[8:11], s31 offen sc1 lds
    buffer_load_dwordx4 v14, s[8:11], s31 offen offset:2048 sc1 lds
    s_add_u32 m0, s30, 118784
    s_add_u32 s31, s45, 53248
    buffer_load_dwordx4 v14, s[8:11], s31 offen sc1 lds
    buffer_load_dwordx4 v14, s[8:11], s31 offen offset:2048 sc1 lds
    s_add_u32 m0, s30, 122880
    s_add_u32 s31, s45, 57344
    buffer_load_dwordx4 v14, s[8:11], s31 offen sc1 lds
    buffer_load_dwordx4 v14, s[8:11], s31 offen offset:2048 sc1 lds
    s_add_u32 m0, s30, 126976
    s_add_u32 s31, s45, 61440
    buffer_load_dwordx4 v14, s[8:11], s31 offen sc1 lds
    buffer_load_dwordx4 v14, s[8:11], s31 offen offset:2048 sc1 lds
    s_add_u32 m0, s30, 131072
    s_add_u32 s31, s45, 65536
    buffer_load_dwordx4 v14, s[8:11], s31 offen sc1 lds
    buffer_load_dwordx4 v14, s[8:11], s31 offen offset:2048 sc1 lds
    s_add_u32 m0, s30, 135168
    s_add_u32 s31, s45, 69632
    buffer_load_dwordx4 v14, s[8:11], s31 offen sc1 lds
    buffer_load_dwordx4 v14, s[8:11], s31 offen offset:2048 sc1 lds
    s_add_u32 m0, s30, 139264
    s_add_u32 s31, s45, 73728
    buffer_load_dwordx4 v14, s[8:11], s31 offen sc1 lds
    buffer_load_dwordx4 v14, s[8:11], s31 offen offset:2048 sc1 lds
    s_add_u32 m0, s30, 143360
    s_add_u32 s31, s45, 77824
    buffer_load_dwordx4 v14, s[8:11], s31 offen sc1 lds
    buffer_load_dwordx4 v14, s[8:11], s31 offen offset:2048 sc1 lds
    s_waitcnt vmcnt(20)
    s_barrier
    s_add_u32 m0, s30, 0
    s_add_u32 s31, s41, 0
    buffer_load_dwordx4 v14, s[8:11], s31 offen sc1 lds
    buffer_load_dwordx4 v14, s[8:11], s31 offen offset:2048 sc1 lds
    s_add_u32 m0, s30, 4096
    s_add_u32 s31, s41, 8192
    buffer_load_dwordx4 v14, s[8:11], s31 offen sc1 lds
    buffer_load_dwordx4 v14, s[8:11], s31 offen offset:2048 sc1 lds
    s_add_u32 m0, s30, 8192
    s_add_u32 s31, s41, 16384
    buffer_load_dwordx4 v14, s[8:11], s31 offen sc1 lds
    buffer_load_dwordx4 v14, s[8:11], s31 offen offset:2048 sc1 lds
    s_add_u32 m0, s30, 12288
    s_add_u32 s31, s41, 24576
    buffer_load_dwordx4 v14, s[8:11], s31 offen sc1 lds
    buffer_load_dwordx4 v14, s[8:11], s31 offen offset:2048 sc1 lds
    s_add_u32 m0, s30, 16384
    s_add_u32 s31, s41, 32768
    buffer_load_dwordx4 v14, s[8:11], s31 offen sc1 lds
    buffer_load_dwordx4 v14, s[8:11], s31 offen offset:2048 sc1 lds
    s_add_u32 m0, s30, 20480
    s_add_u32 s31, s41, 40960
    buffer_load_dwordx4 v14, s[8:11], s31 offen sc1 lds
    buffer_load_dwordx4 v14, s[8:11], s31 offen offset:2048 sc1 lds
    s_add_u32 m0, s30, 24576
    s_add_u32 s31, s41, 49152
    buffer_load_dwordx4 v14, s[8:11], s31 offen sc1 lds
    buffer_load_dwordx4 v14, s[8:11], s31 offen offset:2048 sc1 lds
    s_add_u32 m0, s30, 28672
    s_add_u32 s31, s41, 57344
    buffer_load_dwordx4 v14, s[8:11], s31 offen sc1 lds
    buffer_load_dwordx4 v14, s[8:11], s31 offen offset:2048 sc1 lds
    s_add_u32 m0, s30, 32768
    s_add_u32 s31, s41, 65536
    buffer_load_dwordx4 v14, s[8:11], s31 offen sc1 lds
    buffer_load_dwordx4 v14, s[8:11], s31 offen offset:2048 sc1 lds
    s_add_u32 m0, s30, 36864
    s_add_u32 s31, s41, 73728
    buffer_load_dwordx4 v14, s[8:11], s31 offen sc1 lds
    buffer_load_dwordx4 v14, s[8:11], s31 offen offset:2048 sc1 lds
    s_add_u32 m0, s30, 40960
    s_add_u32 s31, s41, 81920
    buffer_load_dwordx4 v14, s[8:11], s31 offen sc1 lds
    buffer_load_dwordx4 v14, s[8:11], s31 offen offset:2048 sc1 lds
    s_add_u32 m0, s30, 45056
    s_add_u32 s31, s41, 90112
    buffer_load_dwordx4 v14, s[8:11], s31 offen sc1 lds
    buffer_load_dwordx4 v14, s[8:11], s31 offen offset:2048 sc1 lds
    s_waitcnt vmcnt(16)
    s_barrier
    s_add_u32 m0, s30, 49152
    s_add_u32 s31, s41, 98304
    buffer_load_dwordx4 v14, s[8:11], s31 offen sc1 lds
    buffer_load_dwordx4 v14, s[8:11], s31 offen offset:2048 sc1 lds
    s_add_u32 m0, s30, 53248
    s_add_u32 s31, s41, 106496
    buffer_load_dwordx4 v14, s[8:11], s31 offen sc1 lds
    buffer_load_dwordx4 v14, s[8:11], s31 offen offset:2048 sc1 lds
    s_add_u32 m0, s30, 57344
    s_add_u32 s31, s41, 114688
    buffer_load_dwordx4 v14, s[8:11], s31 offen sc1 lds
    buffer_load_dwordx4 v14, s[8:11], s31 offen offset:2048 sc1 lds
    s_add_u32 m0, s30, 61440
    s_add_u32 s31, s41, 122880
    buffer_load_dwordx4 v14, s[8:11], s31 offen sc1 lds
    buffer_load_dwordx4 v14, s[8:11], s31 offen offset:2048 sc1 lds
    s_waitcnt vmcnt(16)
    s_barrier
    s_add_u32 m0, s30, 0
    s_add_u32 s31, s41, 131072
    buffer_load_dwordx4 v14, s[8:11], s31 offen sc1 lds
    buffer_load_dwordx4 v14, s[8:11], s31 offen offset:2048 sc1 lds
    s_add_u32 m0, s30, 4096
    s_add_u32 s31, s41, 139264
    buffer_load_dwordx4 v14, s[8:11], s31 offen sc1 lds
    buffer_load_dwordx4 v14, s[8:11], s31 offen offset:2048 sc1 lds
    s_add_u32 m0, s30, 8192
    s_add_u32 s31, s41, 147456
    buffer_load_dwordx4 v14, s[8:11], s31 offen sc1 lds
    buffer_load_dwordx4 v14, s[8:11], s31 offen offset:2048 sc1 lds
    s_add_u32 m0, s30, 12288
    s_add_u32 s31, s41, 155648
    buffer_load_dwordx4 v14, s[8:11], s31 offen sc1 lds
    buffer_load_dwordx4 v14, s[8:11], s31 offen offset:2048 sc1 lds
    s_waitcnt vmcnt(16)
    s_barrier
    s_add_u32 m0, s30, 65536
    s_add_u32 s31, s45, 81920
    buffer_load_dwordx4 v14, s[8:11], s31 offen sc1 lds
    buffer_load_dwordx4 v14, s[8:11], s31 offen offset:2048 sc1 lds
    s_add_u32 m0, s30, 69632
    s_add_u32 s31, s45, 86016
    buffer_load_dwordx4 v14, s[8:11], s31 offen sc1 lds
    buffer_load_dwordx4 v14, s[8:11], s31 offen offset:2048 sc1 lds
    s_add_u32 m0, s30, 73728
    s_add_u32 s31, s45, 90112
    buffer_load_dwordx4 v14, s[8:11], s31 offen sc1 lds
    buffer_load_dwordx4 v14, s[8:11], s31 offen offset:2048 sc1 lds
    s_add_u32 m0, s30, 77824
    s_add_u32 s31, s45, 94208
    buffer_load_dwordx4 v14, s[8:11], s31 offen sc1 lds
    buffer_load_dwordx4 v14, s[8:11], s31 offen offset:2048 sc1 lds
    s_add_u32 m0, s30, 81920
    s_add_u32 s31, s45, 98304
    buffer_load_dwordx4 v14, s[8:11], s31 offen sc1 lds
    buffer_load_dwordx4 v14, s[8:11], s31 offen offset:2048 sc1 lds
    s_waitcnt vmcnt(18)
    s_barrier
    s_waitcnt vmcnt(10)
    s_barrier
    s_waitcnt vmcnt(0)
    s_barrier
    s_add_u32 m0, s30, 90112
    s_add_u32 s31, s46, 0
    buffer_load_dwordx4 v14, s[8:11], s31 offen sc1 lds
    buffer_load_dwordx4 v14, s[8:11], s31 offen offset:2048 sc1 lds
    s_add_u32 m0, s30, 94208
    s_add_u32 s31, s46, 4096
    buffer_load_dwordx4 v14, s[8:11], s31 offen sc1 lds
    buffer_load_dwordx4 v14, s[8:11], s31 offen offset:2048 sc1 lds
    s_add_u32 m0, s30, 98304
    s_add_u32 s31, s46, 8192
    buffer_load_dwordx4 v14, s[8:11], s31 offen sc1 lds
    buffer_load_dwordx4 v14, s[8:11], s31 offen offset:2048 sc1 lds
    s_add_u32 m0, s30, 102400
    s_add_u32 s31, s46, 12288
    buffer_load_dwordx4 v14, s[8:11], s31 offen sc1 lds
    buffer_load_dwordx4 v14, s[8:11], s31 offen offset:2048 sc1 lds
    s_add_u32 m0, s30, 106496
    s_add_u32 s31, s46, 16384
    buffer_load_dwordx4 v14, s[8:11], s31 offen sc1 lds
    buffer_load_dwordx4 v14, s[8:11], s31 offen offset:2048 sc1 lds
    s_add_u32 m0, s30, 110592
    s_add_u32 s31, s46, 20480
    buffer_load_dwordx4 v14, s[8:11], s31 offen sc1 lds
    buffer_load_dwordx4 v14, s[8:11], s31 offen offset:2048 sc1 lds
    s_add_u32 m0, s30, 114688
    s_add_u32 s31, s46, 24576
    buffer_load_dwordx4 v14, s[8:11], s31 offen sc1 lds
    buffer_load_dwordx4 v14, s[8:11], s31 offen offset:2048 sc1 lds
    s_add_u32 m0, s30, 118784
    s_add_u32 s31, s46, 28672
    buffer_load_dwordx4 v14, s[8:11], s31 offen sc1 lds
    buffer_load_dwordx4 v14, s[8:11], s31 offen offset:2048 sc1 lds
    s_add_u32 m0, s30, 122880
    s_add_u32 s31, s46, 32768
    buffer_load_dwordx4 v14, s[8:11], s31 offen sc1 lds
    buffer_load_dwordx4 v14, s[8:11], s31 offen offset:2048 sc1 lds
    s_add_u32 m0, s30, 126976
    s_add_u32 s31, s46, 36864
    buffer_load_dwordx4 v14, s[8:11], s31 offen sc1 lds
    buffer_load_dwordx4 v14, s[8:11], s31 offen offset:2048 sc1 lds
    s_add_u32 m0, s30, 131072
    s_add_u32 s31, s46, 40960
    buffer_load_dwordx4 v14, s[8:11], s31 offen sc1 lds
    buffer_load_dwordx4 v14, s[8:11], s31 offen offset:2048 sc1 lds
    s_add_u32 m0, s30, 135168
    s_add_u32 s31, s46, 45056
    buffer_load_dwordx4 v14, s[8:11], s31 offen sc1 lds
    buffer_load_dwordx4 v14, s[8:11], s31 offen offset:2048 sc1 lds
    s_barrier
    s_add_u32 m0, s30, 0
    s_add_u32 s31, s42, 0
    buffer_load_dwordx4 v14, s[8:11], s31 offen sc1 lds
    buffer_load_dwordx4 v14, s[8:11], s31 offen offset:2048 sc1 lds
    s_add_u32 m0, s30, 4096
    s_add_u32 s31, s42, 4096
    buffer_load_dwordx4 v14, s[8:11], s31 offen sc1 lds
    buffer_load_dwordx4 v14, s[8:11], s31 offen offset:2048 sc1 lds
    s_add_u32 m0, s30, 8192
    s_add_u32 s31, s42, 8192
    buffer_load_dwordx4 v14, s[8:11], s31 offen sc1 lds
    buffer_load_dwordx4 v14, s[8:11], s31 offen offset:2048 sc1 lds
    s_add_u32 m0, s30, 12288
    s_add_u32 s31, s42, 12288
    buffer_load_dwordx4 v14, s[8:11], s31 offen sc1 lds
    buffer_load_dwordx4 v14, s[8:11], s31 offen offset:2048 sc1 lds
    s_add_u32 m0, s30, 16384
    s_add_u32 s31, s42, 16384
    buffer_load_dwordx4 v14, s[8:11], s31 offen sc1 lds
    buffer_load_dwordx4 v14, s[8:11], s31 offen offset:2048 sc1 lds
    s_add_u32 m0, s30, 20480
    s_add_u32 s31, s42, 20480
    buffer_load_dwordx4 v14, s[8:11], s31 offen sc1 lds
    buffer_load_dwordx4 v14, s[8:11], s31 offen offset:2048 sc1 lds
    s_add_u32 m0, s30, 24576
    s_add_u32 s31, s42, 24576
    buffer_load_dwordx4 v14, s[8:11], s31 offen sc1 lds
    buffer_load_dwordx4 v14, s[8:11], s31 offen offset:2048 sc1 lds
    s_add_u32 m0, s30, 28672
    s_add_u32 s31, s42, 28672
    buffer_load_dwordx4 v14, s[8:11], s31 offen sc1 lds
    buffer_load_dwordx4 v14, s[8:11], s31 offen offset:2048 sc1 lds
    s_add_u32 m0, s30, 65536
    s_add_u32 s31, s46, 49152
    buffer_load_dwordx4 v14, s[8:11], s31 offen sc1 lds
    buffer_load_dwordx4 v14, s[8:11], s31 offen offset:2048 sc1 lds
    s_add_u32 m0, s30, 69632
    s_add_u32 s31, s46, 53248
    buffer_load_dwordx4 v14, s[8:11], s31 offen sc1 lds
    buffer_load_dwordx4 v14, s[8:11], s31 offen offset:2048 sc1 lds
    s_add_u32 m0, s30, 73728
    s_add_u32 s31, s46, 57344
    buffer_load_dwordx4 v14, s[8:11], s31 offen sc1 lds
    buffer_load_dwordx4 v14, s[8:11], s31 offen offset:2048 sc1 lds
    s_add_u32 m0, s30, 77824
    s_add_u32 s31, s46, 61440
    buffer_load_dwordx4 v14, s[8:11], s31 offen sc1 lds
    buffer_load_dwordx4 v14, s[8:11], s31 offen offset:2048 sc1 lds
    s_add_u32 m0, s30, 81920
    s_add_u32 s31, s46, 65536
    buffer_load_dwordx4 v14, s[8:11], s31 offen sc1 lds
    buffer_load_dwordx4 v14, s[8:11], s31 offen offset:2048 sc1 lds
    s_add_u32 m0, s30, 86016
    s_add_u32 s31, s46, 69632
    buffer_load_dwordx4 v14, s[8:11], s31 offen sc1 lds
    buffer_load_dwordx4 v14, s[8:11], s31 offen offset:2048 sc1 lds
    s_waitcnt vmcnt(20)
    s_barrier
    s_add_u32 m0, s30, 32768
    s_add_u32 s31, s42, 32768
    buffer_load_dwordx4 v14, s[8:11], s31 offen sc1 lds
    buffer_load_dwordx4 v14, s[8:11], s31 offen offset:2048 sc1 lds
    s_add_u32 m0, s30, 36864
    s_add_u32 s31, s42, 36864
    buffer_load_dwordx4 v14, s[8:11], s31 offen sc1 lds
    buffer_load_dwordx4 v14, s[8:11], s31 offen offset:2048 sc1 lds
    s_add_u32 m0, s30, 40960
    s_add_u32 s31, s42, 40960
    buffer_load_dwordx4 v14, s[8:11], s31 offen sc1 lds
    buffer_load_dwordx4 v14, s[8:11], s31 offen offset:2048 sc1 lds
    s_add_u32 m0, s30, 45056
    s_add_u32 s31, s42, 45056
    buffer_load_dwordx4 v14, s[8:11], s31 offen sc1 lds
    buffer_load_dwordx4 v14, s[8:11], s31 offen offset:2048 sc1 lds
    s_waitcnt vmcnt(20)
    s_barrier
    s_add_u32 m0, s30, 49152
    s_add_u32 s31, s42, 49152
    buffer_load_dwordx4 v14, s[8:11], s31 offen sc1 lds
    buffer_load_dwordx4 v14, s[8:11], s31 offen offset:2048 sc1 lds
    s_add_u32 m0, s30, 53248
    s_add_u32 s31, s42, 53248
    buffer_load_dwordx4 v14, s[8:11], s31 offen sc1 lds
    buffer_load_dwordx4 v14, s[8:11], s31 offen offset:2048 sc1 lds
    s_add_u32 m0, s30, 57344
    s_add_u32 s31, s42, 57344
    buffer_load_dwordx4 v14, s[8:11], s31 offen sc1 lds
    buffer_load_dwordx4 v14, s[8:11], s31 offen offset:2048 sc1 lds
    s_add_u32 m0, s30, 61440
    s_add_u32 s31, s42, 61440
    buffer_load_dwordx4 v14, s[8:11], s31 offen sc1 lds
    buffer_load_dwordx4 v14, s[8:11], s31 offen offset:2048 sc1 lds
    s_add_u32 m0, s30, 90112
    s_add_u32 s31, s46, 73728
    buffer_load_dwordx4 v14, s[8:11], s31 offen sc1 lds
    buffer_load_dwordx4 v14, s[8:11], s31 offen offset:2048 sc1 lds
    s_add_u32 m0, s30, 94208
    s_add_u32 s31, s46, 77824
    buffer_load_dwordx4 v14, s[8:11], s31 offen sc1 lds
    buffer_load_dwordx4 v14, s[8:11], s31 offen offset:2048 sc1 lds
    s_add_u32 m0, s30, 98304
    s_add_u32 s31, s46, 81920
    buffer_load_dwordx4 v14, s[8:11], s31 offen sc1 lds
    buffer_load_dwordx4 v14, s[8:11], s31 offen offset:2048 sc1 lds
    s_add_u32 m0, s30, 102400
    s_add_u32 s31, s46, 86016
    buffer_load_dwordx4 v14, s[8:11], s31 offen sc1 lds
    buffer_load_dwordx4 v14, s[8:11], s31 offen offset:2048 sc1 lds
    s_add_u32 m0, s30, 106496
    s_add_u32 s31, s46, 90112
    buffer_load_dwordx4 v14, s[8:11], s31 offen sc1 lds
    buffer_load_dwordx4 v14, s[8:11], s31 offen offset:2048 sc1 lds
    s_add_u32 m0, s30, 110592
    s_add_u32 s31, s46, 94208
    buffer_load_dwordx4 v14, s[8:11], s31 offen sc1 lds
    buffer_load_dwordx4 v14, s[8:11], s31 offen offset:2048 sc1 lds
    s_waitcnt vmcnt(20)
    s_barrier
    s_add_u32 m0, s30, 0
    s_add_u32 s31, s42, 65536
    buffer_load_dwordx4 v14, s[8:11], s31 offen sc1 lds
    buffer_load_dwordx4 v14, s[8:11], s31 offen offset:2048 sc1 lds
    s_add_u32 m0, s30, 4096
    s_add_u32 s31, s42, 69632
    buffer_load_dwordx4 v14, s[8:11], s31 offen sc1 lds
    buffer_load_dwordx4 v14, s[8:11], s31 offen offset:2048 sc1 lds
    s_add_u32 m0, s30, 8192
    s_add_u32 s31, s42, 73728
    buffer_load_dwordx4 v14, s[8:11], s31 offen sc1 lds
    buffer_load_dwordx4 v14, s[8:11], s31 offen offset:2048 sc1 lds
    s_add_u32 m0, s30, 12288
    s_add_u32 s31, s42, 77824
    buffer_load_dwordx4 v14, s[8:11], s31 offen sc1 lds
    buffer_load_dwordx4 v14, s[8:11], s31 offen offset:2048 sc1 lds
    s_add_u32 m0, s30, 114688
    s_add_u32 s31, s46, 98304
    buffer_load_dwordx4 v14, s[8:11], s31 offen sc1 lds
    buffer_load_dwordx4 v14, s[8:11], s31 offen offset:2048 sc1 lds
    s_add_u32 m0, s30, 118784
    s_add_u32 s31, s46, 102400
    buffer_load_dwordx4 v14, s[8:11], s31 offen sc1 lds
    buffer_load_dwordx4 v14, s[8:11], s31 offen offset:2048 sc1 lds
    s_add_u32 m0, s30, 122880
    s_add_u32 s31, s46, 106496
    buffer_load_dwordx4 v14, s[8:11], s31 offen sc1 lds
    buffer_load_dwordx4 v14, s[8:11], s31 offen offset:2048 sc1 lds
    s_add_u32 m0, s30, 126976
    s_add_u32 s31, s46, 110592
    buffer_load_dwordx4 v14, s[8:11], s31 offen sc1 lds
    buffer_load_dwordx4 v14, s[8:11], s31 offen offset:2048 sc1 lds
    s_add_u32 m0, s30, 131072
    s_add_u32 s31, s46, 114688
    buffer_load_dwordx4 v14, s[8:11], s31 offen sc1 lds
    buffer_load_dwordx4 v14, s[8:11], s31 offen offset:2048 sc1 lds
    s_add_u32 m0, s30, 135168
    s_add_u32 s31, s46, 118784
    buffer_load_dwordx4 v14, s[8:11], s31 offen sc1 lds
    buffer_load_dwordx4 v14, s[8:11], s31 offen offset:2048 sc1 lds
    s_waitcnt vmcnt(20)
    s_barrier
    s_add_u32 m0, s30, 16384
    s_add_u32 s31, s42, 81920
    buffer_load_dwordx4 v14, s[8:11], s31 offen sc1 lds
    buffer_load_dwordx4 v14, s[8:11], s31 offen offset:2048 sc1 lds
    s_add_u32 m0, s30, 20480
    s_add_u32 s31, s42, 86016
    buffer_load_dwordx4 v14, s[8:11], s31 offen sc1 lds
    buffer_load_dwordx4 v14, s[8:11], s31 offen offset:2048 sc1 lds
    s_add_u32 m0, s30, 24576
    s_add_u32 s31, s42, 90112
    buffer_load_dwordx4 v14, s[8:11], s31 offen sc1 lds
    buffer_load_dwordx4 v14, s[8:11], s31 offen offset:2048 sc1 lds
    s_add_u32 m0, s30, 28672
    s_add_u32 s31, s42, 94208
    buffer_load_dwordx4 v14, s[8:11], s31 offen sc1 lds
    buffer_load_dwordx4 v14, s[8:11], s31 offen offset:2048 sc1 lds
    s_add_u32 m0, s30, 65536
    s_add_u32 s31, s46, 122880
    buffer_load_dwordx4 v14, s[8:11], s31 offen sc1 lds
    buffer_load_dwordx4 v14, s[8:11], s31 offen offset:2048 sc1 lds
    s_add_u32 m0, s30, 69632
    s_add_u32 s31, s46, 126976
    buffer_load_dwordx4 v14, s[8:11], s31 offen sc1 lds
    buffer_load_dwordx4 v14, s[8:11], s31 offen offset:2048 sc1 lds
    s_add_u32 m0, s30, 73728
    s_add_u32 s31, s46, 131072
    buffer_load_dwordx4 v14, s[8:11], s31 offen sc1 lds
    buffer_load_dwordx4 v14, s[8:11], s31 offen offset:2048 sc1 lds
    s_add_u32 m0, s30, 77824
    s_add_u32 s31, s46, 135168
    buffer_load_dwordx4 v14, s[8:11], s31 offen sc1 lds
    buffer_load_dwordx4 v14, s[8:11], s31 offen offset:2048 sc1 lds
    s_add_u32 m0, s30, 81920
    s_add_u32 s31, s46, 139264
    buffer_load_dwordx4 v14, s[8:11], s31 offen sc1 lds
    buffer_load_dwordx4 v14, s[8:11], s31 offen offset:2048 sc1 lds
    s_add_u32 m0, s30, 86016
    s_add_u32 s31, s46, 143360
    buffer_load_dwordx4 v14, s[8:11], s31 offen sc1 lds
    buffer_load_dwordx4 v14, s[8:11], s31 offen offset:2048 sc1 lds
    s_waitcnt vmcnt(20)
    s_barrier
    s_add_u32 m0, s30, 32768
    s_add_u32 s31, s42, 98304
    buffer_load_dwordx4 v14, s[8:11], s31 offen sc1 lds
    buffer_load_dwordx4 v14, s[8:11], s31 offen offset:2048 sc1 lds
    s_add_u32 m0, s30, 36864
    s_add_u32 s31, s42, 102400
    buffer_load_dwordx4 v14, s[8:11], s31 offen sc1 lds
    buffer_load_dwordx4 v14, s[8:11], s31 offen offset:2048 sc1 lds
    s_add_u32 m0, s30, 40960
    s_add_u32 s31, s42, 106496
    buffer_load_dwordx4 v14, s[8:11], s31 offen sc1 lds
    buffer_load_dwordx4 v14, s[8:11], s31 offen offset:2048 sc1 lds
    s_add_u32 m0, s30, 45056
    s_add_u32 s31, s42, 110592
    buffer_load_dwordx4 v14, s[8:11], s31 offen sc1 lds
    buffer_load_dwordx4 v14, s[8:11], s31 offen offset:2048 sc1 lds
    s_add_u32 m0, s30, 90112
    s_add_u32 s31, s46, 151552
    buffer_load_dwordx4 v14, s[8:11], s31 offen sc1 lds
    s_add_u32 m0, s30, 92160
    s_add_u32 s31, s46, 163840
    buffer_load_dwordx4 v14, s[8:11], s31 offen sc1 lds
    s_add_u32 m0, s30, 94208
    s_add_u32 s31, s46, 176128
    buffer_load_dwordx4 v14, s[8:11], s31 offen sc1 lds
    s_add_u32 m0, s30, 96256
    s_add_u32 s31, s46, 157696
    buffer_load_dwordx4 v14, s[8:11], s31 offen sc1 lds
    s_add_u32 m0, s30, 98304
    s_add_u32 s31, s46, 169984
    buffer_load_dwordx4 v14, s[8:11], s31 offen sc1 lds
    s_add_u32 m0, s30, 100352
    s_add_u32 s31, s46, 182272
    buffer_load_dwordx4 v14, s[8:11], s31 offen sc1 lds
    s_add_u32 m0, s30, 102400
    s_add_u32 s31, s46, 188416
    buffer_load_dwordx4 v14, s[8:11], s31 offen sc1 lds
    s_add_u32 m0, s30, 104448
    s_add_u32 s31, s46, 200704
    buffer_load_dwordx4 v14, s[8:11], s31 offen sc1 lds
    s_add_u32 m0, s30, 106496
    s_add_u32 s31, s46, 212992
    buffer_load_dwordx4 v14, s[8:11], s31 offen sc1 lds
    s_add_u32 m0, s30, 108544
    s_add_u32 s31, s46, 194560
    buffer_load_dwordx4 v14, s[8:11], s31 offen sc1 lds
    s_add_u32 m0, s30, 110592
    s_add_u32 s31, s46, 206848
    buffer_load_dwordx4 v14, s[8:11], s31 offen sc1 lds
    s_add_u32 m0, s30, 112640
    s_add_u32 s31, s46, 219136
    buffer_load_dwordx4 v14, s[8:11], s31 offen sc1 lds
    s_waitcnt vmcnt(20)
    s_barrier
    s_add_u32 m0, s30, 49152
    s_add_u32 s31, s42, 114688
    buffer_load_dwordx4 v14, s[8:11], s31 offen sc1 lds
    buffer_load_dwordx4 v14, s[8:11], s31 offen offset:2048 sc1 lds
    s_add_u32 m0, s30, 53248
    s_add_u32 s31, s42, 118784
    buffer_load_dwordx4 v14, s[8:11], s31 offen sc1 lds
    buffer_load_dwordx4 v14, s[8:11], s31 offen offset:2048 sc1 lds
    s_add_u32 m0, s30, 57344
    s_add_u32 s31, s42, 122880
    buffer_load_dwordx4 v14, s[8:11], s31 offen sc1 lds
    buffer_load_dwordx4 v14, s[8:11], s31 offen offset:2048 sc1 lds
    s_add_u32 m0, s30, 61440
    s_add_u32 s31, s42, 126976
    buffer_load_dwordx4 v14, s[8:11], s31 offen sc1 lds
    buffer_load_dwordx4 v14, s[8:11], s31 offen offset:2048 sc1 lds
    s_add_u32 m0, s30, 114688
    s_add_u32 s31, s46, 225280
    buffer_load_dwordx4 v14, s[8:11], s31 offen sc1 lds
    s_add_u32 m0, s30, 116736
    s_add_u32 s31, s46, 237568
    buffer_load_dwordx4 v14, s[8:11], s31 offen sc1 lds
    s_add_u32 m0, s30, 118784
    s_add_u32 s31, s46, 223232
    buffer_load_dwordx4 v14, s[8:11], s31 offen sc1 lds
    s_add_u32 m0, s30, 120832
    s_add_u32 s31, s46, 231424
    buffer_load_dwordx4 v14, s[8:11], s31 offen sc1 lds
    s_add_u32 m0, s30, 122880
    s_add_u32 s31, s46, 243712
    buffer_load_dwordx4 v14, s[8:11], s31 offen sc1 lds
    s_add_u32 m0, s30, 124928
    s_add_u32 s31, s46, 229376
    buffer_load_dwordx4 v14, s[8:11], s31 offen sc1 lds
    s_add_u32 m0, s30, 126976
    s_add_u32 s31, s46, 235520
    buffer_load_dwordx4 v14, s[8:11], s31 offen sc1 lds
    s_add_u32 m0, s30, 129024
    s_add_u32 s31, s46, 198656
    buffer_load_dwordx4 v14, s[8:11], s31 offen sc1 lds
    s_add_u32 m0, s30, 131072
    s_add_u32 s31, s46, 210944
    buffer_load_dwordx4 v14, s[8:11], s31 offen sc1 lds
    s_add_u32 m0, s30, 133120
    s_add_u32 s31, s46, 241664
    buffer_load_dwordx4 v14, s[8:11], s31 offen sc1 lds
    s_add_u32 m0, s30, 135168
    s_add_u32 s31, s46, 204800
    buffer_load_dwordx4 v14, s[8:11], s31 offen sc1 lds
    s_add_u32 m0, s30, 137216
    s_add_u32 s31, s46, 217088
    buffer_load_dwordx4 v14, s[8:11], s31 offen sc1 lds
    s_waitcnt vmcnt(20)
    s_barrier
    s_add_u32 m0, s30, 0
    s_add_u32 s31, s42, 131072
    buffer_load_dwordx4 v14, s[8:11], s31 offen sc1 lds
    buffer_load_dwordx4 v14, s[8:11], s31 offen offset:2048 sc1 lds
    s_add_u32 m0, s30, 4096
    s_add_u32 s31, s42, 135168
    buffer_load_dwordx4 v14, s[8:11], s31 offen sc1 lds
    buffer_load_dwordx4 v14, s[8:11], s31 offen offset:2048 sc1 lds
    s_add_u32 m0, s30, 8192
    s_add_u32 s31, s42, 139264
    buffer_load_dwordx4 v14, s[8:11], s31 offen sc1 lds
    buffer_load_dwordx4 v14, s[8:11], s31 offen offset:2048 sc1 lds
    s_add_u32 m0, s30, 12288
    s_add_u32 s31, s42, 143360
    buffer_load_dwordx4 v14, s[8:11], s31 offen sc1 lds
    buffer_load_dwordx4 v14, s[8:11], s31 offen offset:2048 sc1 lds
    s_waitcnt vmcnt(20)
    s_barrier
    s_add_u32 m0, s30, 16384
    s_add_u32 s31, s42, 147456
    buffer_load_dwordx4 v14, s[8:11], s31 offen sc1 lds
    buffer_load_dwordx4 v14, s[8:11], s31 offen offset:2048 sc1 lds
    s_add_u32 m0, s30, 20480
    s_add_u32 s31, s42, 151552
    buffer_load_dwordx4 v14, s[8:11], s31 offen sc1 lds
    buffer_load_dwordx4 v14, s[8:11], s31 offen offset:2048 sc1 lds
    s_add_u32 m0, s30, 24576
    s_add_u32 s31, s42, 155648
    buffer_load_dwordx4 v14, s[8:11], s31 offen sc1 lds
    buffer_load_dwordx4 v14, s[8:11], s31 offen offset:2048 sc1 lds
    s_add_u32 m0, s30, 28672
    s_add_u32 s31, s42, 159744
    buffer_load_dwordx4 v14, s[8:11], s31 offen sc1 lds
    buffer_load_dwordx4 v14, s[8:11], s31 offen offset:2048 sc1 lds
    s_add_u32 m0, s30, 65536
    s_add_u32 s31, s46, 174080
    buffer_load_dwordx4 v14, s[8:11], s31 offen sc1 lds
    s_add_u32 m0, s30, 67584
    s_add_u32 s31, s46, 186368
    buffer_load_dwordx4 v14, s[8:11], s31 offen sc1 lds
    s_add_u32 m0, s30, 69632
    s_add_u32 s31, s46, 149504
    buffer_load_dwordx4 v14, s[8:11], s31 offen sc1 lds
    s_add_u32 m0, s30, 71680
    s_add_u32 s31, s46, 180224
    buffer_load_dwordx4 v14, s[8:11], s31 offen sc1 lds
    s_add_u32 m0, s30, 73728
    s_add_u32 s31, s46, 192512
    buffer_load_dwordx4 v14, s[8:11], s31 offen sc1 lds
    s_add_u32 m0, s30, 75776
    s_add_u32 s31, s46, 155648
    buffer_load_dwordx4 v14, s[8:11], s31 offen sc1 lds
    s_add_u32 m0, s30, 77824
    s_add_u32 s31, s46, 161792
    buffer_load_dwordx4 v14, s[8:11], s31 offen sc1 lds
    s_add_u32 m0, s30, 79872
    s_add_u32 s31, s46, 147456
    buffer_load_dwordx4 v14, s[8:11], s31 offen sc1 lds
    s_add_u32 m0, s30, 81920
    s_add_u32 s31, s46, 159744
    buffer_load_dwordx4 v14, s[8:11], s31 offen sc1 lds
    s_add_u32 m0, s30, 83968
    s_add_u32 s31, s46, 167936
    buffer_load_dwordx4 v14, s[8:11], s31 offen sc1 lds
    s_add_u32 m0, s30, 86016
    s_add_u32 s31, s46, 153600
    buffer_load_dwordx4 v14, s[8:11], s31 offen sc1 lds
    s_add_u32 m0, s30, 88064
    s_add_u32 s31, s46, 165888
    buffer_load_dwordx4 v14, s[8:11], s31 offen sc1 lds
    s_waitcnt vmcnt(20)
    s_barrier
    s_waitcnt vmcnt(12)
    s_barrier
    s_add_u32 m0, s30, 90112
    s_add_u32 s31, s46, 172032
    buffer_load_dwordx4 v14, s[8:11], s31 offen sc1 lds
    s_add_u32 m0, s30, 92160
    s_add_u32 s31, s46, 184320
    buffer_load_dwordx4 v14, s[8:11], s31 offen sc1 lds
    s_add_u32 m0, s30, 94208
    s_add_u32 s31, s46, 196608
    buffer_load_dwordx4 v14, s[8:11], s31 offen sc1 lds
    s_add_u32 m0, s30, 96256
    s_add_u32 s31, s46, 178176
    buffer_load_dwordx4 v14, s[8:11], s31 offen sc1 lds
    s_add_u32 m0, s30, 98304
    s_add_u32 s31, s46, 190464
    buffer_load_dwordx4 v14, s[8:11], s31 offen sc1 lds
    s_add_u32 m0, s30, 100352
    s_add_u32 s31, s46, 202752
    buffer_load_dwordx4 v14, s[8:11], s31 offen sc1 lds
    s_add_u32 m0, s30, 102400
    s_add_u32 s31, s46, 208896
    buffer_load_dwordx4 v14, s[8:11], s31 offen sc1 lds
    s_add_u32 m0, s30, 104448
    s_add_u32 s31, s46, 221184
    buffer_load_dwordx4 v14, s[8:11], s31 offen sc1 lds
    s_add_u32 m0, s30, 106496
    s_add_u32 s31, s46, 233472
    buffer_load_dwordx4 v14, s[8:11], s31 offen sc1 lds
    s_add_u32 m0, s30, 108544
    s_add_u32 s31, s46, 215040
    buffer_load_dwordx4 v14, s[8:11], s31 offen sc1 lds
    s_add_u32 m0, s30, 110592
    s_add_u32 s31, s46, 227328
    buffer_load_dwordx4 v14, s[8:11], s31 offen sc1 lds
    s_add_u32 m0, s30, 112640
    s_add_u32 s31, s46, 239616
    buffer_load_dwordx4 v14, s[8:11], s31 offen sc1 lds
    s_call_b64 s[38:39], sub_p4a
    s_call_b64 s[38:39], sub_p4r0
    s_waitcnt vmcnt(12)
    s_barrier
    s_add_u32 m0, s30, 114688
    s_add_u32 s31, s47, 0
    buffer_load_dwordx4 v14, s[8:11], s31 offen sc1 lds
    buffer_load_dwordx4 v14, s[8:11], s31 offen offset:2048 sc1 lds
    s_add_u32 m0, s30, 118784
    s_add_u32 s31, s47, 4096
    buffer_load_dwordx4 v14, s[8:11], s31 offen sc1 lds
    buffer_load_dwordx4 v14, s[8:11], s31 offen offset:2048 sc1 lds
    s_add_u32 m0, s30, 122880
    s_add_u32 s31, s47, 8192
    buffer_load_dwordx4 v14, s[8:11], s31 offen sc1 lds
    s_add_u32 m0, s30, 124928
    s_add_u32 s31, s47, 10240
    buffer_load_dwordx4 v14, s[8:11], s31 offen sc1 lds
    buffer_load_dwordx4 v14, s[8:11], s31 offen offset:2048 sc1 lds
    s_add_u32 m0, s30, 129024
    s_add_u32 s31, s47, 14336
    buffer_load_dwordx4 v14, s[8:11], s31 offen sc1 lds
    buffer_load_dwordx4 v14, s[8:11], s31 offen offset:2048 sc1 lds
    s_add_u32 m0, s30, 133120
    s_add_u32 s31, s47, 18432
    buffer_load_dwordx4 v14, s[8:11], s31 offen sc1 lds
    s_call_b64 s[38:39], sub_p4r1
    s_waitcnt vmcnt(10)
    s_barrier
    s_add_u32 m0, s30, 135168
    s_add_u32 s31, s47, 20480
    buffer_load_dwordx4 v14, s[8:11], s31 offen sc1 lds
    buffer_load_dwordx4 v14, s[8:11], s31 offen offset:2048 sc1 lds
    s_add_u32 m0, s30, 139264
    s_add_u32 s31, s47, 24576
    buffer_load_dwordx4 v14, s[8:11], s31 offen sc1 lds
    buffer_load_dwordx4 v14, s[8:11], s31 offen offset:2048 sc1 lds
    s_add_u32 m0, s30, 143360
    s_add_u32 s31, s47, 28672
    buffer_load_dwordx4 v14, s[8:11], s31 offen sc1 lds
    s_add_u32 m0, s30, 145408
    s_add_u32 s31, s47, 30720
    buffer_load_dwordx4 v14, s[8:11], s31 offen sc1 lds
    buffer_load_dwordx4 v14, s[8:11], s31 offen offset:2048 sc1 lds
    s_add_u32 m0, s30, 149504
    s_add_u32 s31, s47, 34816
    buffer_load_dwordx4 v14, s[8:11], s31 offen sc1 lds
    buffer_load_dwordx4 v14, s[8:11], s31 offen offset:2048 sc1 lds
    s_add_u32 m0, s30, 153600
    s_add_u32 s31, s47, 38912
    buffer_load_dwordx4 v14, s[8:11], s31 offen sc1 lds
    s_call_b64 s[38:39], sub_p4r2
    s_call_b64 s[38:39], sub_p4r3
    s_barrier
    s_add_u32 m0, s30, 32768
    s_add_u32 s31, s43, 0
    buffer_load_dwordx4 v14, s[8:11], s31 offen sc1 lds
    buffer_load_dwordx4 v14, s[8:11], s31 offen offset:2048 sc1 lds
    s_add_u32 m0, s30, 36864
    s_add_u32 s31, s43, 8192
    buffer_load_dwordx4 v14, s[8:11], s31 offen sc1 lds
    buffer_load_dwordx4 v14, s[8:11], s31 offen offset:2048 sc1 lds
    s_add_u32 m0, s30, 40960
    s_add_u32 s31, s43, 16384
    buffer_load_dwordx4 v14, s[8:11], s31 offen sc1 lds
    buffer_load_dwordx4 v14, s[8:11], s31 offen offset:2048 sc1 lds
    s_add_u32 m0, s30, 45056
    s_add_u32 s31, s43, 24576
    buffer_load_dwordx4 v14, s[8:11], s31 offen sc1 lds
    buffer_load_dwordx4 v14, s[8:11], s31 offen offset:2048 sc1 lds
    s_add_u32 m0, s30, 49152
    s_add_u32 s31, s43, 32768
    buffer_load_dwordx4 v14, s[8:11], s31 offen sc1 lds
    buffer_load_dwordx4 v14, s[8:11], s31 offen offset:2048 sc1 lds
    s_add_u32 m0, s30, 53248
    s_add_u32 s31, s43, 40960
    buffer_load_dwordx4 v14, s[8:11], s31 offen sc1 lds
    buffer_load_dwordx4 v14, s[8:11], s31 offen offset:2048 sc1 lds
    s_add_u32 m0, s30, 57344
    s_add_u32 s31, s43, 49152
    buffer_load_dwordx4 v14, s[8:11], s31 offen sc1 lds
    buffer_load_dwordx4 v14, s[8:11], s31 offen offset:2048 sc1 lds
    s_add_u32 m0, s30, 61440
    s_add_u32 s31, s43, 57344
    buffer_load_dwordx4 v14, s[8:11], s31 offen sc1 lds
    buffer_load_dwordx4 v14, s[8:11], s31 offen offset:2048 sc1 lds
    s_barrier
    s_add_u32 m0, s30, 0
    s_add_u32 s31, s43, 65536
    buffer_load_dwordx4 v14, s[8:11], s31 offen sc1 lds
    buffer_load_dwordx4 v14, s[8:11], s31 offen offset:2048 sc1 lds
    s_add_u32 m0, s30, 4096
    s_add_u32 s31, s43, 73728
    buffer_load_dwordx4 v14, s[8:11], s31 offen sc1 lds
    buffer_load_dwordx4 v14, s[8:11], s31 offen offset:2048 sc1 lds
    s_add_u32 m0, s30, 8192
    s_add_u32 s31, s43, 81920
    buffer_load_dwordx4 v14, s[8:11], s31 offen sc1 lds
    buffer_load_dwordx4 v14, s[8:11], s31 offen offset:2048 sc1 lds
    s_add_u32 m0, s30, 12288
    s_add_u32 s31, s43, 90112
    buffer_load_dwordx4 v14, s[8:11], s31 offen sc1 lds
    buffer_load_dwordx4 v14, s[8:11], s31 offen offset:2048 sc1 lds
    s_barrier
    s_add_u32 m0, s30, 16384
    s_add_u32 s31, s43, 98304
    buffer_load_dwordx4 v14, s[8:11], s31 offen sc1 lds
    buffer_load_dwordx4 v14, s[8:11], s31 offen offset:2048 sc1 lds
    s_add_u32 m0, s30, 20480
    s_add_u32 s31, s43, 106496
    buffer_load_dwordx4 v14, s[8:11], s31 offen sc1 lds
    buffer_load_dwordx4 v14, s[8:11], s31 offen offset:2048 sc1 lds
    s_add_u32 m0, s30, 24576
    s_add_u32 s31, s43, 114688
    buffer_load_dwordx4 v14, s[8:11], s31 offen sc1 lds
    buffer_load_dwordx4 v14, s[8:11], s31 offen offset:2048 sc1 lds
    s_add_u32 m0, s30, 28672
    s_add_u32 s31, s43, 122880
    buffer_load_dwordx4 v14, s[8:11], s31 offen sc1 lds
    buffer_load_dwordx4 v14, s[8:11], s31 offen offset:2048 sc1 lds
    s_waitcnt vmcnt(16)
    s_call_b64 s[48:49], y_p4
    s_cmp_lg_u32 s19, 0
    s_cbranch_scc1 main_kernel_end
    s_mov_b32 s19, 1
    s_mul_i32 s34, s17, 163840
    s_and_b32 s35, s18, 1
    s_lshl_b32 s35, s35, 12
    s_mul_i32 s40, s19, 2621440
    s_add_u32 s40, s40, 131072
    s_add_u32 s40, s40, s34
    s_mul_i32 s41, s19, 2621440
    s_add_u32 s41, s41, 5373952
    s_add_u32 s41, s41, s34
    s_add_u32 s41, s41, s35
    s_mul_i32 s42, s19, 2621440
    s_add_u32 s42, s42, 10616832
    s_add_u32 s42, s42, s34
    s_mul_i32 s43, s19, 6291456
    s_add_u32 s43, s43, 15859712
    s_mul_i32 s34, s17, 393216
    s_add_u32 s43, s43, s34
    s_add_u32 s43, s43, s35
    s_add_u32 m0, s30, 65536
    s_add_u32 s31, s44, 0
    buffer_load_dwordx4 v14, s[8:11], s31 offen sc1 lds
    buffer_load_dwordx4 v14, s[8:11], s31 offen offset:2048 sc1 lds
    s_add_u32 m0, s30, 69632
    s_add_u32 s31, s44, 4096
    buffer_load_dwordx4 v14, s[8:11], s31 offen sc1 lds
    buffer_load_dwordx4 v14, s[8:11], s31 offen offset:2048 sc1 lds
    s_add_u32 m0, s30, 73728
    s_add_u32 s31, s44, 8192
    buffer_load_dwordx4 v14, s[8:11], s31 offen sc1 lds
    s_add_u32 m0, s30, 75776
    s_add_u32 s31, s44, 10240
    buffer_load_dwordx4 v14, s[8:11], s31 offen sc1 lds
    buffer_load_dwordx4 v14, s[8:11], s31 offen offset:2048 sc1 lds
    s_add_u32 m0, s30, 79872
    s_add_u32 s31, s44, 14336
    buffer_load_dwordx4 v14, s[8:11], s31 offen sc1 lds
    buffer_load_dwordx4 v14, s[8:11], s31 offen offset:2048 sc1 lds
    s_add_u32 m0, s30, 83968
    s_add_u32 s31, s44, 18432
    buffer_load_dwordx4 v14, s[8:11], s31 offen sc1 lds
    s_add_u32 m0, s30, 86016
    s_add_u32 s31, s44, 20480
    buffer_load_dwordx4 v14, s[8:11], s31 offen sc1 lds
    buffer_load_dwordx4 v14, s[8:11], s31 offen offset:2048 sc1 lds
    s_add_u32 m0, s30, 90112
    s_add_u32 s31, s44, 24576
    buffer_load_dwordx4 v14, s[8:11], s31 offen sc1 lds
    buffer_load_dwordx4 v14, s[8:11], s31 offen offset:2048 sc1 lds
    s_add_u32 m0, s30, 94208
    s_add_u32 s31, s44, 28672
    buffer_load_dwordx4 v14, s[8:11], s31 offen sc1 lds
    s_add_u32 m0, s30, 96256
    s_add_u32 s31, s44, 30720
    buffer_load_dwordx4 v14, s[8:11], s31 offen sc1 lds
    buffer_load_dwordx4 v14, s[8:11], s31 offen offset:2048 sc1 lds
    s_add_u32 m0, s30, 100352
    s_add_u32 s31, s44, 34816
    buffer_load_dwordx4 v14, s[8:11], s31 offen sc1 lds
    buffer_load_dwordx4 v14, s[8:11], s31 offen offset:2048 sc1 lds
    s_add_u32 m0, s30, 104448
    s_add_u32 s31, s44, 38912
    buffer_load_dwordx4 v14, s[8:11], s31 offen sc1 lds
    s_add_u32 m0, s30, 106496
    s_add_u32 s31, s44, 40960
    buffer_load_dwordx4 v14, s[8:11], s31 offen sc1 lds
    buffer_load_dwordx4 v14, s[8:11], s31 offen offset:2048 sc1 lds
    s_add_u32 m0, s30, 110592
    s_add_u32 s31, s44, 45056
    buffer_load_dwordx4 v14, s[8:11], s31 offen sc1 lds
    buffer_load_dwordx4 v14, s[8:11], s31 offen offset:2048 sc1 lds
    s_add_u32 m0, s30, 114688
    s_add_u32 s31, s44, 49152
    buffer_load_dwordx4 v14, s[8:11], s31 offen sc1 lds
    s_add_u32 m0, s30, 116736
    s_add_u32 s31, s44, 51200
    buffer_load_dwordx4 v14, s[8:11], s31 offen sc1 lds
    buffer_load_dwordx4 v14, s[8:11], s31 offen offset:2048 sc1 lds
    s_add_u32 m0, s30, 120832
    s_add_u32 s31, s44, 55296
    buffer_load_dwordx4 v14, s[8:11], s31 offen sc1 lds
    buffer_load_dwordx4 v14, s[8:11], s31 offen offset:2048 sc1 lds
    s_add_u32 m0, s30, 124928
    s_add_u32 s31, s44, 59392
    buffer_load_dwordx4 v14, s[8:11], s31 offen sc1 lds
    s_add_u32 m0, s30, 126976
    s_add_u32 s31, s44, 61440
    buffer_load_dwordx4 v14, s[8:11], s31 offen sc1 lds
    buffer_load_dwordx4 v14, s[8:11], s31 offen offset:2048 sc1 lds
    s_add_u32 m0, s30, 131072
    s_add_u32 s31, s44, 65536
    buffer_load_dwordx4 v14, s[8:11], s31 offen sc1 lds
    buffer_load_dwordx4 v14, s[8:11], s31 offen offset:2048 sc1 lds
    s_add_u32 m0, s30, 135168
    s_add_u32 s31, s44, 69632
    buffer_load_dwordx4 v14, s[8:11], s31 offen sc1 lds
    s_add_u32 m0, s30, 137216
    s_add_u32 s31, s44, 71680
    buffer_load_dwordx4 v14, s[8:11], s31 offen sc1 lds
    buffer_load_dwordx4 v14, s[8:11], s31 offen offset:2048 sc1 lds
    s_add_u32 m0, s30, 141312
    s_add_u32 s31, s44, 75776
    buffer_load_dwordx4 v14, s[8:11], s31 offen sc1 lds
    buffer_load_dwordx4 v14, s[8:11], s31 offen offset:2048 sc1 lds
    s_add_u32 m0, s30, 145408
    s_add_u32 s31, s44, 79872
    buffer_load_dwordx4 v14, s[8:11], s31 offen sc1 lds
    s_barrier
    s_add_u32 m0, s30, 0
    s_add_u32 s31, s40, 0
    buffer_load_dwordx4 v14, s[8:11], s31 offen sc1 lds
    buffer_load_dwordx4 v14, s[8:11], s31 offen offset:2048 sc1 lds
    s_add_u32 m0, s30, 4096
    s_add_u32 s31, s40, 4096
    buffer_load_dwordx4 v14, s[8:11], s31 offen sc1 lds
    buffer_load_dwordx4 v14, s[8:11], s31 offen offset:2048 sc1 lds
    s_add_u32 m0, s30, 8192
    s_add_u32 s31, s40, 8192
    buffer_load_dwordx4 v14, s[8:11], s31 offen sc1 lds
    buffer_load_dwordx4 v14, s[8:11], s31 offen offset:2048 sc1 lds
    s_add_u32 m0, s30, 12288
    s_add_u32 s31, s40, 12288
    buffer_load_dwordx4 v14, s[8:11], s31 offen sc1 lds
    buffer_load_dwordx4 v14, s[8:11], s31 offen offset:2048 sc1 lds
    s_add_u32 m0, s30, 16384
    s_add_u32 s31, s40, 16384
    buffer_load_dwordx4 v14, s[8:11], s31 offen sc1 lds
    buffer_load_dwordx4 v14, s[8:11], s31 offen offset:2048 sc1 lds
    s_add_u32 m0, s30, 20480
    s_add_u32 s31, s40, 20480
    buffer_load_dwordx4 v14, s[8:11], s31 offen sc1 lds
    buffer_load_dwordx4 v14, s[8:11], s31 offen offset:2048 sc1 lds
    s_add_u32 m0, s30, 24576
    s_add_u32 s31, s40, 24576
    buffer_load_dwordx4 v14, s[8:11], s31 offen sc1 lds
    buffer_load_dwordx4 v14, s[8:11], s31 offen offset:2048 sc1 lds
    s_add_u32 m0, s30, 28672
    s_add_u32 s31, s40, 28672
    buffer_load_dwordx4 v14, s[8:11], s31 offen sc1 lds
    buffer_load_dwordx4 v14, s[8:11], s31 offen offset:2048 sc1 lds
    s_add_u32 m0, s30, 32768
    s_add_u32 s31, s40, 32768
    buffer_load_dwordx4 v14, s[8:11], s31 offen sc1 lds
    buffer_load_dwordx4 v14, s[8:11], s31 offen offset:2048 sc1 lds
    s_add_u32 m0, s30, 36864
    s_add_u32 s31, s40, 36864
    buffer_load_dwordx4 v14, s[8:11], s31 offen sc1 lds
    buffer_load_dwordx4 v14, s[8:11], s31 offen offset:2048 sc1 lds
    s_add_u32 m0, s30, 40960
    s_add_u32 s31, s40, 40960
    buffer_load_dwordx4 v14, s[8:11], s31 offen sc1 lds
    buffer_load_dwordx4 v14, s[8:11], s31 offen offset:2048 sc1 lds
    s_add_u32 m0, s30, 45056
    s_add_u32 s31, s40, 45056
    buffer_load_dwordx4 v14, s[8:11], s31 offen sc1 lds
    buffer_load_dwordx4 v14, s[8:11], s31 offen offset:2048 sc1 lds
    s_waitcnt vmcnt(16)
    s_barrier
    s_add_u32 m0, s30, 49152
    s_add_u32 s31, s40, 49152
    buffer_load_dwordx4 v14, s[8:11], s31 offen sc1 lds
    buffer_load_dwordx4 v14, s[8:11], s31 offen offset:2048 sc1 lds
    s_add_u32 m0, s30, 53248
    s_add_u32 s31, s40, 53248
    buffer_load_dwordx4 v14, s[8:11], s31 offen sc1 lds
    buffer_load_dwordx4 v14, s[8:11], s31 offen offset:2048 sc1 lds
    s_add_u32 m0, s30, 57344
    s_add_u32 s31, s40, 57344
    buffer_load_dwordx4 v14, s[8:11], s31 offen sc1 lds
    buffer_load_dwordx4 v14, s[8:11], s31 offen offset:2048 sc1 lds
    s_add_u32 m0, s30, 61440
    s_add_u32 s31, s40, 61440
    buffer_load_dwordx4 v14, s[8:11], s31 offen sc1 lds
    buffer_load_dwordx4 v14, s[8:11], s31 offen offset:2048 sc1 lds
    s_waitcnt vmcnt(16)
    s_barrier
    s_add_u32 m0, s30, 0
    s_add_u32 s31, s40, 65536
    buffer_load_dwordx4 v14, s[8:11], s31 offen sc1 lds
    buffer_load_dwordx4 v14, s[8:11], s31 offen offset:2048 sc1 lds
    s_add_u32 m0, s30, 4096
    s_add_u32 s31, s40, 69632
    buffer_load_dwordx4 v14, s[8:11], s31 offen sc1 lds
    buffer_load_dwordx4 v14, s[8:11], s31 offen offset:2048 sc1 lds
    s_add_u32 m0, s30, 8192
    s_add_u32 s31, s40, 73728
    buffer_load_dwordx4 v14, s[8:11], s31 offen sc1 lds
    buffer_load_dwordx4 v14, s[8:11], s31 offen offset:2048 sc1 lds
    s_add_u32 m0, s30, 12288
    s_add_u32 s31, s40, 77824
    buffer_load_dwordx4 v14, s[8:11], s31 offen sc1 lds
    buffer_load_dwordx4 v14, s[8:11], s31 offen offset:2048 sc1 lds
    s_add_u32 m0, s30, 65536
    s_add_u32 s31, s44, 81920
    buffer_load_dwordx4 v14, s[8:11], s31 offen sc1 lds
    buffer_load_dwordx4 v14, s[8:11], s31 offen offset:2048 sc1 lds
    s_add_u32 m0, s30, 69632
    s_add_u32 s31, s44, 86016
    buffer_load_dwordx4 v14, s[8:11], s31 offen sc1 lds
    buffer_load_dwordx4 v14, s[8:11], s31 offen offset:2048 sc1 lds
    s_add_u32 m0, s30, 73728
    s_add_u32 s31, s44, 90112
    buffer_load_dwordx4 v14, s[8:11], s31 offen sc1 lds
    s_waitcnt vmcnt(21)
    s_barrier
    s_add_u32 m0, s30, 16384
    s_add_u32 s31, s40, 81920
    buffer_load_dwordx4 v14, s[8:11], s31 offen sc1 lds
    buffer_load_dwordx4 v14, s[8:11], s31 offen offset:2048 sc1 lds
    s_add_u32 m0, s30, 20480
    s_add_u32 s31, s40, 86016
    buffer_load_dwordx4 v14, s[8:11], s31 offen sc1 lds
    buffer_load_dwordx4 v14, s[8:11], s31 offen offset:2048 sc1 lds
    s_add_u32 m0, s30, 24576
    s_add_u32 s31, s40, 90112
    buffer_load_dwordx4 v14, s[8:11], s31 offen sc1 lds
    buffer_load_dwordx4 v14, s[8:11], s31 offen offset:2048 sc1 lds
    s_add_u32 m0, s30, 28672
    s_add_u32 s31, s40, 94208
    buffer_load_dwordx4 v14, s[8:11], s31 offen sc1 lds
    buffer_load_dwordx4 v14, s[8:11], s31 offen offset:2048 sc1 lds
    s_waitcnt vmcnt(21)
    s_barrier
    s_add_u32 m0, s30, 32768
    s_add_u32 s31, s40, 98304
    buffer_load_dwordx4 v14, s[8:11], s31 offen sc1 lds
    buffer_load_dwordx4 v14, s[8:11], s31 offen offset:2048 sc1 lds
    s_add_u32 m0, s30, 36864
    s_add_u32 s31, s40, 102400
    buffer_load_dwordx4 v14, s[8:11], s31 offen sc1 lds
    buffer_load_dwordx4 v14, s[8:11], s31 offen offset:2048 sc1 lds
    s_add_u32 m0, s30, 40960
    s_add_u32 s31, s40, 106496
    buffer_load_dwordx4 v14, s[8:11], s31 offen sc1 lds
    buffer_load_dwordx4 v14, s[8:11], s31 offen offset:2048 sc1 lds
    s_add_u32 m0, s30, 45056
    s_add_u32 s31, s40, 110592
    buffer_load_dwordx4 v14, s[8:11], s31 offen sc1 lds
    buffer_load_dwordx4 v14, s[8:11], s31 offen offset:2048 sc1 lds
    s_add_u32 m0, s30, 75776
    s_add_u32 s31, s44, 92160
    buffer_load_dwordx4 v14, s[8:11], s31 offen sc1 lds
    buffer_load_dwordx4 v14, s[8:11], s31 offen offset:2048 sc1 lds
    s_add_u32 m0, s30, 79872
    s_add_u32 s31, s44, 96256
    buffer_load_dwordx4 v14, s[8:11], s31 offen sc1 lds
    buffer_load_dwordx4 v14, s[8:11], s31 offen offset:2048 sc1 lds
    s_add_u32 m0, s30, 83968
    s_add_u32 s31, s44, 100352
    buffer_load_dwordx4 v14, s[8:11], s31 offen sc1 lds
    s_waitcnt vmcnt(26)
    s_barrier
    s_add_u32 m0, s30, 49152
    s_add_u32 s31, s40, 114688
    buffer_load_dwordx4 v14, s[8:11], s31 offen sc1 lds
    buffer_load_dwordx4 v14, s[8:11], s31 offen offset:2048 sc1 lds
    s_add_u32 m0, s30, 53248
    s_add_u32 s31, s40, 118784
    buffer_load_dwordx4 v14, s[8:11], s31 offen sc1 lds
    buffer_load_dwordx4 v14, s[8:11], s31 offen offset:2048 sc1 lds
    s_add_u32 m0, s30, 57344
    s_add_u32 s31, s40, 122880
    buffer_load_dwordx4 v14, s[8:11], s31 offen sc1 lds
    buffer_load_dwordx4 v14, s[8:11], s31 offen offset:2048 sc1 lds
    s_add_u32 m0, s30, 61440
    s_add_u32 s31, s40, 126976
    buffer_load_dwordx4 v14, s[8:11], s31 offen sc1 lds
    buffer_load_dwordx4 v14, s[8:11], s31 offen offset:2048 sc1 lds
    s_waitcnt vmcnt(21)
    s_barrier
    s_add_u32 m0, s30, 0
    s_add_u32 s31, s40, 131072
    buffer_load_dwordx4 v14, s[8:11], s31 offen sc1 lds
    buffer_load_dwordx4 v14, s[8:11], s31 offen offset:2048 sc1 lds
    s_add_u32 m0, s30, 4096
    s_add_u32 s31, s40, 135168
    buffer_load_dwordx4 v14, s[8:11], s31 offen sc1 lds
    buffer_load_dwordx4 v14, s[8:11], s31 offen offset:2048 sc1 lds
    s_add_u32 m0, s30, 8192
    s_add_u32 s31, s40, 139264
    buffer_load_dwordx4 v14, s[8:11], s31 offen sc1 lds
    buffer_load_dwordx4 v14, s[8:11], s31 offen offset:2048 sc1 lds
    s_add_u32 m0, s30, 12288
    s_add_u32 s31, s40, 143360
    buffer_load_dwordx4 v14, s[8:11], s31 offen sc1 lds
    buffer_load_dwordx4 v14, s[8:11], s31 offen offset:2048 sc1 lds
    s_waitcnt vmcnt(21)
    s_barrier
    s_add_u32 m0, s30, 16384
    s_add_u32 s31, s40, 147456
    buffer_load_dwordx4 v14, s[8:11], s31 offen sc1 lds
    buffer_load_dwordx4 v14, s[8:11], s31 offen offset:2048 sc1 lds
    s_add_u32 m0, s30, 20480
    s_add_u32 s31, s40, 151552
    buffer_load_dwordx4 v14, s[8:11], s31 offen sc1 lds
    buffer_load_dwordx4 v14, s[8:11], s31 offen offset:2048 sc1 lds
    s_add_u32 m0, s30, 24576
    s_add_u32 s31, s40, 155648
    buffer_load_dwordx4 v14, s[8:11], s31 offen sc1 lds
    buffer_load_dwordx4 v14, s[8:11], s31 offen offset:2048 sc1 lds
    s_add_u32 m0, s30, 28672
    s_add_u32 s31, s40, 159744
    buffer_load_dwordx4 v14, s[8:11], s31 offen sc1 lds
    buffer_load_dwordx4 v14, s[8:11], s31 offen offset:2048 sc1 lds
    s_waitcnt vmcnt(16)
    s_barrier
    s_add_u32 m0, s30, 86016
    s_add_u32 s31, s44, 102400
    buffer_load_dwordx4 v14, s[8:11], s31 offen sc1 lds
    buffer_load_dwordx4 v14, s[8:11], s31 offen offset:2048 sc1 lds
    s_add_u32 m0, s30, 90112
    s_add_u32 s31, s44, 106496
    buffer_load_dwordx4 v14, s[8:11], s31 offen sc1 lds
    buffer_load_dwordx4 v14, s[8:11], s31 offen offset:2048 sc1 lds
    s_add_u32 m0, s30, 94208
    s_add_u32 s31, s44, 110592
    buffer_load_dwordx4 v14, s[8:11], s31 offen sc1 lds
    buffer_load_dwordx4 v14, s[8:11], s31 offen offset:2048 sc1 lds
    s_add_u32 m0, s30, 98304
    s_add_u32 s31, s44, 114688
    buffer_load_dwordx4 v14, s[8:11], s31 offen sc1 lds
    buffer_load_dwordx4 v14, s[8:11], s31 offen offset:2048 sc1 lds
    s_add_u32 m0, s30, 102400
    s_add_u32 s31, s44, 118784
    buffer_load_dwordx4 v14, s[8:11], s31 offen sc1 lds
    buffer_load_dwordx4 v14, s[8:11], s31 offen offset:2048 sc1 lds
    s_add_u32 m0, s30, 106496
    s_add_u32 s31, s44, 122880
    buffer_load_dwordx4 v14, s[8:11], s31 offen sc1 lds
    buffer_load_dwordx4 v14, s[8:11], s31 offen offset:2048 sc1 lds
    s_waitcnt vmcnt(20)
    s_barrier
    s_add_u32 m0, s30, 110592
    s_add_u32 s31, s44, 126976
    buffer_load_dwordx4 v14, s[8:11], s31 offen sc1 lds
    buffer_load_dwordx4 v14, s[8:11], s31 offen offset:2048 sc1 lds
    s_add_u32 m0, s30, 114688
    s_add_u32 s31, s44, 131072
    buffer_load_dwordx4 v14, s[8:11], s31 offen sc1 lds
    buffer_load_dwordx4 v14, s[8:11], s31 offen offset:2048 sc1 lds
    s_add_u32 m0, s30, 118784
    s_add_u32 s31, s44, 135168
    buffer_load_dwordx4 v14, s[8:11], s31 offen sc1 lds
    buffer_load_dwordx4 v14, s[8:11], s31 offen offset:2048 sc1 lds
    s_add_u32 m0, s30, 122880
    s_add_u32 s31, s44, 139264
    buffer_load_dwordx4 v14, s[8:11], s31 offen sc1 lds
    buffer_load_dwordx4 v14, s[8:11], s31 offen offset:2048 sc1 lds
    s_add_u32 m0, s30, 126976
    s_add_u32 s31, s44, 143360
    buffer_load_dwordx4 v14, s[8:11], s31 offen sc1 lds
    buffer_load_dwordx4 v14, s[8:11], s31 offen offset:2048 sc1 lds
    s_add_u32 m0, s30, 131072
    s_add_u32 s31, s44, 147456
    buffer_load_dwordx4 v14, s[8:11], s31 offen sc1 lds
    buffer_load_dwordx4 v14, s[8:11], s31 offen offset:2048 sc1 lds
    s_waitcnt vmcnt(24)
    s_barrier
    s_add_u32 m0, s30, 135168
    s_add_u32 s31, s44, 151552
    buffer_load_dwordx4 v14, s[8:11], s31 offen sc1 lds
    buffer_load_dwordx4 v14, s[8:11], s31 offen offset:2048 sc1 lds
    s_add_u32 m0, s30, 139264
    s_add_u32 s31, s44, 155648
    buffer_load_dwordx4 v14, s[8:11], s31 offen sc1 lds
    buffer_load_dwordx4 v14, s[8:11], s31 offen offset:2048 sc1 lds
    s_add_u32 m0, s30, 143360
    s_add_u32 s31, s44, 159744
    buffer_load_dwordx4 v14, s[8:11], s31 offen sc1 lds
    buffer_load_dwordx4 v14, s[8:11], s31 offen offset:2048 sc1 lds
    s_mul_i32 s20, s19, 524288
    s_add_u32 s20, s20, 29097984
    v_mov_b32 v67, 0x3f80
    s_sub_u32 s26, s16, 4
    s_lshl_b32 s27, s26, 9
    s_lshl_b32 s26, s26, 10
    s_lshl_b32 s21, s18, 15
    s_add_u32 s20, s20, s21
    s_add_u32 s20, s20, s27
    s_lshl_b32 s21, s17, 11
    s_add_u32 s21, s21, s20
    v_and_b32 v3, 63, v0
    v_lshlrev_b32 v3, 3, v3
    v_lshl_add_u32 v2, v3, 1, s26
    v_bfe_u32 v64, v0, 3, 1
    v_bfe_u32 v65, v0, 4, 1
    v_cmp_eq_u32 vcc, v65, v64
    v_and_b32 v66, 1, v0
    v_lshlrev_b32 v66, 4, v66
    v_lshlrev_b32 v66, v66, v67
    v_cndmask_b32 v66, 0, v66, vcc
    v_bfe_u32 v64, v0, 1, 2
    v_cmp_eq_u32 vcc, 0, v64
    s_nop 1
    v_cndmask_b32 v68, 0, v66, vcc
    v_cmp_eq_u32 vcc, 1, v64
    s_nop 1
    v_cndmask_b32 v69, 0, v66, vcc
    v_cmp_eq_u32 vcc, 2, v64
    s_nop 1
    v_cndmask_b32 v70, 0, v66, vcc
    v_cmp_eq_u32 vcc, 3, v64
    s_nop 1
    v_cndmask_b32 v71, 0, v66, vcc
    v_and_b32 v64, 31, v0
    v_lshlrev_b32 v64, 4, v64
    v_bfe_u32 v66, v0, 5, 1
    v_lshl_add_u32 v72, v66, 11, v64
    v_and_b32 v64, 15, v0
    v_lshl_add_u32 v64, v66, 4, v64
    v_lshl_add_u32 v64, v64, 1, v65
    v_lshl_add_u32 v5, v64, 3, s27
    v_add_u32 v5, 158208, v5
    s_lshl_b32 s25, s19, 14
    s_lshl_b32 s22, s26, 2
    s_add_u32 s25, s25, s22
    s_lshl_b32 s22, s18, 8
    s_add_u32 s25, s25, s22
    s_add_u32 s25, s25, 57344
    s_waitcnt vmcnt(0)
    s_barrier
    s_branch main_kernel_ljoin
main_kernel_misc:
    s_lshl_b32 s50, s17, 8
    s_add_u32 s50, s50, 0
    s_mov_b32 s51, s50
    v_mov_b32 v16, 0
    v_mov_b32 v17, 0
    v_mov_b32 v18, 160256
    ds_write_b64 v18, v[16:17]
    s_lshr_b32 s36, s2, 3
    s_lshl_b32 s36, s36, 1
    s_add_u32 s36, s36, s16
    s_sub_u32 s36, s36, 6
    s_lshl_b32 s36, s36, 10
    s_mov_b32 s37, main_kernel_end-main_kernel-1088
    s_min_u32 s36, s36, s37
    v_add_u32 v15, s36, v1
main_kernel_mloop:
    s_cmp_lg_u32 s16, 7
    s_cbranch_scc1 go_3001
    s_cmp_eq_u32 s19, 0
    s_cbranch_scc1 go_3001
    s_mov_b32 s72, 1
    s_atomic_add s72, s[4:5], s51
    s_add_u32 s51, s51, 4096
go_3001:
    s_cmp_lg_u32 s16, 7
    s_cbranch_scc1 go_3002
    s_cmp_eq_u32 s19, 0
    s_cbranch_scc1 go_3002
    s_mov_b32 s74, 300000
poll_3003:
    s_mov_b32 s75, 0
    s_atomic_add s75, s[4:5], s50 glc
    s_waitcnt lgkmcnt(0)
    s_cmp_ge_u32 s75, 16
    s_cbranch_scc1 poll_3003_x
    s_sub_u32 s74, s74, 1
    s_cmp_lg_u32 s74, 0
    s_cbranch_scc1 poll_3003
poll_3003_x:
go_3002_k:
    s_add_u32 s50, s50, 4096
go_3002:
    s_cmp_lg_u32 s19, 0
    s_cbranch_scc1 pp_3004
    s_cmp_lg_u32 s16, 7
    s_cbranch_scc1 pp_3004
    s_lshr_b32 s22, s18, 1
    s_lshl_b32 s22, s22, 8
    s_add_u32 s22, s22, 98304
    s_add_u32 s23, s22, 2048
    s_add_u32 s24, s22, 4096
    s_lshl_b32 s25, s17, 8
    s_add_u32 s25, s25, 106496
    s_mov_b32 s74, 300000
    s_branch poll_3005_f
poll_3005:
    s_sleep 6
poll_3005_f:
    s_mov_b32 s75, 0
    s_mov_b32 s76, 0
    s_mov_b32 s77, 0
    s_mov_b32 s78, 0
    s_atomic_add s75, s[4:5], s23 glc
    s_atomic_add s76, s[4:5], s24 glc
    s_atomic_add s77, s[4:5], s22 glc
    s_atomic_add s78, s[4:5], s25 glc
    s_waitcnt lgkmcnt(0)
    s_sub_u32 s74, s74, 1
    s_cmp_eq_u32 s74, 0
    s_cbranch_scc1 poll_3005_x
    s_cmp_lt_u32 s75, 20
    s_cbranch_scc1 poll_3005
    s_cmp_lt_u32 s76, 20
    s_cbranch_scc1 poll_3005
    s_cmp_lt_u32 s77, 20
    s_cbranch_scc1 poll_3005
    s_cmp_lt_u32 s78, 16
    s_cbranch_scc1 poll_3005
poll_3005_x:
pp_3004:
    s_barrier
    s_cmp_eq_u32 s16, 7
    s_cbranch_scc1 st_3006
    s_mul_i32 s20, s19, 131072
    s_add_u32 s20, s20, 28442624
    s_lshl_b32 s21, s17, 13
    s_add_u32 s20, s20, s21
    s_add_u32 s21, s20, 4096
    buffer_load_dwordx4 v[16:19], v1, s[8:11], s20 offen offset:0 sc1
    buffer_load_dwordx4 v[20:23], v1, s[8:11], s20 offen offset:1024 sc1
    buffer_load_dwordx4 v[24:27], v1, s[8:11], s20 offen offset:2048 sc1
    buffer_load_dwordx4 v[28:31], v1, s[8:11], s20 offen offset:3072 sc1
    buffer_load_dwordx4 v[32:35], v1, s[8:11], s21 offen offset:0 sc1
    buffer_load_dwordx4 v[36:39], v1, s[8:11], s21 offen offset:1024 sc1
    buffer_load_dwordx4 v[40:43], v1, s[8:11], s21 offen offset:2048 sc1
    buffer_load_dwordx4 v[44:47], v1, s[8:11], s21 offen offset:3072 sc1
    s_cmp_eq_u32 s19, 0
    s_cbranch_scc1 st_3006
    s_add_u32 s20, s20, 393216
    s_add_u32 s21, s20, 4096
    buffer_load_dwordx4 v[48:51], v1, s[8:11], s20 offen offset:0 sc1
    buffer_load_dwordx4 v[52:55], v1, s[8:11], s20 offen offset:1024 sc1
    buffer_load_dwordx4 v[56:59], v1, s[8:11], s20 offen offset:2048 sc1
    buffer_load_dwordx4 v[60:63], v1, s[8:11], s20 offen offset:3072 sc1
    buffer_load_dwordx4 v[64:67], v1, s[8:11], s21 offen offset:0 sc1
    buffer_load_dwordx4 v[68:71], v1, s[8:11], s21 offen offset:1024 sc1
    buffer_load_dwordx4 v[72:75], v1, s[8:11], s21 offen offset:2048 sc1
    buffer_load_dwordx4 v[76:79], v1, s[8:11], s21 offen offset:3072 sc1
st_3006:
    s_barrier
    s_cmp_lg_u32 s19, 0
    s_cbranch_scc1 ch_3007
    s_cmp_lg_u32 s16, 7
    s_cbranch_scc1 ch_3007
    s_mov_b32 exec_hi, 0
    v_lshrrev_b32 v24, 6, v1
    v_and_b32 v25, 48, v1
    s_lshr_b32 s20, s18, 1
    s_lshl_b32 s20, s20, 9
    s_and_b32 s21, s18, 1
    s_mul_i32 s21, s21, 192
    s_add_u32 s20, s20, s21
    v_lshlrev_b32 v26, 2, v24
    v_mov_b32 v27, 0x00012211
    v_lshrrev_b32 v27, v26, v27
    v_and_b32 v27, 3, v27
    v_lshrrev_b32 v23, 5, v1
    v_cmp_eq_u32 vcc, 9, v23
    s_nop 1
    v_cndmask_b32 v27, v27, 2, vcc
    v_lshl_add_u32 v25, v27, 12, v25
    v_mov_b32 v27, 0x21021010
    v_lshrrev_b32 v27, v26, v27
    v_and_b32 v27, 3, v27
    v_lshl_add_u32 v25, v27, 6, v25
    s_add_u32 s20, s20, 39518208
    buffer_load_dwordx4 v[112:115], v25, s[8:11], s20 offen sc1
    s_add_u32 s20, s20, 12288
    buffer_load_dwordx4 v[116:119], v25, s[8:11], s20 offen sc1
    s_add_u32 s20, s20, 12288
    buffer_load_dwordx4 v[120:123], v25, s[8:11], s20 offen sc1
    s_add_u32 s20, s20, 12288
    buffer_load_dwordx4 v[124:127], v25, s[8:11], s20 offen sc1
    s_add_u32 s20, s20, 12288
    buffer_load_dwordx4 v[128:131], v25, s[8:11], s20 offen sc1
    s_add_u32 s20, s20, 12288
    buffer_load_dwordx4 v[132:135], v25, s[8:11], s20 offen sc1
    s_add_u32 s20, s20, 12288
    buffer_load_dwordx4 v[136:139], v25, s[8:11], s20 offen sc1
    s_add_u32 s20, s20, 12288
    buffer_load_dwordx4 v[140:143], v25, s[8:11], s20 offen sc1
    s_add_u32 s20, s20, 12288
    buffer_load_dwordx4 v[144:147], v25, s[8:11], s20 offen sc1
    s_add_u32 s20, s20, 12288
    buffer_load_dwordx4 v[148:151], v25, s[8:11], s20 offen sc1
    s_add_u32 s20, s20, 12288
    buffer_load_dwordx4 v[152:155], v25, s[8:11], s20 offen sc1
    s_add_u32 s20, s20, 12288
    buffer_load_dwordx4 v[156:159], v25, s[8:11], s20 offen sc1
    s_add_u32 s20, s20, 12288
    buffer_load_dwordx4 v[160:163], v25, s[8:11], s20 offen sc1
    s_add_u32 s20, s20, 12288
    buffer_load_dwordx4 v[164:167], v25, s[8:11], s20 offen sc1
    s_add_u32 s20, s20, 12288
    buffer_load_dwordx4 v[168:171], v25, s[8:11], s20 offen sc1
    s_add_u32 s20, s20, 12288
    buffer_load_dwordx4 v[172:175], v25, s[8:11], s20 offen sc1
    s_add_u32 s20, s20, 12288
    buffer_load_dwordx4 v[176:179], v25, s[8:11], s20 offen sc1
    s_add_u32 s20, s20, 12288
    buffer_load_dwordx4 v[180:183], v25, s[8:11], s20 offen sc1
    s_add_u32 s20, s20, 12288
    buffer_load_dwordx4 v[184:187], v25, s[8:11], s20 offen sc1
    s_add_u32 s20, s20, 12288
    buffer_load_dwordx4 v[188:191], v25, s[8:11], s20 offen sc1
    s_add_u32 s20, s20, 12288
    s_mov_b32 exec_hi, -1
ch_3007:
    s_barrier
    s_cmp_eq_u32 s16, 7
    s_cbranch_scc1 ch_3008
    s_cmp_eq_u32 s19, 0
    s_cbranch_scc1 ch_3008
    s_waitcnt vmcnt(0)
    v_add_f32 v16, v16, v48
    v_add_f32 v17, v17, v49
    v_add_f32 v18, v18, v50
    v_add_f32 v19, v19, v51
    v_add_f32 v20, v20, v52
    v_add_f32 v21, v21, v53
    v_add_f32 v22, v22, v54
    v_add_f32 v23, v23, v55
    v_add_f32 v24, v24, v56
    v_add_f32 v25, v25, v57
    v_add_f32 v26, v26, v58
    v_add_f32 v27, v27, v59
    v_add_f32 v28, v28, v60
    v_add_f32 v29, v29, v61
    v_add_f32 v30, v30, v62
    v_add_f32 v31, v31, v63
ch_3008:
    s_barrier
    s_cmp_eq_u32 s16, 7
    s_cbranch_scc1 ch_3009
    s_cmp_eq_u32 s19, 0
    s_cbranch_scc1 ch_3009
    v_add_f32 v32, v32, v64
    v_add_f32 v33, v33, v65
    v_add_f32 v34, v34, v66
    v_add_f32 v35, v35, v67
    v_add_f32 v36, v36, v68
    v_add_f32 v37, v37, v69
    v_add_f32 v38, v38, v70
    v_add_f32 v39, v39, v71
    v_add_f32 v40, v40, v72
    v_add_f32 v41, v41, v73
    v_add_f32 v42, v42, v74
    v_add_f32 v43, v43, v75
    v_add_f32 v44, v44, v76
    v_add_f32 v45, v45, v77
    v_add_f32 v46, v46, v78
    v_add_f32 v47, v47, v79
ch_3009:
    s_cmp_eq_u32 s16, 7
    s_cbranch_scc1 ch_3010
    s_waitcnt vmcnt(0)
    v_add_f32 v16, v16, v32
    v_add_f32 v17, v17, v33
    v_add_f32 v18, v18, v34
    v_add_f32 v19, v19, v35
    v_add_f32 v20, v20, v36
    v_add_f32 v21, v21, v37
    v_add_f32 v22, v22, v38
    v_add_f32 v23, v23, v39
    v_add_f32 v24, v24, v40
    v_add_f32 v25, v25, v41
    v_add_f32 v26, v26, v42
    v_add_f32 v27, v27, v43
    v_add_f32 v28, v28, v44
    v_add_f32 v29, v29, v45
    v_add_f32 v30, v30, v46
    v_add_f32 v31, v31, v47
    v_add_f32 v16, v16, v24
ch_3010:
    s_cmp_lg_u32 s19, 0
    s_cbranch_scc1 ch_3011
    s_cmp_lg_u32 s16, 7
    s_cbranch_scc1 ch_3011
    s_waitcnt vmcnt(0)
    v_add_f32 v112, v112, v116
    v_add_f32 v113, v113, v117
    v_add_f32 v114, v114, v118
    v_add_f32 v115, v115, v119
    v_add_f32 v112, v112, v120
    v_add_f32 v113, v113, v121
    v_add_f32 v114, v114, v122
    v_add_f32 v115, v115, v123
    v_add_f32 v112, v112, v124
    v_add_f32 v113, v113, v125
    v_add_f32 v114, v114, v126
    v_add_f32 v115, v115, v127
    v_add_f32 v112, v112, v128
    v_add_f32 v113, v113, v129
    v_add_f32 v114, v114, v130
    v_add_f32 v115, v115, v131
ch_3011:
    s_barrier
    s_cmp_eq_u32 s16, 7
    s_cbranch_scc1 ch_3012
    v_add_f32 v17, v17, v25
    v_add_f32 v18, v18, v26
    v_add_f32 v19, v19, v27
    v_add_f32 v20, v20, v28
    v_add_f32 v21, v21, v29
    v_add_f32 v22, v22, v30
    v_add_f32 v23, v23, v31
    v_add_f32 v16, v16, v20
    v_add_f32 v17, v17, v21
    v_add_f32 v18, v18, v22
    v_add_f32 v19, v19, v23
    s_mov_b32 s22, 0x3acccccd
    v_mul_f32 v16, s22, v16
    v_mul_f32 v18, s22, v18
    v_mul_f32 v20, v16, v16
    v_mul_f32 v21, v18, v18
    v_fma_f32 v20, v17, s22, -v20
    v_fma_f32 v21, v19, s22, -v21
ch_3012:
    s_cmp_lg_u32 s19, 0
    s_cbranch_scc1 ch_3013
    s_cmp_lg_u32 s16, 7
    s_cbranch_scc1 ch_3013
    v_add_f32 v112, v112, v132
    v_add_f32 v113, v113, v133
    v_add_f32 v114, v114, v134
    v_add_f32 v115, v115, v135
    v_add_f32 v112, v112, v136
    v_add_f32 v113, v113, v137
    v_add_f32 v114, v114, v138
    v_add_f32 v115, v115, v139
    v_add_f32 v112, v112, v140
    v_add_f32 v113, v113, v141
    v_add_f32 v114, v114, v142
    v_add_f32 v115, v115, v143
    v_add_f32 v112, v112, v144
    v_add_f32 v113, v113, v145
    v_add_f32 v114, v114, v146
    v_add_f32 v115, v115, v147
    v_add_f32 v112, v112, v148
ch_3013:
    s_barrier
    s_cmp_eq_u32 s16, 7
    s_cbranch_scc1 ch_3014
    v_max_f32 v20, 0, v20
    v_max_f32 v21, 0, v21
    v_add_f32 v20, 0x3727c5ac, v20
    v_add_f32 v21, 0x3727c5ac, v21
    v_rsq_f32 v22, v20
    v_rsq_f32 v23, v21
    v_sub_f32 v24, 0, v16
    v_sub_f32 v25, 0, v18
    v_lshrrev_b32 v26, 1, v1
    v_add_u32 v26, 155648, v26
    v_mul_f32 v28, 1069066811, v22
    v_mul_f32 v29, 1069066811, v23
    ds_write_b64 v26, v[24:25]
    ds_write_b64 v26, v[22:23] offset:512
    ds_write_b64 v26, v[28:29] offset:5120
    ds_write_b64 v26, v[20:21] offset:5632
ch_3014:
    s_cmp_lg_u32 s19, 0
    s_cbranch_scc1 ch_3015
    s_cmp_lg_u32 s16, 7
    s_cbranch_scc1 ch_3015
    v_add_f32 v113, v113, v149
    v_add_f32 v114, v114, v150
    v_add_f32 v115, v115, v151
    v_add_f32 v112, v112, v152
    v_add_f32 v113, v113, v153
    v_add_f32 v114, v114, v154
    v_add_f32 v115, v115, v155
    v_add_f32 v112, v112, v156
    v_add_f32 v113, v113, v157
    v_add_f32 v114, v114, v158
    v_add_f32 v115, v115, v159
    v_add_f32 v112, v112, v160
    v_add_f32 v113, v113, v161
    v_add_f32 v114, v114, v162
    v_add_f32 v115, v115, v163
    v_add_f32 v112, v112, v164
    v_add_f32 v113, v113, v165
ch_3015:
    s_barrier
    s_waitcnt lgkmcnt(0)
    s_cmp_lg_u32 s19, 0
    s_cbranch_scc1 ch_3016
    s_cmp_lg_u32 s16, 7
    s_cbranch_scc1 ch_3016
    v_add_f32 v114, v114, v166
    v_add_f32 v115, v115, v167
    v_add_f32 v112, v112, v168
    v_add_f32 v113, v113, v169
    v_add_f32 v114, v114, v170
    v_add_f32 v115, v115, v171
    v_add_f32 v112, v112, v172
    v_add_f32 v113, v113, v173
    v_add_f32 v114, v114, v174
    v_add_f32 v115, v115, v175
    v_add_f32 v112, v112, v176
    v_add_f32 v113, v113, v177
    v_add_f32 v114, v114, v178
    v_add_f32 v115, v115, v179
    v_add_f32 v112, v112, v180
    v_add_f32 v113, v113, v181
    v_add_f32 v114, v114, v182
ch_3016:
    s_cmp_lg_u32 s19, 0
    s_cbranch_scc1 ch_3017
    s_cmp_lg_u32 s16, 7
    s_cbranch_scc1 ch_3017
    v_mov_b32 v28, -1
    v_mov_b32 v29, -1
    v_mov_b32 v30, -1
    v_mov_b32 v31, -1
    s_lshl_b32 s36, s18, 4
    s_add_u32 s36, s36, s17
    s_lshl_b32 s36, s36, 11
    s_add_u32 s36, s36, 29097984
    s_add_u32 s37, s36, 524288
    buffer_store_dwordx4 v[28:31], v1, s[8:11], s36 offen offset:0 sc1
    buffer_store_dwordx4 v[28:31], v1, s[8:11], s36 offen offset:1024 sc1
    buffer_store_dwordx4 v[28:31], v1, s[8:11], s37 offen offset:0 sc1
    buffer_store_dwordx4 v[28:31], v1, s[8:11], s37 offen offset:1024 sc1
ch_3017:
    s_barrier
    s_cmp_lg_u32 s19, 0
    s_cbranch_scc1 ch_3018
    s_cmp_lg_u32 s16, 7
    s_cbranch_scc1 ch_3018
    v_add_f32 v115, v115, v183
    v_add_f32 v112, v112, v184
    v_add_f32 v113, v113, v185
    v_add_f32 v114, v114, v186
    v_add_f32 v115, v115, v187
    v_add_f32 v112, v112, v188
    v_add_f32 v113, v113, v189
    v_add_f32 v114, v114, v190
    v_add_f32 v115, v115, v191
    v_add_u32 v26, 156672, v1
    s_mov_b32 exec_hi, 0
    ds_write_b128 v26, v[112:115]
    s_mov_b64 exec, -1
    s_waitcnt lgkmcnt(0)
    s_nop 0
ch_3018:
    s_cmp_lg_u32 s19, 0
    s_cbranch_scc1 pf_3019
    global_load_dword v12, v15, s[86:87]
pf_3019:
    s_barrier
    s_barrier
    s_waitcnt vmcnt(0)
    s_cmp_lg_u32 s19, 0
    s_cbranch_scc1 mc_3020
    s_add_u32 m0, s68, 0
    s_nop 0
    buffer_load_dwordx4 v101, s[52:55], s67 offen offset:0 nt lds
    s_add_u32 m0, s68, 896
    s_nop 0
    buffer_load_dwordx4 v101, s[52:55], s67 offen offset:128 nt lds
    s_add_u32 s67, s67, s66
    s_add_u32 m0, s68, 2048
    s_nop 0
    buffer_load_dwordx4 v101, s[52:55], s67 offen offset:0 nt lds
    s_add_u32 m0, s68, 2944
    s_nop 0
    buffer_load_dwordx4 v101, s[52:55], s67 offen offset:128 nt lds
    s_add_u32 s67, s67, s66
    s_add_u32 s67, s67, s70
    s_add_u32 m0, s68, 4096
    s_nop 0
    buffer_load_dwordx4 v101, s[52:55], s67 offen offset:0 nt lds
    s_add_u32 m0, s68, 4992
    s_nop 0
    buffer_load_dwordx4 v101, s[52:55], s67 offen offset:128 nt lds
    s_add_u32 s67, s67, s66
    s_add_u32 m0, s68, 6144
    s_nop 0
    buffer_load_dwordx4 v101, s[52:55], s67 offen offset:0 nt lds
    s_add_u32 m0, s68, 7040
    s_nop 0
    buffer_load_dwordx4 v101, s[52:55], s67 offen offset:128 nt lds
    s_add_u32 s67, s67, s66
mc_3020:
    s_barrier
    s_cmp_lg_u32 s19, 0
    s_cbranch_scc1 pp_3021
    s_lshr_b32 s22, s18, 1
    s_lshl_b32 s22, s22, 8
    s_add_u32 s22, s22, 104448
    s_mov_b32 s74, 300000
poll_3022:
    s_mov_b32 s75, 0
    s_atomic_add s75, s[4:5], s22 glc
    s_waitcnt lgkmcnt(0)
    s_cmp_ge_u32 s75, 20
    s_cbranch_scc1 poll_3022_x
    s_sub_u32 s74, s74, 1
    s_cmp_lg_u32 s74, 0
    s_cbranch_scc1 poll_3022
poll_3022_x:
pp_3021:
    s_mul_i32 s20, s19, 524288
    s_add_u32 s20, s20, 29097984
    v_mov_b32 v67, 0x3f80
    s_sub_u32 s26, s16, 4
    s_lshl_b32 s27, s26, 9
    s_lshl_b32 s26, s26, 10
    s_lshl_b32 s21, s18, 15
    s_add_u32 s20, s20, s21
    s_add_u32 s20, s20, s27
    s_lshl_b32 s21, s17, 11
    s_add_u32 s21, s21, s20
    v_and_b32 v3, 63, v0
    v_lshlrev_b32 v3, 3, v3
    v_lshl_add_u32 v2, v3, 1, s26
    v_bfe_u32 v64, v0, 3, 1
    v_bfe_u32 v65, v0, 4, 1
    v_cmp_eq_u32 vcc, v65, v64
    v_and_b32 v66, 1, v0
    v_lshlrev_b32 v66, 4, v66
    v_lshlrev_b32 v66, v66, v67
    v_cndmask_b32 v66, 0, v66, vcc
    v_bfe_u32 v64, v0, 1, 2
    v_cmp_eq_u32 vcc, 0, v64
    s_nop 1
    v_cndmask_b32 v68, 0, v66, vcc
    v_cmp_eq_u32 vcc, 1, v64
    s_nop 1
    v_cndmask_b32 v69, 0, v66, vcc
    v_cmp_eq_u32 vcc, 2, v64
    s_nop 1
    v_cndmask_b32 v70, 0, v66, vcc
    v_cmp_eq_u32 vcc, 3, v64
    s_nop 1
    v_cndmask_b32 v71, 0, v66, vcc
    v_and_b32 v64, 31, v0
    v_lshlrev_b32 v64, 4, v64
    v_bfe_u32 v66, v0, 5, 1
    v_lshl_add_u32 v72, v66, 11, v64
    v_and_b32 v64, 15, v0
    v_lshl_add_u32 v64, v66, 4, v64
    v_lshl_add_u32 v64, v64, 1, v65
    v_lshl_add_u32 v5, v64, 3, s27
    v_add_u32 v5, 158208, v5
    s_lshl_b32 s25, s19, 14
    s_lshl_b32 s22, s26, 2
    s_add_u32 s25, s25, s22
    s_lshl_b32 s22, s18, 8
    s_add_u32 s25, s25, s22
    s_add_u32 s25, s25, 57344
    s_barrier
    ds_read_b128 v[16:19], v2 offset:0
    ds_read_b128 v[20:23], v2 offset:4096
    ds_read_b128 v[24:27], v2 offset:8192
    ds_read_b128 v[28:31], v2 offset:12288
    s_waitcnt lgkmcnt(2)
    v_add_f32 v16, v16, v20
    v_add_f32 v17, v17, v21
    v_add_f32 v18, v18, v22
    v_add_f32 v19, v19, v23
    s_waitcnt lgkmcnt(0)
    v_add_f32 v24, v24, v28
    v_add_f32 v25, v25, v29
    v_add_f32 v26, v26, v30
    v_add_f32 v27, v27, v31
    v_add_f32 v16, v16, v24
    v_add_f32 v17, v17, v25
    v_add_f32 v18, v18, v26
    v_add_f32 v19, v19, v27
    v_cvt_pk_bf16_f32 v24, v16, v17
    v_cvt_pk_bf16_f32 v25, v18, v19
    v_min_u32 v24, -2, v24
    v_min_u32 v25, -2, v25
    buffer_store_dwordx2 v[24:25], v3, s[8:11], s21 offen sc1
    s_mov_b32 s72, 1
    s_atomic_add s72, s[4:5], s25
    s_cmp_lg_u32 s19, 0
    s_cbranch_scc1 cd_3023_e
    s_cmp_ge_u32 s2, 160
    s_cbranch_scc1 cd_3023_w2
    v_add_u32 v110, 0, v106
    v_lshrrev_b32 v112, 7, v110
    v_mul_u32_u24 v112, 896, v112
    v_add3_u32 v112, v112, v110, v104
    v_add_u32 v110, 64, v106
    v_lshrrev_b32 v113, 7, v110
    v_mul_u32_u24 v113, 896, v113
    v_add3_u32 v113, v113, v110, v104
    v_add_u32 v110, 128, v106
    v_lshrrev_b32 v114, 7, v110
    v_mul_u32_u24 v114, 896, v114
    v_add3_u32 v114, v114, v110, v104
    v_add_u32 v110, 32, v106
    v_lshrrev_b32 v115, 7, v110
    v_mul_u32_u24 v115, 896, v115
    v_add3_u32 v115, v115, v110, v104
    v_add_u32 v110, 96, v106
    v_lshrrev_b32 v116, 7, v110
    v_mul_u32_u24 v116, 896, v116
    v_add3_u32 v116, v116, v110, v104
    v_add_u32 v110, 160, v106
    v_lshrrev_b32 v117, 7, v110
    v_mul_u32_u24 v117, 896, v117
    v_add3_u32 v117, v117, v110, v104
    s_bfe_u32 s69, s2, 0x10002
    s_mul_i32 s70, s63, 20
    s_add_u32 s70, s70, s64
    s_mul_i32 s70, s70, 12
    s_add_u32 s70, s70, s69
    s_lshl_b32 s70, s70, 10
    s_add_u32 s70, s70, 33619968
    s_lshl_b32 s71, s64, 4
    s_add_u32 s71, s71, s63
    s_lshl_b32 s71, s71, 1
    s_add_u32 s71, s71, s69
    s_lshl_b32 s71, s71, 9
    s_add_u32 s71, s71, 39780352
    s_waitcnt vmcnt(0)
    ds_read_b64_tr_b16 v[128:129], v112
    ds_read_b64_tr_b16 v[130:131], v112 offset:512
    ds_read_b64_tr_b16 v[132:133], v113
    ds_read_b64_tr_b16 v[134:135], v113 offset:512
    ds_read_b64_tr_b16 v[136:137], v114
    ds_read_b64_tr_b16 v[138:139], v114 offset:512
    ds_read_b64_tr_b16 v[140:141], v115
    ds_read_b64_tr_b16 v[142:143], v115 offset:512
    ds_read_b64_tr_b16 v[144:145], v116
    ds_read_b64_tr_b16 v[146:147], v116 offset:512
    ds_read_b64_tr_b16 v[148:149], v117
    ds_read_b64_tr_b16 v[150:151], v117 offset:512
    s_waitcnt lgkmcnt(10)
    buffer_store_dwordx4 v[128:131], v108, s[8:11], s70 offen offset:0 sc1
    v_mfma_f32_16x16x32_bf16 v[160:163], v[128:131], v[76:79], 0
    s_waitcnt lgkmcnt(8)
    buffer_store_dwordx4 v[132:135], v108, s[8:11], s70 offen offset:2048 sc1
    v_mfma_f32_16x16x32_bf16 v[160:163], v[132:135], v[80:83], v[160:163]
    s_add_u32 s70, s70, 4096
    s_waitcnt lgkmcnt(6)
    buffer_store_dwordx4 v[136:139], v108, s[8:11], s70 offen offset:0 sc1
    v_mfma_f32_16x16x32_bf16 v[160:163], v[136:139], v[84:87], v[160:163]
    s_waitcnt lgkmcnt(4)
    buffer_store_dwordx4 v[140:143], v108, s[8:11], s70 offen offset:2048 sc1
    v_mfma_f32_16x16x32_bf16 v[160:163], v[140:143], v[88:91], v[160:163]
    s_add_u32 s70, s70, 4096
    s_waitcnt lgkmcnt(2)
    buffer_store_dwordx4 v[144:147], v108, s[8:11], s70 offen offset:0 sc1
    v_mfma_f32_16x16x32_bf16 v[160:163], v[144:147], v[92:95], v[160:163]
    s_waitcnt lgkmcnt(0)
    buffer_store_dwordx4 v[148:151], v108, s[8:11], s70 offen offset:2048 sc1
    v_mfma_f32_16x16x32_bf16 v[160:163], v[148:151], v[96:99], v[160:163]
    s_add_u32 s70, s70, 4096
    s_mov_b32 exec_lo, 0xff00ff
    s_mov_b32 exec_hi, 0xff00ff
    s_nop 4
    buffer_store_dwordx4 v[160:163], v109, s[8:11], s71 offen sc1
    s_mov_b64 exec, -1
    s_branch cd_3023_e
cd_3023_w2:
    v_add_u32 v110, 0, v107
    v_lshrrev_b32 v112, 7, v110
    v_mul_u32_u24 v112, 896, v112
    v_add3_u32 v112, v112, v110, v104
    v_add_u32 v110, 8, v107
    v_lshrrev_b32 v113, 7, v110
    v_mul_u32_u24 v113, 896, v113
    v_add3_u32 v113, v113, v110, v104
    v_add_u32 v110, 64, v107
    v_lshrrev_b32 v114, 7, v110
    v_mul_u32_u24 v114, 896, v114
    v_add3_u32 v114, v114, v110, v104
    v_add_u32 v110, 72, v107
    v_lshrrev_b32 v115, 7, v110
    v_mul_u32_u24 v115, 896, v115
    v_add3_u32 v115, v115, v110, v104
    v_add_u32 v110, 128, v106
    v_lshrrev_b32 v116, 7, v110
    v_mul_u32_u24 v116, 896, v116
    v_add3_u32 v116, v116, v110, v104
    s_mul_i32 s69, s64, 43691
    s_lshr_b32 s69, s69, 17
    s_mul_i32 s70, s69, 3
    s_sub_u32 s70, s64, s70
    s_sub_u32 s70, 2, s70
    s_lshl_b32 s70, s70, 4
    s_add_u32 s69, s69, s70
    s_mul_i32 s70, s63, 245760
    s_add_u32 s70, s70, 37552128
    s_lshl_b32 s71, s69, 10
    s_add_u32 s71, s71, s70
    s_lshl_b32 s69, s69, 12
    s_add_u32 s70, s70, s69
    s_add_u32 s70, s70, 49152
    s_waitcnt vmcnt(0)
    ds_read_b64_tr_b16 v[128:129], v112
    ds_read_b64_tr_b16 v[130:131], v112 offset:512
    ds_read_b64_tr_b16 v[132:133], v113
    ds_read_b64_tr_b16 v[134:135], v113 offset:512
    ds_read_b64_tr_b16 v[136:137], v114
    ds_read_b64_tr_b16 v[138:139], v114 offset:512
    ds_read_b64_tr_b16 v[140:141], v115
    ds_read_b64_tr_b16 v[142:143], v115 offset:512
    ds_read_b64_tr_b16 v[144:145], v116
    ds_read_b64_tr_b16 v[146:147], v116 offset:512
    s_waitcnt lgkmcnt(8)
    buffer_store_dwordx4 v[128:131], v108, s[8:11], s70 offen offset:0 sc1
    s_waitcnt lgkmcnt(6)
    buffer_store_dwordx4 v[132:135], v108, s[8:11], s70 offen offset:1024 sc1
    s_waitcnt lgkmcnt(4)
    buffer_store_dwordx4 v[136:139], v108, s[8:11], s70 offen offset:2048 sc1
    s_waitcnt lgkmcnt(2)
    buffer_store_dwordx4 v[140:143], v108, s[8:11], s70 offen offset:3072 sc1
    s_waitcnt lgkmcnt(0)
    buffer_store_dwordx4 v[144:147], v108, s[8:11], s71 offen sc1
cd_3023_e:
    s_mov_b32 s74, 300000
poll_3024:
    s_mov_b32 s75, 0
    s_atomic_add s75, s[4:5], s25 glc
    s_waitcnt lgkmcnt(0)
    s_cmp_ge_u32 s75, 16
    s_cbranch_scc1 poll_3024_x
    s_sub_u32 s74, s74, 1
    s_cmp_lg_u32 s74, 0
    s_cbranch_scc1 poll_3024
poll_3024_x:
    s_mov_b32 s24, 300000
kvp_3025:
    s_mov_b32 s22, s20
    buffer_load_dwordx4 v[32:35], v72, s[8:11], s22 offen sc1
    s_add_u32 s22, s22, 4096
    buffer_load_dwordx4 v[36:39], v72, s[8:11], s22 offen sc1
    s_add_u32 s22, s22, 4096
    buffer_load_dwordx4 v[40:43], v72, s[8:11], s22 offen sc1
    s_add_u32 s22, s22, 4096
    buffer_load_dwordx4 v[44:47], v72, s[8:11], s22 offen sc1
    s_add_u32 s22, s22, 4096
    buffer_load_dwordx4 v[48:51], v72, s[8:11], s22 offen sc1
    s_add_u32 s22, s22, 4096
    buffer_load_dwordx4 v[52:55], v72, s[8:11], s22 offen sc1
    s_add_u32 s22, s22, 4096
    buffer_load_dwordx4 v[56:59], v72, s[8:11], s22 offen sc1
    s_add_u32 s22, s22, 4096
    buffer_load_dwordx4 v[60:63], v72, s[8:11], s22 offen sc1
    s_add_u32 s22, s22, 4096
    v_mov_b32 v6, 0
    s_waitcnt vmcnt(7)
    v_mfma_f32_16x16x32_bf16 v[16:19], v[68:71], v[32:35], 0
    v_max3_u32 v6, v32, v33, v6
    v_max3_u32 v6, v34, v35, v6
    s_waitcnt vmcnt(6)
    v_mfma_f32_16x16x32_bf16 v[16:19], v[68:71], v[36:39], v[16:19]
    v_max3_u32 v6, v36, v37, v6
    v_max3_u32 v6, v38, v39, v6
    s_waitcnt vmcnt(5)
    v_mfma_f32_16x16x32_bf16 v[16:19], v[68:71], v[40:43], v[16:19]
    v_max3_u32 v6, v40, v41, v6
    v_max3_u32 v6, v42, v43, v6
    s_waitcnt vmcnt(4)
    v_mfma_f32_16x16x32_bf16 v[16:19], v[68:71], v[44:47], v[16:19]
    v_max3_u32 v6, v44, v45, v6
    v_max3_u32 v6, v46, v47, v6
    s_waitcnt vmcnt(3)
    v_mfma_f32_16x16x32_bf16 v[16:19], v[68:71], v[48:51], v[16:19]
    v_max3_u32 v6, v48, v49, v6
    v_max3_u32 v6, v50, v51, v6
    s_waitcnt vmcnt(2)
    v_mfma_f32_16x16x32_bf16 v[16:19], v[68:71], v[52:55], v[16:19]
    v_max3_u32 v6, v52, v53, v6
    v_max3_u32 v6, v54, v55, v6
    s_waitcnt vmcnt(1)
    v_mfma_f32_16x16x32_bf16 v[16:19], v[68:71], v[56:59], v[16:19]
    v_max3_u32 v6, v56, v57, v6
    v_max3_u32 v6, v58, v59, v6
    s_waitcnt vmcnt(0)
    v_mfma_f32_16x16x32_bf16 v[16:19], v[68:71], v[60:63], v[16:19]
    v_max3_u32 v6, v60, v61, v6
    v_max3_u32 v6, v62, v63, v6
    s_sub_u32 s24, s24, 1
    s_cmp_eq_u32 s24, 0
    s_cbranch_scc1 kvp_3025_x
    v_cmp_eq_u32 vcc, -1, v6
    s_cbranch_vccnz kvp_3025
kvp_3025_x:
    s_nop 1
    v_cvt_pk_bf16_f32 v24, v16, v17
    v_cvt_pk_bf16_f32 v25, v18, v19
    ds_write_b64 v5, v[24:25]
    s_waitcnt lgkmcnt(0)
    s_cmp_lg_u32 s19, 0
    s_cbranch_scc1 cp_3026
    s_cmp_ge_u32 s2, 160
    s_cselect_b32 s69, 16, 0
    s_add_u32 s69, s69, s63
    s_lshl_b32 s69, s69, 8
    s_add_u32 s69, s69, 90112
    s_waitcnt vmcnt(0)
    s_mov_b32 s72, 1
    s_atomic_add s72, s[4:5], s69
cp_3026:
    s_barrier
    s_barrier
    s_cmp_lg_u32 s16, 7
    s_cbranch_scc1 go_3027
    s_mov_b32 s72, 1
    s_atomic_add s72, s[4:5], s51
    s_add_u32 s51, s51, 4096
go_3027:
    s_cmp_lg_u32 s16, 7
    s_cbranch_scc1 go_3028
    s_mov_b32 s74, 300000
poll_3029:
    s_mov_b32 s75, 0
    s_atomic_add s75, s[4:5], s50 glc
    s_waitcnt lgkmcnt(0)
    s_cmp_ge_u32 s75, 16
    s_cbranch_scc1 poll_3029_x
    s_sub_u32 s74, s74, 1
    s_cmp_lg_u32 s74, 0
    s_cbranch_scc1 poll_3029
poll_3029_x:
go_3028_k:
    s_add_u32 s50, s50, 4096
go_3028:
    s_cmp_lg_u32 s19, 0
    s_cbranch_scc1 pf_3030
    global_load_dword v12, v15, s[86:87]
pf_3030:
    s_barrier
    s_barrier
    s_barrier
    s_barrier
    s_barrier
    s_barrier
    s_cmp_lg_u32 s19, 0
    s_cbranch_scc1 ch_3031
    s_cmp_lg_u32 s16, 6
    s_cbranch_scc1 ch_3031
    s_lshl_b32 s22, s18, 8
    s_add_u32 s22, s22, 90112
    s_mov_b32 s74, 300000
poll_9001:
    s_mov_b32 s75, 0
    s_atomic_add s75, s[4:5], s22 glc
    s_waitcnt lgkmcnt(0)
    s_cmp_ge_u32 s75, 40
    s_cbranch_scc1 poll_9001_x
    s_sub_u32 s74, s74, 1
    s_cmp_lg_u32 s74, 0
    s_cbranch_scc1 poll_9001
poll_9001_x:
ch_3031:
    s_barrier
    s_cmp_lg_u32 s19, 0
    s_cbranch_scc1 ch_3032
    s_cmp_lg_u32 s16, 6
    s_cbranch_scc1 ch_3032
    s_lshr_b32 s22, s18, 1
    s_lshl_b32 s22, s22, 8
    s_add_u32 s22, s22, 94208
    s_mov_b32 s74, 300000
poll_9201:
    s_mov_b32 s75, 0
    s_atomic_add s75, s[4:5], s22 glc
    s_waitcnt lgkmcnt(0)
    s_cmp_ge_u32 s75, 48
    s_cbranch_scc1 poll_9201_x
    s_sub_u32 s74, s74, 1
    s_cmp_lg_u32 s74, 0
    s_cbranch_scc1 poll_9201
poll_9201_x:
ch_3032:
    s_cmp_lg_u32 s16, 7
    s_cbranch_scc1 go_3033
    s_mov_b32 s72, 1
    s_atomic_add s72, s[4:5], s51
    s_add_u32 s51, s51, 4096
go_3033:
    s_cmp_lg_u32 s16, 7
    s_cbranch_scc1 go_3034
    s_mov_b32 s74, 300000
poll_3035:
    s_mov_b32 s75, 0
    s_atomic_add s75, s[4:5], s50 glc
    s_waitcnt lgkmcnt(0)
    s_cmp_ge_u32 s75, 16
    s_cbranch_scc1 poll_3035_x
    s_sub_u32 s74, s74, 1
    s_cmp_lg_u32 s74, 0
    s_cbranch_scc1 poll_3035
poll_3035_x:
go_3034_k:
    s_add_u32 s50, s50, 4096
go_3034:
    s_cmp_lg_u32 s19, 0
    s_cbranch_scc1 pf_3036
    global_load_dword v12, v15, s[86:87]
pf_3036:
    s_barrier
    s_barrier
    s_cmp_lg_u32 s16, 7
    s_cbranch_scc1 go_3037
    s_mov_b32 s72, 1
    s_atomic_add s72, s[4:5], s51
    s_add_u32 s51, s51, 4096
go_3037:
    s_cmp_lg_u32 s19, 0
    s_cbranch_scc1 ch_3038
    s_cmp_lg_u32 s16, 7
    s_cbranch_scc1 ch_3038
    s_mov_b32 exec_hi, 0xffff
    v_lshrrev_b32 v24, 6, v1
    v_and_b32 v25, 48, v1
    s_lshl_b32 s20, s18, 10
    v_and_b32 v26, 1, v24
    v_lshl_add_u32 v25, v26, 9, v25
    v_lshrrev_b32 v24, 1, v24
    v_lshl_add_u32 v25, v24, 6, v25
    s_add_u32 s20, s20, 39780352
    buffer_load_dwordx4 v[32:35], v25, s[8:11], s20 offen sc1
    s_add_u32 s20, s20, 16384
    buffer_load_dwordx4 v[36:39], v25, s[8:11], s20 offen sc1
    s_add_u32 s20, s20, 16384
    buffer_load_dwordx4 v[40:43], v25, s[8:11], s20 offen sc1
    s_add_u32 s20, s20, 16384
    buffer_load_dwordx4 v[44:47], v25, s[8:11], s20 offen sc1
    s_add_u32 s20, s20, 16384
    buffer_load_dwordx4 v[48:51], v25, s[8:11], s20 offen sc1
    s_add_u32 s20, s20, 16384
    buffer_load_dwordx4 v[52:55], v25, s[8:11], s20 offen sc1
    s_add_u32 s20, s20, 16384
    buffer_load_dwordx4 v[56:59], v25, s[8:11], s20 offen sc1
    s_add_u32 s20, s20, 16384
    buffer_load_dwordx4 v[60:63], v25, s[8:11], s20 offen sc1
    s_add_u32 s20, s20, 16384
    buffer_load_dwordx4 v[64:67], v25, s[8:11], s20 offen sc1
    s_add_u32 s20, s20, 16384
    buffer_load_dwordx4 v[68:71], v25, s[8:11], s20 offen sc1
    s_add_u32 s20, s20, 16384
    buffer_load_dwordx4 v[72:75], v25, s[8:11], s20 offen sc1
    s_add_u32 s20, s20, 16384
    buffer_load_dwordx4 v[76:79], v25, s[8:11], s20 offen sc1
    s_add_u32 s20, s20, 16384
    buffer_load_dwordx4 v[80:83], v25, s[8:11], s20 offen sc1
    s_add_u32 s20, s20, 16384
    buffer_load_dwordx4 v[84:87], v25, s[8:11], s20 offen sc1
    s_add_u32 s20, s20, 16384
    buffer_load_dwordx4 v[88:91], v25, s[8:11], s20 offen sc1
    s_add_u32 s20, s20, 16384
    buffer_load_dwordx4 v[92:95], v25, s[8:11], s20 offen sc1
    s_add_u32 s20, s20, 16384
    buffer_load_dwordx4 v[96:99], v25, s[8:11], s20 offen sc1
    s_add_u32 s20, s20, 16384
    buffer_load_dwordx4 v[100:103], v25, s[8:11], s20 offen sc1
    s_add_u32 s20, s20, 16384
    buffer_load_dwordx4 v[104:107], v25, s[8:11], s20 offen sc1
    s_add_u32 s20, s20, 16384
    buffer_load_dwordx4 v[108:111], v25, s[8:11], s20 offen sc1
    s_add_u32 s20, s20, 16384
    s_mov_b32 exec_hi, -1
ch_3038:
    s_barrier
    s_cmp_lg_u32 s16, 7
    s_cbranch_scc1 go_3039
    s_mov_b32 s74, 300000
poll_3040:
    s_mov_b32 s75, 0
    s_atomic_add s75, s[4:5], s50 glc
    s_waitcnt lgkmcnt(0)
    s_cmp_ge_u32 s75, 16
    s_cbranch_scc1 poll_3040_x
    s_sub_u32 s74, s74, 1
    s_cmp_lg_u32 s74, 0
    s_cbranch_scc1 poll_3040
poll_3040_x:
go_3039_k:
    s_add_u32 s50, s50, 4096
go_3039:
    s_barrier
    s_cmp_eq_u32 s16, 7
    s_cbranch_scc1 st_3041
    s_mul_i32 s20, s19, 131072
    s_add_u32 s20, s20, 28704768
    s_lshl_b32 s21, s17, 13
    s_add_u32 s20, s20, s21
    s_add_u32 s21, s20, 4096
    buffer_load_dwordx4 v[16:19], v1, s[8:11], s20 offen offset:0 sc1
    buffer_load_dwordx4 v[20:23], v1, s[8:11], s20 offen offset:1024 sc1
    buffer_load_dwordx4 v[24:27], v1, s[8:11], s20 offen offset:2048 sc1
    buffer_load_dwordx4 v[28:31], v1, s[8:11], s20 offen offset:3072 sc1
    buffer_load_dwordx4 v[32:35], v1, s[8:11], s21 offen offset:0 sc1
    buffer_load_dwordx4 v[36:39], v1, s[8:11], s21 offen offset:1024 sc1
    buffer_load_dwordx4 v[40:43], v1, s[8:11], s21 offen offset:2048 sc1
    buffer_load_dwordx4 v[44:47], v1, s[8:11], s21 offen offset:3072 sc1
st_3041:
    s_cmp_lg_u32 s19, 0
    s_cbranch_scc1 ch_3042
    s_cmp_lg_u32 s16, 7
    s_cbranch_scc1 ch_3042
    s_waitcnt vmcnt(0)
    v_add_f32 v32, v32, v36
    v_add_f32 v33, v33, v37
    v_add_f32 v34, v34, v38
    v_add_f32 v35, v35, v39
    v_add_f32 v32, v32, v40
    v_add_f32 v33, v33, v41
    v_add_f32 v34, v34, v42
    v_add_f32 v35, v35, v43
    v_add_f32 v32, v32, v44
    v_add_f32 v33, v33, v45
    v_add_f32 v34, v34, v46
    v_add_f32 v35, v35, v47
    v_add_f32 v32, v32, v48
    v_add_f32 v33, v33, v49
    v_add_f32 v34, v34, v50
    v_add_f32 v35, v35, v51
    v_add_f32 v32, v32, v52
    v_add_f32 v33, v33, v53
    v_add_f32 v34, v34, v54
    v_add_f32 v35, v35, v55
    v_add_f32 v32, v32, v56
    v_add_f32 v33, v33, v57
    v_add_f32 v34, v34, v58
    v_add_f32 v35, v35, v59
    v_add_f32 v32, v32, v60
    v_add_f32 v33, v33, v61
    v_add_f32 v34, v34, v62
    v_add_f32 v35, v35, v63
    v_add_f32 v32, v32, v64
    v_add_f32 v33, v33, v65
    v_add_f32 v34, v34, v66
    v_add_f32 v35, v35, v67
    v_add_f32 v32, v32, v68
    v_add_f32 v33, v33, v69
    v_add_f32 v34, v34, v70
    v_add_f32 v35, v35, v71
    v_add_f32 v32, v32, v72
    v_add_f32 v33, v33, v73
    v_add_f32 v34, v34, v74
    v_add_f32 v35, v35, v75
ch_3042:
    s_cmp_lg_u32 s19, 0
    s_cbranch_scc1 pf_3043
    global_load_dword v12, v15, s[86:87]
pf_3043:
    s_barrier
    s_cmp_eq_u32 s16, 7
    s_cbranch_scc1 ch_3044
    s_waitcnt vmcnt(0)
    v_add_f32 v16, v16, v32
    v_add_f32 v17, v17, v33
    v_add_f32 v18, v18, v34
    v_add_f32 v19, v19, v35
    v_add_f32 v20, v20, v36
    v_add_f32 v21, v21, v37
    v_add_f32 v22, v22, v38
    v_add_f32 v23, v23, v39
    v_add_f32 v24, v24, v40
    v_add_f32 v25, v25, v41
    v_add_f32 v26, v26, v42
    v_add_f32 v27, v27, v43
    v_add_f32 v28, v28, v44
    v_add_f32 v29, v29, v45
    v_add_f32 v30, v30, v46
    v_add_f32 v31, v31, v47
    v_add_f32 v16, v16, v24
    v_add_f32 v17, v17, v25
    v_add_f32 v18, v18, v26
    v_add_f32 v19, v19, v27
    v_add_f32 v20, v20, v28
    v_add_f32 v21, v21, v29
    v_add_f32 v22, v22, v30
    v_add_f32 v23, v23, v31
    v_add_f32 v16, v16, v20
    v_add_f32 v17, v17, v21
    v_add_f32 v18, v18, v22
    v_add_f32 v19, v19, v23
    s_mov_b32 s22, 0x3acccccd
    v_mul_f32 v16, s22, v16
    v_mul_f32 v18, s22, v18
    v_mul_f32 v20, v16, v16
    v_mul_f32 v21, v18, v18
    v_fma_f32 v20, v17, s22, -v20
    v_fma_f32 v21, v19, s22, -v21
    v_max_f32 v20, 0, v20
    v_max_f32 v21, 0, v21
    v_add_f32 v20, 0x3727c5ac, v20
    v_add_f32 v21, 0x3727c5ac, v21
    v_rsq_f32 v22, v20
    v_rsq_f32 v23, v21
    v_sub_f32 v24, 0, v16
    v_sub_f32 v25, 0, v18
    v_lshrrev_b32 v26, 1, v1
    v_add_u32 v26, 155648, v26
    v_mul_f32 v28, 1069066811, v22
    v_mul_f32 v29, 1069066811, v23
    ds_write_b64 v26, v[24:25]
    ds_write_b64 v26, v[22:23] offset:512
    ds_write_b64 v26, v[28:29] offset:5120
    ds_write_b64 v26, v[20:21] offset:5632
ch_3044:
    s_cmp_lg_u32 s19, 0
    s_cbranch_scc1 ch_3045
    s_cmp_lg_u32 s16, 7
    s_cbranch_scc1 ch_3045
    v_add_f32 v32, v32, v76
    v_add_f32 v33, v33, v77
    v_add_f32 v34, v34, v78
    v_add_f32 v35, v35, v79
    v_add_f32 v32, v32, v80
    v_add_f32 v33, v33, v81
    v_add_f32 v34, v34, v82
    v_add_f32 v35, v35, v83
    v_add_f32 v32, v32, v84
    v_add_f32 v33, v33, v85
    v_add_f32 v34, v34, v86
    v_add_f32 v35, v35, v87
    v_add_f32 v32, v32, v88
    v_add_f32 v33, v33, v89
    v_add_f32 v34, v34, v90
    v_add_f32 v35, v35, v91
    v_add_f32 v32, v32, v92
    v_add_f32 v33, v33, v93
    v_add_f32 v34, v34, v94
    v_add_f32 v35, v35, v95
    v_add_f32 v32, v32, v96
    v_add_f32 v33, v33, v97
    v_add_f32 v34, v34, v98
    v_add_f32 v35, v35, v99
    v_add_f32 v32, v32, v100
    v_add_f32 v33, v33, v101
    v_add_f32 v34, v34, v102
    v_add_f32 v35, v35, v103
    v_add_f32 v32, v32, v104
    v_add_f32 v33, v33, v105
    v_add_f32 v34, v34, v106
    v_add_f32 v35, v35, v107
    v_add_f32 v32, v32, v108
    v_add_f32 v33, v33, v109
    v_add_f32 v34, v34, v110
    v_add_f32 v35, v35, v111
    v_add_u32 v26, 157184, v1
    s_mov_b32 exec_hi, 65535
    ds_write_b128 v26, v[32:35]
    s_mov_b64 exec, -1
ch_3045:
    s_barrier
    s_waitcnt lgkmcnt(0)
    s_waitcnt lgkmcnt(0)
    s_barrier
    s_cmp_lg_u32 s19, 0
    s_cbranch_scc1 pf_3046
    global_load_dword v12, v15, s[86:87]
pf_3046:
    s_barrier
    s_barrier
    s_barrier
    s_barrier
    s_call_b64 s[38:39], sub_p4a
    s_call_b64 s[38:39], sub_p4r0
    s_cmp_lg_u32 s19, 0
    s_cbranch_scc1 pf_3047
    global_load_dword v12, v15, s[86:87]
pf_3047:
    s_barrier
    s_call_b64 s[38:39], sub_p4r1
    s_barrier
    s_cmp_lg_u32 s16, 7
    s_cbranch_scc1 go_3048
    s_mov_b32 s72, 1
    s_atomic_add s72, s[4:5], s51
    s_add_u32 s51, s51, 4096
go_3048:
    s_cmp_lg_u32 s16, 7
    s_cbranch_scc1 go_3049
    s_mov_b32 s74, 300000
poll_3050:
    s_mov_b32 s75, 0
    s_atomic_add s75, s[4:5], s50 glc
    s_waitcnt lgkmcnt(0)
    s_cmp_ge_u32 s75, 16
    s_cbranch_scc1 poll_3050_x
    s_sub_u32 s74, s74, 1
    s_cmp_lg_u32 s74, 0
    s_cbranch_scc1 poll_3050
poll_3050_x:
go_3049_k:
    s_add_u32 s50, s50, 4096
go_3049:
    s_call_b64 s[38:39], sub_p4r2
    s_call_b64 s[38:39], sub_p4r3
    s_barrier
    s_barrier
    s_cmp_lg_u32 s19, 0
    s_cbranch_scc1 pf_3051
    global_load_dword v12, v15, s[86:87]
pf_3051:
    s_barrier
    s_cmp_lg_u32 s16, 7
    s_cbranch_scc1 go_3052
    s_mov_b32 s72, 1
    s_atomic_add s72, s[4:5], s51
    s_add_u32 s51, s51, 8192
    s_add_u32 s50, s50, 8192
go_3052:
    s_waitcnt vmcnt(0)
    s_call_b64 s[48:49], y_p4
    s_cmp_lg_u32 s19, 0
    s_cbranch_scc1 main_kernel_end
    s_mov_b32 s19, 1
    s_branch main_kernel_mloop
sub_p4a:
    s_sub_u32 s20, s16, 4
    s_and_b32 s21, s20, 1
    s_lshr_b32 s32, s20, 1
    s_lshl_b32 s27, s21, 1
    s_add_u32 s27, s27, s32
    v_bfe_u32 v5, v1, 4, 4
    v_bfe_u32 v6, v1, 8, 2
    s_lshl_b32 s22, s21, 2
    s_add_u32 s22, s22, s27
    s_lshl_b32 s22, s22, 10
    v_add_u32 v2, s22, v1
    v_xor_b32 v7, 1024, v2
    v_xor_b32 v8, 2048, v2
    v_xor_b32 v9, 3072, v2
    s_lshl_b32 s22, s21, 10
    s_add_u32 s23, s22, 114688
    v_add_u32 v3, s23, v1
    s_add_u32 s23, s22, 65536
    v_add_u32 v4, s23, v1
    s_lshl_b32 s22, s27, 11
    s_add_u32 s23, s22, 73728
    v_add_u32 v11, s23, v1
    s_lshr_b32 s26, s18, 1
    s_mul_i32 s23, s26, 245760
    s_add_u32 s23, s23, s22
    s_add_u32 s23, s23, 37601280
    s_and_b32 s28, s18, 1
    s_lshl_b32 s28, s28, 2
    s_add_u32 s27, s27, s28
    v_and_b32 v10, 1, v6
    v_lshlrev_b32 v10, 3, v10
    s_mul_i32 s24, s19, 2621440
    s_add_u32 s24, s24, 10616832
    s_mul_i32 s25, s17, 163840
    s_lshl_b32 s28, s27, 10
    s_add_u32 s25, s25, s28
    s_add_u32 s24, s24, s25
    s_lshl_b32 s28, s26, 13
    v_add_u32 v68, s28, v1
    v_add_u32 v69, 65536, v68
    s_lshr_b32 s28, s26, 1
    s_lshl_b32 s28, s28, 4
    s_and_b32 s29, s26, 1
    s_add_u32 s28, s28, s29
    s_lshl_b32 s28, s28, 9
    s_add_u32 s28, s28, 131072
    v_lshrrev_b32 v70, 1, v6
    v_lshl_add_u32 v70, v70, 8, s28
    v_lshl_add_u32 v70, v5, 4, v70
    v_add_u32 v70, v70, v10
    s_lshl_b32 s28, s32, 16
    s_add_u32 s28, s28, s24
    s_xor_b32 s29, s28, 1024
    buffer_load_dwordx4 v[56:59], v68, s[8:11], s28 offen sc1
    buffer_load_dwordx4 v[60:63], v68, s[8:11], s29 offen sc1
    buffer_load_dwordx2 v[64:65], v70, s[8:11], s24 offen sc1
    s_setpc_b64 s[38:39]
sub_p4r0:
    s_cmp_lg_u32 s19, 0
    s_cbranch_scc1 sub_p4r0_e
    s_add_u32 s21, s23, 0
    buffer_load_dwordx4 v[96:99], v1, s[8:11], s21 offen offset:0 sc1
    buffer_load_dwordx4 v[100:103], v1, s[8:11], s21 offen offset:1024 sc1
    s_add_u32 s21, s23, 8192
    buffer_load_dwordx4 v[104:107], v1, s[8:11], s21 offen offset:0 sc1
    buffer_load_dwordx4 v[108:111], v1, s[8:11], s21 offen offset:1024 sc1
    s_add_u32 s21, s23, 16384
    buffer_load_dwordx4 v[112:115], v1, s[8:11], s21 offen offset:0 sc1
    buffer_load_dwordx4 v[116:119], v1, s[8:11], s21 offen offset:1024 sc1
    s_add_u32 s21, s23, 24576
    buffer_load_dwordx4 v[120:123], v1, s[8:11], s21 offen offset:0 sc1
    buffer_load_dwordx4 v[124:127], v1, s[8:11], s21 offen offset:1024 sc1
sub_p4r0_e:
    s_setpc_b64 s[38:39]
sub_p4r1:
    s_cmp_lg_u32 s19, 0
    s_cbranch_scc1 sub_p4r1_e
    s_add_u32 s21, s23, 32768
    buffer_load_dwordx4 v[128:131], v1, s[8:11], s21 offen offset:0 sc1
    buffer_load_dwordx4 v[132:135], v1, s[8:11], s21 offen offset:1024 sc1
    s_add_u32 s21, s23, 40960
    buffer_load_dwordx4 v[136:139], v1, s[8:11], s21 offen offset:0 sc1
    buffer_load_dwordx4 v[140:143], v1, s[8:11], s21 offen offset:1024 sc1
    s_add_u32 s21, s23, 49152
    buffer_load_dwordx4 v[144:147], v1, s[8:11], s21 offen offset:0 sc1
    buffer_load_dwordx4 v[148:151], v1, s[8:11], s21 offen offset:1024 sc1
    s_add_u32 s21, s23, 57344
    buffer_load_dwordx4 v[152:155], v1, s[8:11], s21 offen offset:0 sc1
    buffer_load_dwordx4 v[156:159], v1, s[8:11], s21 offen offset:1024 sc1
sub_p4r1_e:
    s_setpc_b64 s[38:39]
sub_p4r2:
    s_cmp_lg_u32 s19, 0
    s_cbranch_scc1 sub_p4r2_e
    s_add_u32 s21, s23, 65536
    buffer_load_dwordx4 v[160:163], v1, s[8:11], s21 offen offset:0 sc1
    buffer_load_dwordx4 v[164:167], v1, s[8:11], s21 offen offset:1024 sc1
    s_add_u32 s21, s23, 73728
    buffer_load_dwordx4 v[168:171], v1, s[8:11], s21 offen offset:0 sc1
    buffer_load_dwordx4 v[172:175], v1, s[8:11], s21 offen offset:1024 sc1
    s_add_u32 s21, s23, 81920
    buffer_load_dwordx4 v[176:179], v1, s[8:11], s21 offen offset:0 sc1
    buffer_load_dwordx4 v[180:183], v1, s[8:11], s21 offen offset:1024 sc1
    s_add_u32 s21, s23, 90112
    buffer_load_dwordx4 v[184:187], v1, s[8:11], s21 offen offset:0 sc1
    buffer_load_dwordx4 v[188:191], v1, s[8:11], s21 offen offset:1024 sc1
sub_p4r2_e:
    s_setpc_b64 s[38:39]
sub_p4r3:
    s_cmp_lg_u32 s19, 0
    s_cbranch_scc1 sub_p4r3_e
    s_add_u32 s21, s23, 98304
    buffer_load_dwordx4 v[192:195], v1, s[8:11], s21 offen offset:0 sc1
    buffer_load_dwordx4 v[196:199], v1, s[8:11], s21 offen offset:1024 sc1
    s_add_u32 s21, s23, 106496
    buffer_load_dwordx4 v[200:203], v1, s[8:11], s21 offen offset:0 sc1
    buffer_load_dwordx4 v[204:207], v1, s[8:11], s21 offen offset:1024 sc1
    s_add_u32 s21, s23, 114688
    buffer_load_dwordx4 v[208:211], v1, s[8:11], s21 offen offset:0 sc1
    buffer_load_dwordx4 v[212:215], v1, s[8:11], s21 offen offset:1024 sc1
    s_add_u32 s21, s23, 122880
    buffer_load_dwordx4 v[216:219], v1, s[8:11], s21 offen offset:0 sc1
    buffer_load_dwordx4 v[220:223], v1, s[8:11], s21 offen offset:1024 sc1
sub_p4r3_e:
    s_setpc_b64 s[38:39]
sub_p4r4:
    s_cmp_lg_u32 s19, 0
    s_cbranch_scc1 sub_p4r4_e
    s_add_u32 s21, s23, 131072
    buffer_load_dwordx4 v[224:227], v1, s[8:11], s21 offen offset:0 sc1
    buffer_load_dwordx4 v[228:231], v1, s[8:11], s21 offen offset:1024 sc1
    s_add_u32 s21, s23, 139264
    buffer_load_dwordx4 v[232:235], v1, s[8:11], s21 offen offset:0 sc1
    buffer_load_dwordx4 v[236:239], v1, s[8:11], s21 offen offset:1024 sc1
    s_add_u32 s21, s23, 147456
    buffer_load_dwordx4 v[240:243], v1, s[8:11], s21 offen offset:0 sc1
    buffer_load_dwordx4 v[244:247], v1, s[8:11], s21 offen offset:1024 sc1
    s_add_u32 s21, s23, 155648
    buffer_load_dwordx4 v[248:251], v1, s[8:11], s21 offen offset:0 sc1
    buffer_load_dwordx4 v[252:255], v1, s[8:11], s21 offen offset:1024 sc1
sub_p4r4_e:
    s_setpc_b64 s[38:39]
y_p4:
    v_lshlrev_b32 v16, 16, v56
    v_and_b32 v17, 0xffff0000, v56
    v_lshlrev_b32 v18, 16, v57
    v_and_b32 v19, 0xffff0000, v57
    v_lshlrev_b32 v20, 16, v58
    v_and_b32 v21, 0xffff0000, v58
    v_lshlrev_b32 v22, 16, v59
    v_and_b32 v23, 0xffff0000, v59
    v_lshlrev_b32 v24, 16, v60
    v_and_b32 v25, 0xffff0000, v60
    v_lshlrev_b32 v26, 16, v61
    v_and_b32 v27, 0xffff0000, v61
    v_lshlrev_b32 v28, 16, v62
    v_and_b32 v29, 0xffff0000, v62
    v_lshlrev_b32 v30, 16, v63
    v_and_b32 v31, 0xffff0000, v63
    v_lshlrev_b32 v32, 16, v64
    v_and_b32 v33, 0xffff0000, v64
    v_lshlrev_b32 v34, 16, v65
    v_and_b32 v35, 0xffff0000, v65
    s_setprio 0
    s_barrier
    ds_read_b128 v[56:59], v2 offset:32768
    ds_read_b128 v[60:63], v3 offset:0
    ds_read_b128 v[64:67], v7 offset:32768
    ds_read_b128 v[68:71], v8 offset:32768
    ds_read_b128 v[72:75], v9 offset:32768
    ds_read_b128 v[76:79], v2 offset:40960
    ds_read_b128 v[80:83], v3 offset:2048
    ds_read_b128 v[84:87], v7 offset:40960
    ds_read_b128 v[88:91], v8 offset:40960
    ds_read_b128 v[92:95], v9 offset:40960
    s_waitcnt lgkmcnt(9)
    v_mfma_f32_16x16x32_bf16 v[16:19], v[96:99], v[56:59], v[16:19]
    v_mfma_f32_16x16x32_bf16 v[20:23], v[100:103], v[56:59], v[20:23]
    s_waitcnt lgkmcnt(8)
    v_mfma_f32_16x16x32_bf16 v[32:35], v[60:63], v[56:59], v[32:35]
    ds_read_b128 v[56:59], v2 offset:49152
    s_waitcnt lgkmcnt(8)
    v_mfma_f32_16x16x32_bf16 v[24:27], v[96:99], v[64:67], v[24:27]
    v_mfma_f32_16x16x32_bf16 v[28:31], v[100:103], v[64:67], v[28:31]
    ds_read_b128 v[64:67], v3 offset:4096
    s_waitcnt lgkmcnt(8)
    v_mfma_f32_16x16x32_bf16 v[36:39], v[96:99], v[68:71], 0
    v_mfma_f32_16x16x32_bf16 v[40:43], v[100:103], v[68:71], 0
    v_mfma_f32_16x16x32_bf16 v[52:55], v[60:63], v[68:71], 0
    ds_read_b128 v[60:63], v7 offset:49152
    s_waitcnt lgkmcnt(8)
    v_mfma_f32_16x16x32_bf16 v[44:47], v[96:99], v[72:75], 0
    ds_read_b128 v[68:71], v8 offset:49152
    v_mfma_f32_16x16x32_bf16 v[48:51], v[100:103], v[72:75], 0
    ds_read_b128 v[72:75], v9 offset:49152
    s_waitcnt lgkmcnt(9)
    v_mfma_f32_16x16x32_bf16 v[16:19], v[104:107], v[76:79], v[16:19]
    v_mfma_f32_16x16x32_bf16 v[20:23], v[108:111], v[76:79], v[20:23]
    s_waitcnt lgkmcnt(8)
    v_mfma_f32_16x16x32_bf16 v[32:35], v[80:83], v[76:79], v[32:35]
    ds_read_b128 v[76:79], v2 offset:57344
    s_waitcnt lgkmcnt(8)
    v_mfma_f32_16x16x32_bf16 v[24:27], v[104:107], v[84:87], v[24:27]
    v_mfma_f32_16x16x32_bf16 v[28:31], v[108:111], v[84:87], v[28:31]
    ds_read_b128 v[84:87], v3 offset:6144
    s_waitcnt lgkmcnt(8)
    v_mfma_f32_16x16x32_bf16 v[36:39], v[104:107], v[88:91], v[36:39]
    v_mfma_f32_16x16x32_bf16 v[40:43], v[108:111], v[88:91], v[40:43]
    v_mfma_f32_16x16x32_bf16 v[52:55], v[80:83], v[88:91], v[52:55]
    ds_read_b128 v[80:83], v7 offset:57344
    s_waitcnt lgkmcnt(8)
    v_mfma_f32_16x16x32_bf16 v[44:47], v[104:107], v[92:95], v[44:47]
    ds_read_b128 v[88:91], v8 offset:57344
    v_mfma_f32_16x16x32_bf16 v[48:51], v[108:111], v[92:95], v[48:51]
    ds_read_b128 v[92:95], v9 offset:57344
    s_waitcnt lgkmcnt(9)
    v_mfma_f32_16x16x32_bf16 v[16:19], v[112:115], v[56:59], v[16:19]
    v_mfma_f32_16x16x32_bf16 v[20:23], v[116:119], v[56:59], v[20:23]
    s_waitcnt lgkmcnt(8)
    v_mfma_f32_16x16x32_bf16 v[32:35], v[64:67], v[56:59], v[32:35]
    s_waitcnt lgkmcnt(7)
    v_mfma_f32_16x16x32_bf16 v[24:27], v[112:115], v[60:63], v[24:27]
    v_mfma_f32_16x16x32_bf16 v[28:31], v[116:119], v[60:63], v[28:31]
    s_waitcnt lgkmcnt(6)
    v_mfma_f32_16x16x32_bf16 v[36:39], v[112:115], v[68:71], v[36:39]
    v_mfma_f32_16x16x32_bf16 v[40:43], v[116:119], v[68:71], v[40:43]
    v_mfma_f32_16x16x32_bf16 v[52:55], v[64:67], v[68:71], v[52:55]
    s_waitcnt lgkmcnt(5)
    v_mfma_f32_16x16x32_bf16 v[44:47], v[112:115], v[72:75], v[44:47]
    v_mfma_f32_16x16x32_bf16 v[48:51], v[116:119], v[72:75], v[48:51]
    s_waitcnt lgkmcnt(4)
    v_mfma_f32_16x16x32_bf16 v[16:19], v[120:123], v[76:79], v[16:19]
    v_mfma_f32_16x16x32_bf16 v[20:23], v[124:127], v[76:79], v[20:23]
    s_waitcnt lgkmcnt(3)
    v_mfma_f32_16x16x32_bf16 v[32:35], v[84:87], v[76:79], v[32:35]
    s_waitcnt lgkmcnt(2)
    v_mfma_f32_16x16x32_bf16 v[24:27], v[120:123], v[80:83], v[24:27]
    v_mfma_f32_16x16x32_bf16 v[28:31], v[124:127], v[80:83], v[28:31]
    s_waitcnt vmcnt(0)
    s_waitcnt lgkmcnt(0)
    s_barrier
    v_mfma_f32_16x16x32_bf16 v[36:39], v[120:123], v[88:91], v[36:39]
    ds_read_b128 v[56:59], v2 offset:0
    v_mfma_f32_16x16x32_bf16 v[40:43], v[124:127], v[88:91], v[40:43]
    ds_read_b128 v[60:63], v3 offset:8192
    v_mfma_f32_16x16x32_bf16 v[52:55], v[84:87], v[88:91], v[52:55]
    ds_read_b128 v[64:67], v7 offset:0
    v_mfma_f32_16x16x32_bf16 v[44:47], v[120:123], v[92:95], v[44:47]
    ds_read_b128 v[68:71], v8 offset:0
    v_mfma_f32_16x16x32_bf16 v[48:51], v[124:127], v[92:95], v[48:51]
    ds_read_b128 v[72:75], v9 offset:0
    s_waitcnt lgkmcnt(4)
    v_mfma_f32_16x16x32_bf16 v[16:19], v[128:131], v[56:59], v[16:19]
    ds_read_b128 v[76:79], v2 offset:8192
    v_mfma_f32_16x16x32_bf16 v[20:23], v[132:135], v[56:59], v[20:23]
    ds_read_b128 v[80:83], v3 offset:10240
    s_waitcnt lgkmcnt(5)
    v_mfma_f32_16x16x32_bf16 v[32:35], v[60:63], v[56:59], v[32:35]
    ds_read_b128 v[84:87], v7 offset:8192
    s_waitcnt lgkmcnt(5)
    v_mfma_f32_16x16x32_bf16 v[24:27], v[128:131], v[64:67], v[24:27]
    ds_read_b128 v[88:91], v8 offset:8192
    v_mfma_f32_16x16x32_bf16 v[28:31], v[132:135], v[64:67], v[28:31]
    ds_read_b128 v[92:95], v9 offset:8192
    s_waitcnt lgkmcnt(6)
    v_mfma_f32_16x16x32_bf16 v[36:39], v[128:131], v[68:71], v[36:39]
    v_mfma_f32_16x16x32_bf16 v[40:43], v[132:135], v[68:71], v[40:43]
    v_mfma_f32_16x16x32_bf16 v[52:55], v[60:63], v[68:71], v[52:55]
    s_waitcnt lgkmcnt(5)
    v_mfma_f32_16x16x32_bf16 v[44:47], v[128:131], v[72:75], v[44:47]
    v_mfma_f32_16x16x32_bf16 v[48:51], v[132:135], v[72:75], v[48:51]
    s_waitcnt lgkmcnt(4)
    v_mfma_f32_16x16x32_bf16 v[16:19], v[136:139], v[76:79], v[16:19]
    v_mfma_f32_16x16x32_bf16 v[20:23], v[140:143], v[76:79], v[20:23]
    s_waitcnt lgkmcnt(0)
    s_barrier
    v_mfma_f32_16x16x32_bf16 v[32:35], v[80:83], v[76:79], v[32:35]
    ds_read_b128 v[56:59], v2 offset:16384
    v_mfma_f32_16x16x32_bf16 v[24:27], v[136:139], v[84:87], v[24:27]
    ds_read_b128 v[64:67], v3 offset:12288
    v_mfma_f32_16x16x32_bf16 v[28:31], v[140:143], v[84:87], v[28:31]
    ds_read_b128 v[60:63], v7 offset:16384
    v_mfma_f32_16x16x32_bf16 v[36:39], v[136:139], v[88:91], v[36:39]
    ds_read_b128 v[68:71], v8 offset:16384
    v_mfma_f32_16x16x32_bf16 v[40:43], v[140:143], v[88:91], v[40:43]
    ds_read_b128 v[72:75], v9 offset:16384
    v_mfma_f32_16x16x32_bf16 v[52:55], v[80:83], v[88:91], v[52:55]
    ds_read_b128 v[76:79], v2 offset:24576
    v_mfma_f32_16x16x32_bf16 v[44:47], v[136:139], v[92:95], v[44:47]
    ds_read_b128 v[84:87], v3 offset:14336
    v_mfma_f32_16x16x32_bf16 v[48:51], v[140:143], v[92:95], v[48:51]
    ds_read_b128 v[80:83], v7 offset:24576
    s_waitcnt lgkmcnt(7)
    v_mfma_f32_16x16x32_bf16 v[16:19], v[144:147], v[56:59], v[16:19]
    ds_read_b128 v[88:91], v8 offset:24576
    v_mfma_f32_16x16x32_bf16 v[20:23], v[148:151], v[56:59], v[20:23]
    ds_read_b128 v[92:95], v9 offset:24576
    s_waitcnt lgkmcnt(8)
    v_mfma_f32_16x16x32_bf16 v[32:35], v[64:67], v[56:59], v[32:35]
    s_waitcnt lgkmcnt(7)
    v_mfma_f32_16x16x32_bf16 v[24:27], v[144:147], v[60:63], v[24:27]
    v_mfma_f32_16x16x32_bf16 v[28:31], v[148:151], v[60:63], v[28:31]
    s_waitcnt lgkmcnt(6)
    v_mfma_f32_16x16x32_bf16 v[36:39], v[144:147], v[68:71], v[36:39]
    v_mfma_f32_16x16x32_bf16 v[40:43], v[148:151], v[68:71], v[40:43]
    v_mfma_f32_16x16x32_bf16 v[52:55], v[64:67], v[68:71], v[52:55]
    s_waitcnt lgkmcnt(5)
    v_mfma_f32_16x16x32_bf16 v[44:47], v[144:147], v[72:75], v[44:47]
    v_mfma_f32_16x16x32_bf16 v[48:51], v[148:151], v[72:75], v[48:51]
    s_waitcnt lgkmcnt(4)
    v_mfma_f32_16x16x32_bf16 v[16:19], v[152:155], v[76:79], v[16:19]
    s_call_b64 s[38:39], sub_p4r4
    v_mfma_f32_16x16x32_bf16 v[20:23], v[156:159], v[76:79], v[20:23]
    s_waitcnt lgkmcnt(0)
    s_barrier
    v_mfma_f32_16x16x32_bf16 v[32:35], v[84:87], v[76:79], v[32:35]
    ds_read_b128 v[56:59], v2 offset:32768
    v_mfma_f32_16x16x32_bf16 v[24:27], v[152:155], v[80:83], v[24:27]
    ds_read_b128 v[60:63], v3 offset:16384
    v_mfma_f32_16x16x32_bf16 v[28:31], v[156:159], v[80:83], v[28:31]
    ds_read_b128 v[64:67], v7 offset:32768
    v_mfma_f32_16x16x32_bf16 v[36:39], v[152:155], v[88:91], v[36:39]
    ds_read_b128 v[68:71], v8 offset:32768
    v_mfma_f32_16x16x32_bf16 v[40:43], v[156:159], v[88:91], v[40:43]
    ds_read_b128 v[72:75], v9 offset:32768
    v_mfma_f32_16x16x32_bf16 v[52:55], v[84:87], v[88:91], v[52:55]
    ds_read_b128 v[76:79], v2 offset:40960
    v_mfma_f32_16x16x32_bf16 v[44:47], v[152:155], v[92:95], v[44:47]
    ds_read_b128 v[80:83], v3 offset:18432
    v_mfma_f32_16x16x32_bf16 v[48:51], v[156:159], v[92:95], v[48:51]
    ds_read_b128 v[84:87], v7 offset:40960
    s_waitcnt lgkmcnt(7)
    v_mfma_f32_16x16x32_bf16 v[16:19], v[160:163], v[56:59], v[16:19]
    ds_read_b128 v[88:91], v8 offset:40960
    v_mfma_f32_16x16x32_bf16 v[20:23], v[164:167], v[56:59], v[20:23]
    ds_read_b128 v[92:95], v9 offset:40960
    s_waitcnt lgkmcnt(8)
    v_mfma_f32_16x16x32_bf16 v[32:35], v[60:63], v[56:59], v[32:35]
    s_waitcnt lgkmcnt(7)
    v_mfma_f32_16x16x32_bf16 v[24:27], v[160:163], v[64:67], v[24:27]
    v_mfma_f32_16x16x32_bf16 v[28:31], v[164:167], v[64:67], v[28:31]
    s_waitcnt lgkmcnt(6)
    v_mfma_f32_16x16x32_bf16 v[36:39], v[160:163], v[68:71], v[36:39]
    v_mfma_f32_16x16x32_bf16 v[40:43], v[164:167], v[68:71], v[40:43]
    v_mfma_f32_16x16x32_bf16 v[52:55], v[60:63], v[68:71], v[52:55]
    s_waitcnt lgkmcnt(5)
    v_mfma_f32_16x16x32_bf16 v[44:47], v[160:163], v[72:75], v[44:47]
    v_mfma_f32_16x16x32_bf16 v[48:51], v[164:167], v[72:75], v[48:51]
    s_waitcnt lgkmcnt(4)
    v_mfma_f32_16x16x32_bf16 v[16:19], v[168:171], v[76:79], v[16:19]
    v_mfma_f32_16x16x32_bf16 v[20:23], v[172:175], v[76:79], v[20:23]
    s_waitcnt lgkmcnt(0)
    s_barrier
    v_mfma_f32_16x16x32_bf16 v[32:35], v[80:83], v[76:79], v[32:35]
    ds_read_b128 v[56:59], v2 offset:49152
    v_mfma_f32_16x16x32_bf16 v[24:27], v[168:171], v[84:87], v[24:27]
    ds_read_b128 v[64:67], v3 offset:20480
    v_mfma_f32_16x16x32_bf16 v[28:31], v[172:175], v[84:87], v[28:31]
    ds_read_b128 v[60:63], v7 offset:49152
    v_mfma_f32_16x16x32_bf16 v[36:39], v[168:171], v[88:91], v[36:39]
    ds_read_b128 v[68:71], v8 offset:49152
    v_mfma_f32_16x16x32_bf16 v[40:43], v[172:175], v[88:91], v[40:43]
    ds_read_b128 v[72:75], v9 offset:49152
    v_mfma_f32_16x16x32_bf16 v[52:55], v[80:83], v[88:91], v[52:55]
    ds_read_b128 v[76:79], v2 offset:57344
    v_mfma_f32_16x16x32_bf16 v[44:47], v[168:171], v[92:95], v[44:47]
    ds_read_b128 v[84:87], v3 offset:22528
    v_mfma_f32_16x16x32_bf16 v[48:51], v[172:175], v[92:95], v[48:51]
    ds_read_b128 v[80:83], v7 offset:57344
    s_waitcnt lgkmcnt(7)
    v_mfma_f32_16x16x32_bf16 v[16:19], v[176:179], v[56:59], v[16:19]
    ds_read_b128 v[88:91], v8 offset:57344
    v_mfma_f32_16x16x32_bf16 v[20:23], v[180:183], v[56:59], v[20:23]
    ds_read_b128 v[92:95], v9 offset:57344
    s_waitcnt lgkmcnt(8)
    v_mfma_f32_16x16x32_bf16 v[32:35], v[64:67], v[56:59], v[32:35]
    s_waitcnt lgkmcnt(7)
    v_mfma_f32_16x16x32_bf16 v[24:27], v[176:179], v[60:63], v[24:27]
    v_mfma_f32_16x16x32_bf16 v[28:31], v[180:183], v[60:63], v[28:31]
    s_waitcnt lgkmcnt(6)
    v_mfma_f32_16x16x32_bf16 v[36:39], v[176:179], v[68:71], v[36:39]
    v_mfma_f32_16x16x32_bf16 v[40:43], v[180:183], v[68:71], v[40:43]
    v_mfma_f32_16x16x32_bf16 v[52:55], v[64:67], v[68:71], v[52:55]
    s_waitcnt lgkmcnt(5)
    v_mfma_f32_16x16x32_bf16 v[44:47], v[176:179], v[72:75], v[44:47]
    v_mfma_f32_16x16x32_bf16 v[48:51], v[180:183], v[72:75], v[48:51]
    s_waitcnt lgkmcnt(4)
    v_mfma_f32_16x16x32_bf16 v[16:19], v[184:187], v[76:79], v[16:19]
    v_mfma_f32_16x16x32_bf16 v[20:23], v[188:191], v[76:79], v[20:23]
    s_waitcnt lgkmcnt(0)
    s_barrier
    v_mfma_f32_16x16x32_bf16 v[32:35], v[84:87], v[76:79], v[32:35]
    ds_read_b128 v[56:59], v2 offset:0
    v_mfma_f32_16x16x32_bf16 v[24:27], v[184:187], v[80:83], v[24:27]
    ds_read_b128 v[60:63], v3 offset:24576
    v_mfma_f32_16x16x32_bf16 v[28:31], v[188:191], v[80:83], v[28:31]
    ds_read_b128 v[64:67], v7 offset:0
    v_mfma_f32_16x16x32_bf16 v[36:39], v[184:187], v[88:91], v[36:39]
    ds_read_b128 v[68:71], v8 offset:0
    v_mfma_f32_16x16x32_bf16 v[40:43], v[188:191], v[88:91], v[40:43]
    ds_read_b128 v[72:75], v9 offset:0
    v_mfma_f32_16x16x32_bf16 v[52:55], v[84:87], v[88:91], v[52:55]
    ds_read_b128 v[76:79], v2 offset:8192
    v_mfma_f32_16x16x32_bf16 v[44:47], v[184:187], v[92:95], v[44:47]
    ds_read_b128 v[80:83], v3 offset:26624
    v_mfma_f32_16x16x32_bf16 v[48:51], v[188:191], v[92:95], v[48:51]
    ds_read_b128 v[84:87], v7 offset:8192
    s_waitcnt lgkmcnt(7)
    v_mfma_f32_16x16x32_bf16 v[16:19], v[192:195], v[56:59], v[16:19]
    ds_read_b128 v[88:91], v8 offset:8192
    v_mfma_f32_16x16x32_bf16 v[20:23], v[196:199], v[56:59], v[20:23]
    ds_read_b128 v[92:95], v9 offset:8192
    s_waitcnt lgkmcnt(8)
    v_mfma_f32_16x16x32_bf16 v[32:35], v[60:63], v[56:59], v[32:35]
    s_lshl_b32 s35, s17, 3
    s_waitcnt lgkmcnt(7)
    v_mfma_f32_16x16x32_bf16 v[24:27], v[192:195], v[64:67], v[24:27]
    s_add_u32 s35, s35, s27
    v_mfma_f32_16x16x32_bf16 v[28:31], v[196:199], v[64:67], v[28:31]
    s_xor_b32 s36, s35, 1
    s_waitcnt lgkmcnt(6)
    v_mfma_f32_16x16x32_bf16 v[36:39], v[192:195], v[68:71], v[36:39]
    s_mul_i32 s35, s35, 20480
    v_mfma_f32_16x16x32_bf16 v[40:43], v[196:199], v[68:71], v[40:43]
    s_mul_i32 s36, s36, 20480
    v_mfma_f32_16x16x32_bf16 v[52:55], v[60:63], v[68:71], v[52:55]
    s_add_u32 s24, s25, 2752512
    s_waitcnt lgkmcnt(5)
    v_mfma_f32_16x16x32_bf16 v[44:47], v[192:195], v[72:75], v[44:47]
    s_xor_b32 s25, s24, 1024
    v_mfma_f32_16x16x32_bf16 v[48:51], v[196:199], v[72:75], v[48:51]
    s_lshl_b32 s29, s17, 3
    s_waitcnt lgkmcnt(4)
    v_mfma_f32_16x16x32_bf16 v[16:19], v[200:203], v[76:79], v[16:19]
    s_add_u32 s29, s29, s26
    v_mfma_f32_16x16x32_bf16 v[20:23], v[204:207], v[76:79], v[20:23]
    s_lshl_b32 s29, s29, 10
    s_waitcnt lgkmcnt(0)
    s_barrier
    v_mfma_f32_16x16x32_bf16 v[32:35], v[80:83], v[76:79], v[32:35]
    ds_read_b128 v[56:59], v2 offset:16384
    s_mul_i32 s28, s32, 393216
    v_mfma_f32_16x16x32_bf16 v[24:27], v[200:203], v[84:87], v[24:27]
    ds_read_b128 v[64:67], v3 offset:28672
    s_add_u32 s28, s28, s29
    v_mfma_f32_16x16x32_bf16 v[28:31], v[204:207], v[84:87], v[28:31]
    ds_read_b128 v[60:63], v7 offset:16384
    s_add_u32 s28, s28, 28573696
    v_mfma_f32_16x16x32_bf16 v[36:39], v[200:203], v[88:91], v[36:39]
    ds_read_b128 v[68:71], v8 offset:16384
    s_lshl_b32 s29, s27, 7
    v_mfma_f32_16x16x32_bf16 v[40:43], v[204:207], v[88:91], v[40:43]
    ds_read_b128 v[72:75], v9 offset:16384
    s_add_u32 s28, s28, s29
    v_mfma_f32_16x16x32_bf16 v[52:55], v[80:83], v[88:91], v[52:55]
    ds_read_b128 v[76:79], v2 offset:24576
    s_xor_b32 s29, s28, 128
    v_mfma_f32_16x16x32_bf16 v[44:47], v[200:203], v[92:95], v[44:47]
    ds_read_b128 v[84:87], v3 offset:30720
    s_xor_b32 s22, s20, 1
    v_mfma_f32_16x16x32_bf16 v[48:51], v[204:207], v[92:95], v[48:51]
    ds_read_b128 v[80:83], v7 offset:24576
    s_mul_i32 s22, s22, 5120
    s_waitcnt lgkmcnt(7)
    v_mfma_f32_16x16x32_bf16 v[16:19], v[208:211], v[56:59], v[16:19]
    ds_read_b128 v[88:91], v8 offset:24576
    s_add_u32 s22, s22, 32768
    v_mfma_f32_16x16x32_bf16 v[20:23], v[212:215], v[56:59], v[20:23]
    ds_read_b128 v[92:95], v9 offset:24576
    v_add_u32 v12, s22, v1
    s_waitcnt lgkmcnt(8)
    v_mfma_f32_16x16x32_bf16 v[32:35], v[64:67], v[56:59], v[32:35]
    s_waitcnt lgkmcnt(7)
    v_mfma_f32_16x16x32_bf16 v[24:27], v[208:211], v[60:63], v[24:27]
    v_mfma_f32_16x16x32_bf16 v[28:31], v[212:215], v[60:63], v[28:31]
    s_waitcnt lgkmcnt(6)
    v_mfma_f32_16x16x32_bf16 v[36:39], v[208:211], v[68:71], v[36:39]
    v_mfma_f32_16x16x32_bf16 v[40:43], v[212:215], v[68:71], v[40:43]
    v_mfma_f32_16x16x32_bf16 v[52:55], v[64:67], v[68:71], v[52:55]
    s_waitcnt lgkmcnt(5)
    v_mfma_f32_16x16x32_bf16 v[44:47], v[208:211], v[72:75], v[44:47]
    v_mfma_f32_16x16x32_bf16 v[48:51], v[212:215], v[72:75], v[48:51]
    s_waitcnt lgkmcnt(4)
    v_mfma_f32_16x16x32_bf16 v[16:19], v[216:219], v[76:79], v[16:19]
    v_mfma_f32_16x16x32_bf16 v[20:23], v[220:223], v[76:79], v[20:23]
    s_waitcnt lgkmcnt(0)
    s_barrier
    v_mfma_f32_16x16x32_bf16 v[32:35], v[84:87], v[76:79], v[32:35]
    ds_read_b128 v[56:59], v2 offset:32768
    v_mfma_f32_16x16x32_bf16 v[24:27], v[216:219], v[80:83], v[24:27]
    ds_read_b128 v[60:63], v3 offset:32768
    v_mfma_f32_16x16x32_bf16 v[28:31], v[220:223], v[80:83], v[28:31]
    ds_read_b128 v[64:67], v7 offset:32768
    v_mfma_f32_16x16x32_bf16 v[36:39], v[216:219], v[88:91], v[36:39]
    ds_read_b128 v[68:71], v8 offset:32768
    v_mfma_f32_16x16x32_bf16 v[40:43], v[220:223], v[88:91], v[40:43]
    ds_read_b128 v[72:75], v9 offset:32768
    v_mfma_f32_16x16x32_bf16 v[52:55], v[84:87], v[88:91], v[52:55]
    ds_read_b128 v[76:79], v2 offset:40960
    v_mfma_f32_16x16x32_bf16 v[44:47], v[216:219], v[92:95], v[44:47]
    ds_read_b128 v[80:83], v3 offset:34816
    v_mfma_f32_16x16x32_bf16 v[48:51], v[220:223], v[92:95], v[48:51]
    ds_read_b128 v[84:87], v7 offset:40960
    s_waitcnt vmcnt(0)
    s_waitcnt lgkmcnt(7)
    v_mfma_f32_16x16x32_bf16 v[16:19], v[224:227], v[56:59], v[16:19]
    ds_read_b128 v[88:91], v8 offset:40960
    v_mfma_f32_16x16x32_bf16 v[20:23], v[228:231], v[56:59], v[20:23]
    ds_read_b128 v[92:95], v9 offset:40960
    s_waitcnt lgkmcnt(8)
    v_mfma_f32_16x16x32_bf16 v[32:35], v[60:63], v[56:59], v[32:35]
    s_waitcnt lgkmcnt(7)
    v_mfma_f32_16x16x32_bf16 v[24:27], v[224:227], v[64:67], v[24:27]
    v_mfma_f32_16x16x32_bf16 v[28:31], v[228:231], v[64:67], v[28:31]
    s_waitcnt lgkmcnt(6)
    v_mfma_f32_16x16x32_bf16 v[36:39], v[224:227], v[68:71], v[36:39]
    v_mfma_f32_16x16x32_bf16 v[40:43], v[228:231], v[68:71], v[40:43]
    v_mfma_f32_16x16x32_bf16 v[52:55], v[60:63], v[68:71], v[52:55]
    s_waitcnt lgkmcnt(5)
    v_mfma_f32_16x16x32_bf16 v[44:47], v[224:227], v[72:75], v[44:47]
    v_mfma_f32_16x16x32_bf16 v[48:51], v[228:231], v[72:75], v[48:51]
    s_waitcnt lgkmcnt(4)
    v_mfma_f32_16x16x32_bf16 v[16:19], v[232:235], v[76:79], v[16:19]
    v_mfma_f32_16x16x32_bf16 v[20:23], v[236:239], v[76:79], v[20:23]
    s_waitcnt lgkmcnt(0)
    s_barrier
    v_mfma_f32_16x16x32_bf16 v[32:35], v[80:83], v[76:79], v[32:35]
    ds_read_b128 v[56:59], v2 offset:49152
    v_mfma_f32_16x16x32_bf16 v[24:27], v[232:235], v[84:87], v[24:27]
    ds_read_b128 v[64:67], v3 offset:36864
    v_mfma_f32_16x16x32_bf16 v[28:31], v[236:239], v[84:87], v[28:31]
    ds_read_b128 v[60:63], v7 offset:49152
    v_mfma_f32_16x16x32_bf16 v[36:39], v[232:235], v[88:91], v[36:39]
    ds_read_b128 v[68:71], v8 offset:49152
    v_mfma_f32_16x16x32_bf16 v[40:43], v[236:239], v[88:91], v[40:43]
    ds_read_b128 v[72:75], v9 offset:49152
    v_mfma_f32_16x16x32_bf16 v[52:55], v[80:83], v[88:91], v[52:55]
    ds_read_b128 v[76:79], v2 offset:57344
    v_mfma_f32_16x16x32_bf16 v[44:47], v[232:235], v[92:95], v[44:47]
    ds_read_b128 v[84:87], v3 offset:38912
    v_mfma_f32_16x16x32_bf16 v[48:51], v[236:239], v[92:95], v[48:51]
    ds_read_b128 v[80:83], v7 offset:57344
    s_waitcnt lgkmcnt(7)
    v_mfma_f32_16x16x32_bf16 v[16:19], v[240:243], v[56:59], v[16:19]
    ds_read_b128 v[88:91], v8 offset:57344
    v_mfma_f32_16x16x32_bf16 v[20:23], v[244:247], v[56:59], v[20:23]
    ds_read_b128 v[92:95], v9 offset:57344
    s_waitcnt lgkmcnt(8)
    v_mfma_f32_16x16x32_bf16 v[32:35], v[64:67], v[56:59], v[32:35]
    s_waitcnt lgkmcnt(7)
    v_mfma_f32_16x16x32_bf16 v[24:27], v[240:243], v[60:63], v[24:27]
    v_mfma_f32_16x16x32_bf16 v[28:31], v[244:247], v[60:63], v[28:31]
    s_waitcnt lgkmcnt(6)
    v_mfma_f32_16x16x32_bf16 v[36:39], v[240:243], v[68:71], v[36:39]
    v_mfma_f32_16x16x32_bf16 v[40:43], v[244:247], v[68:71], v[40:43]
    v_mfma_f32_16x16x32_bf16 v[52:55], v[64:67], v[68:71], v[52:55]
    s_waitcnt lgkmcnt(5)
    v_mfma_f32_16x16x32_bf16 v[44:47], v[240:243], v[72:75], v[44:47]
    v_mfma_f32_16x16x32_bf16 v[48:51], v[244:247], v[72:75], v[48:51]
    s_waitcnt lgkmcnt(4)
    v_mfma_f32_16x16x32_bf16 v[16:19], v[248:251], v[76:79], v[16:19]
    v_mfma_f32_16x16x32_bf16 v[20:23], v[252:255], v[76:79], v[20:23]
    s_waitcnt lgkmcnt(0)
    s_barrier
    v_mfma_f32_16x16x32_bf16 v[32:35], v[84:87], v[76:79], v[32:35]
    ds_read_b128 v[56:59], v2 offset:0
    v_mfma_f32_16x16x32_bf16 v[24:27], v[248:251], v[80:83], v[24:27]
    ds_read_b128 v[60:63], v11 offset:0
    v_mfma_f32_16x16x32_bf16 v[28:31], v[252:255], v[80:83], v[28:31]
    ds_read_b128 v[64:67], v11 offset:1024
    v_mfma_f32_16x16x32_bf16 v[36:39], v[248:251], v[88:91], v[36:39]
    ds_read_b128 v[68:71], v4 offset:0
    v_mfma_f32_16x16x32_bf16 v[40:43], v[252:255], v[88:91], v[40:43]
    ds_read_b128 v[72:75], v7 offset:0
    v_mfma_f32_16x16x32_bf16 v[52:55], v[84:87], v[88:91], v[52:55]
    ds_read_b128 v[76:79], v8 offset:0
    v_mfma_f32_16x16x32_bf16 v[44:47], v[248:251], v[92:95], v[44:47]
    ds_read_b128 v[80:83], v9 offset:0
    v_mfma_f32_16x16x32_bf16 v[48:51], v[252:255], v[92:95], v[48:51]
    ds_read_b128 v[84:87], v2 offset:8192
    s_waitcnt lgkmcnt(6)
    v_mfma_f32_16x16x32_bf16 v[16:19], v[60:63], v[56:59], v[16:19]
    ds_read_b128 v[88:91], v11 offset:8192
    s_waitcnt lgkmcnt(6)
    v_mfma_f32_16x16x32_bf16 v[20:23], v[64:67], v[56:59], v[20:23]
    ds_read_b128 v[92:95], v11 offset:9216
    s_waitcnt lgkmcnt(6)
    v_mfma_f32_16x16x32_bf16 v[32:35], v[68:71], v[56:59], v[32:35]
    ds_read_b128 v[56:59], v4 offset:2048
    s_waitcnt lgkmcnt(6)
    v_mfma_f32_16x16x32_bf16 v[24:27], v[60:63], v[72:75], v[24:27]
    v_mfma_f32_16x16x32_bf16 v[28:31], v[64:67], v[72:75], v[28:31]
    ds_read_b128 v[72:75], v7 offset:8192
    s_waitcnt lgkmcnt(6)
    v_mfma_f32_16x16x32_bf16 v[36:39], v[60:63], v[76:79], v[36:39]
    v_mfma_f32_16x16x32_bf16 v[40:43], v[64:67], v[76:79], v[40:43]
    v_mfma_f32_16x16x32_bf16 v[52:55], v[68:71], v[76:79], v[52:55]
    ds_read_b128 v[68:71], v8 offset:8192
    s_waitcnt lgkmcnt(6)
    v_mfma_f32_16x16x32_bf16 v[44:47], v[60:63], v[80:83], v[44:47]
    ds_read_b128 v[76:79], v9 offset:8192
    v_mfma_f32_16x16x32_bf16 v[48:51], v[64:67], v[80:83], v[48:51]
    s_waitcnt lgkmcnt(5)
    v_mfma_f32_16x16x32_bf16 v[16:19], v[88:91], v[84:87], v[16:19]
    s_waitcnt lgkmcnt(4)
    v_mfma_f32_16x16x32_bf16 v[20:23], v[92:95], v[84:87], v[20:23]
    s_waitcnt lgkmcnt(0)
    s_barrier
    v_mfma_f32_16x16x32_bf16 v[32:35], v[56:59], v[84:87], v[32:35]
    ds_read_b128 v[60:63], v8 offset:16384
    v_mfma_f32_16x16x32_bf16 v[24:27], v[88:91], v[72:75], v[24:27]
    ds_read_b128 v[64:67], v11 offset:16384
    v_mfma_f32_16x16x32_bf16 v[28:31], v[92:95], v[72:75], v[28:31]
    ds_read_b128 v[80:83], v11 offset:17408
    v_mfma_f32_16x16x32_bf16 v[36:39], v[88:91], v[68:71], v[36:39]
    ds_read_b128 v[84:87], v4 offset:4096
    v_mfma_f32_16x16x32_bf16 v[40:43], v[92:95], v[68:71], v[40:43]
    ds_read_b128 v[72:75], v9 offset:16384
    v_mfma_f32_16x16x32_bf16 v[52:55], v[56:59], v[68:71], v[52:55]
    ds_read_b128 v[56:59], v8 offset:24576
    v_mfma_f32_16x16x32_bf16 v[44:47], v[88:91], v[76:79], v[44:47]
    ds_read_b128 v[68:71], v11 offset:24576
    v_mfma_f32_16x16x32_bf16 v[48:51], v[92:95], v[76:79], v[48:51]
    ds_read_b128 v[88:91], v11 offset:25600
    s_waitcnt lgkmcnt(6)
    v_mfma_f32_16x16x32_bf16 v[36:39], v[64:67], v[60:63], v[36:39]
    ds_read_b128 v[92:95], v4 offset:6144
    s_waitcnt lgkmcnt(6)
    v_mfma_f32_16x16x32_bf16 v[40:43], v[80:83], v[60:63], v[40:43]
    ds_read_b128 v[76:79], v9 offset:24576
    s_waitcnt lgkmcnt(6)
    v_mfma_f32_16x16x32_bf16 v[52:55], v[84:87], v[60:63], v[52:55]
    ds_read_b128 v[60:63], v2 offset:16384
    s_waitcnt lgkmcnt(6)
    v_mfma_f32_16x16x32_bf16 v[44:47], v[64:67], v[72:75], v[44:47]
    v_mfma_f32_16x16x32_bf16 v[48:51], v[80:83], v[72:75], v[48:51]
    ds_read_b128 v[72:75], v7 offset:16384
    s_waitcnt lgkmcnt(5)
    v_mfma_f32_16x16x32_bf16 v[36:39], v[68:71], v[56:59], v[36:39]
    s_waitcnt lgkmcnt(4)
    v_mfma_f32_16x16x32_bf16 v[40:43], v[88:91], v[56:59], v[40:43]
    s_waitcnt lgkmcnt(3)
    v_mfma_f32_16x16x32_bf16 v[52:55], v[92:95], v[56:59], v[52:55]
    ds_read_b128 v[56:59], v2 offset:24576
    s_waitcnt lgkmcnt(3)
    v_mfma_f32_16x16x32_bf16 v[44:47], v[68:71], v[76:79], v[44:47]
    v_mfma_f32_16x16x32_bf16 v[48:51], v[88:91], v[76:79], v[48:51]
    ds_read_b128 v[76:79], v7 offset:24576
    s_waitcnt lgkmcnt(3)
    v_mfma_f32_16x16x32_bf16 v[16:19], v[64:67], v[60:63], v[16:19]
    v_mfma_f32_16x16x32_bf16 v[20:23], v[80:83], v[60:63], v[20:23]
    ds_write_b128 v12, v[36:39] offset:0
    v_mfma_f32_16x16x32_bf16 v[32:35], v[84:87], v[60:63], v[32:35]
    s_waitcnt lgkmcnt(3)
    v_mfma_f32_16x16x32_bf16 v[24:27], v[64:67], v[72:75], v[24:27]
    ds_write_b128 v12, v[40:43] offset:1024
    v_mfma_f32_16x16x32_bf16 v[28:31], v[80:83], v[72:75], v[28:31]
    s_waitcnt lgkmcnt(3)
    v_mfma_f32_16x16x32_bf16 v[16:19], v[68:71], v[56:59], v[16:19]
    ds_write_b128 v12, v[52:55] offset:4096
    v_mfma_f32_16x16x32_bf16 v[20:23], v[88:91], v[56:59], v[20:23]
    v_mfma_f32_16x16x32_bf16 v[32:35], v[92:95], v[56:59], v[32:35]
    ds_write_b128 v12, v[44:47] offset:2048
    s_waitcnt lgkmcnt(4)
    v_mfma_f32_16x16x32_bf16 v[24:27], v[68:71], v[76:79], v[24:27]
    v_mfma_f32_16x16x32_bf16 v[28:31], v[88:91], v[76:79], v[28:31]
    ds_write_b128 v12, v[48:51] offset:3072
    s_waitcnt lgkmcnt(0)
    s_mul_i32 s22, s20, 5120
    s_add_u32 s21, s22, 32768
    v_add_u32 v2, s21, v1
    s_barrier
    ds_read_b128 v[36:39], v2 offset:0
    ds_read_b128 v[40:43], v2 offset:1024
    ds_read_b128 v[44:47], v2 offset:2048
    ds_read_b128 v[48:51], v2 offset:3072
    ds_read_b128 v[52:55], v2 offset:4096
    s_mul_i32 s22, s26, 10
    v_lshrrev_b32 v12, 1, v6
    v_add3_u32 v12, v12, s22, 8
    s_lshl_b32 s21, s32, 2
    s_add_u32 s22, s22, s21
    v_add_u32 v11, s22, v6
    s_cmp_eq_u32 s19, 0
    s_cbranch_scc1 y_a0
    v_mul_u32_u24 v3, 1280, v5
    v_lshl_add_u32 v7, v11, 4, v3
    v_lshl_add_u32 v9, v12, 4, v3
    s_branch y_a1
y_a0:
    v_lshrrev_b32 v3, 2, v11
    v_and_b32 v7, 3, v11
    v_lshlrev_b32 v7, 8, v7
    v_lshl_add_u32 v7, v3, 13, v7
    v_lshl_add_u32 v7, v5, 4, v7
    v_lshrrev_b32 v3, 2, v12
    v_and_b32 v9, 3, v12
    v_lshlrev_b32 v9, 8, v9
    v_lshl_add_u32 v9, v3, 13, v9
    v_lshl_add_u32 v9, v5, 4, v9
y_a1:
    v_add_u32 v9, v9, v10
    s_waitcnt lgkmcnt(3)
    v_pk_add_f32 v[16:17], v[16:17], v[36:37]
    v_pk_add_f32 v[18:19], v[18:19], v[38:39]
    v_pk_add_f32 v[20:21], v[20:21], v[40:41]
    v_pk_add_f32 v[22:23], v[22:23], v[42:43]
    v_cvt_pk_bf16_f32 v56, v16, v17
    v_cvt_pk_bf16_f32 v57, v18, v19
    v_cvt_pk_bf16_f32 v58, v20, v21
    v_cvt_pk_bf16_f32 v59, v22, v23
    s_cbranch_scc1 y_w0
    buffer_store_dwordx4 v[56:59], v7, s[12:15], s35 offen
    s_branch y_n0
y_w0:
    buffer_store_dwordx4 v[56:59], v7, s[8:11], s24 offen sc1
y_n0:
    s_waitcnt lgkmcnt(1)
    v_pk_add_f32 v[24:25], v[24:25], v[44:45]
    v_pk_add_f32 v[26:27], v[26:27], v[46:47]
    v_pk_add_f32 v[28:29], v[28:29], v[48:49]
    v_pk_add_f32 v[30:31], v[30:31], v[50:51]
    v_cvt_pk_bf16_f32 v60, v24, v25
    v_cvt_pk_bf16_f32 v61, v26, v27
    v_cvt_pk_bf16_f32 v62, v28, v29
    v_cvt_pk_bf16_f32 v63, v30, v31
    s_cbranch_scc1 y_w1
    buffer_store_dwordx4 v[60:63], v7, s[12:15], s36 offen
    s_branch y_n1
y_w1:
    buffer_store_dwordx4 v[60:63], v7, s[8:11], s25 offen sc1
y_n1:
    s_waitcnt lgkmcnt(0)
    v_pk_add_f32 v[32:33], v[32:33], v[52:53]
    v_pk_add_f32 v[34:35], v[34:35], v[54:55]
    v_cvt_pk_bf16_f32 v64, v32, v33
    v_cvt_pk_bf16_f32 v65, v34, v35
    s_cbranch_scc1 y_w2
    buffer_store_dwordx2 v[64:65], v9, s[12:15], s35 offen
    s_branch y_end
y_w2:
    buffer_store_dwordx2 v[64:65], v9, s[8:11], s24 offen sc1
    v_lshlrev_b32 v3, 3, v5
    v_lshrrev_b32 v4, 1, v6
    v_lshl_add_u32 v3, v4, 2, v3
    v_pk_mul_f32 v[70:71], v[16:17], v[16:17]
    v_pk_fma_f32 v[70:71], v[18:19], v[18:19], v[70:71]
    v_pk_add_f32 v[16:17], v[16:17], v[18:19]
    v_pk_fma_f32 v[70:71], v[20:21], v[20:21], v[70:71]
    v_pk_add_f32 v[16:17], v[16:17], v[20:21]
    v_pk_fma_f32 v[70:71], v[22:23], v[22:23], v[70:71]
    v_pk_add_f32 v[16:17], v[16:17], v[22:23]
    v_pk_fma_f32 v[70:71], v[32:33], v[32:33], v[70:71]
    v_pk_add_f32 v[16:17], v[16:17], v[32:33]
    v_pk_fma_f32 v[70:71], v[34:35], v[34:35], v[70:71]
    v_pk_add_f32 v[16:17], v[16:17], v[34:35]
    v_add_f32 v68, v16, v17
    v_add_f32 v69, v70, v71
    v_pk_mul_f32 v[74:75], v[24:25], v[24:25]
    v_pk_fma_f32 v[74:75], v[26:27], v[26:27], v[74:75]
    v_pk_add_f32 v[24:25], v[24:25], v[26:27]
    v_pk_fma_f32 v[74:75], v[28:29], v[28:29], v[74:75]
    v_pk_add_f32 v[24:25], v[24:25], v[28:29]
    v_pk_fma_f32 v[74:75], v[30:31], v[30:31], v[74:75]
    v_pk_add_f32 v[24:25], v[24:25], v[30:31]
    v_add_f32 v72, v24, v25
    v_add_f32 v73, v74, v75
    v_permlane32_swap_b32 v68, v69
    s_nop 0
    v_permlane32_swap_b32 v72, v73
    v_add_f32 v68, v68, v69
    v_add_f32 v72, v72, v73
    v_mov_b32 v69, v68
    v_mov_b32 v73, v72
    s_nop 0
    v_permlane16_swap_b32 v69, v68
    v_permlane16_swap_b32 v73, v72
    v_add_f32 v68, v68, v69
    v_add_f32 v72, v72, v73
    s_mov_b32 exec_lo, 0xffff
    s_mov_b32 exec_hi, 0xffff
    buffer_store_dword v68, v3, s[8:11], s28 offen sc1
    buffer_store_dword v72, v3, s[8:11], s29 offen sc1
    s_mov_b64 exec, -1
y_end:
    s_setprio 3
    s_waitcnt vmcnt(0)
    s_barrier
    s_setpc_b64 s[48:49]
x_load:
    s_lshl_b32 s30, s16, 10
    v_add_u32 v14, s30, v1
    s_lshr_b32 s34, s18, 1
    s_mul_i32 s47, s34, 245760
    s_add_u32 s47, s47, 37552128
    s_and_b32 s35, s18, 1
    s_lshl_b32 s35, s35, 12
    s_mul_i32 s43, s19, 6291456
    s_add_u32 s43, s43, 15859712
    s_mul_i32 s34, s17, 393216
    s_add_u32 s43, s43, s34
    s_add_u32 s43, s43, s35
    s_waitcnt vmcnt(0)
    s_barrier
    s_add_u32 m0, s30, 32768
    s_add_u32 s31, s43, 131072
    buffer_load_dwordx4 v14, s[8:11], s31 offen sc1 lds
    buffer_load_dwordx4 v14, s[8:11], s31 offen offset:2048 sc1 lds
    s_add_u32 m0, s30, 36864
    s_add_u32 s31, s43, 139264
    buffer_load_dwordx4 v14, s[8:11], s31 offen sc1 lds
    buffer_load_dwordx4 v14, s[8:11], s31 offen offset:2048 sc1 lds
    s_add_u32 m0, s30, 40960
    s_add_u32 s31, s43, 147456
    buffer_load_dwordx4 v14, s[8:11], s31 offen sc1 lds
    buffer_load_dwordx4 v14, s[8:11], s31 offen offset:2048 sc1 lds
    s_add_u32 m0, s30, 45056
    s_add_u32 s31, s43, 155648
    buffer_load_dwordx4 v14, s[8:11], s31 offen sc1 lds
    buffer_load_dwordx4 v14, s[8:11], s31 offen offset:2048 sc1 lds
    s_add_u32 m0, s30, 49152
    s_add_u32 s31, s43, 163840
    buffer_load_dwordx4 v14, s[8:11], s31 offen sc1 lds
    buffer_load_dwordx4 v14, s[8:11], s31 offen offset:2048 sc1 lds
    s_add_u32 m0, s30, 53248
    s_add_u32 s31, s43, 172032
    buffer_load_dwordx4 v14, s[8:11], s31 offen sc1 lds
    buffer_load_dwordx4 v14, s[8:11], s31 offen offset:2048 sc1 lds
    s_add_u32 m0, s30, 57344
    s_add_u32 s31, s43, 180224
    buffer_load_dwordx4 v14, s[8:11], s31 offen sc1 lds
    buffer_load_dwordx4 v14, s[8:11], s31 offen offset:2048 sc1 lds
    s_add_u32 m0, s30, 61440
    s_add_u32 s31, s43, 188416
    buffer_load_dwordx4 v14, s[8:11], s31 offen sc1 lds
    buffer_load_dwordx4 v14, s[8:11], s31 offen offset:2048 sc1 lds
    s_barrier
    s_add_u32 m0, s30, 0
    s_add_u32 s31, s43, 196608
    buffer_load_dwordx4 v14, s[8:11], s31 offen sc1 lds
    buffer_load_dwordx4 v14, s[8:11], s31 offen offset:2048 sc1 lds
    s_add_u32 m0, s30, 4096
    s_add_u32 s31, s43, 204800
    buffer_load_dwordx4 v14, s[8:11], s31 offen sc1 lds
    buffer_load_dwordx4 v14, s[8:11], s31 offen offset:2048 sc1 lds
    s_add_u32 m0, s30, 8192
    s_add_u32 s31, s43, 212992
    buffer_load_dwordx4 v14, s[8:11], s31 offen sc1 lds
    buffer_load_dwordx4 v14, s[8:11], s31 offen offset:2048 sc1 lds
    s_add_u32 m0, s30, 12288
    s_add_u32 s31, s43, 221184
    buffer_load_dwordx4 v14, s[8:11], s31 offen sc1 lds
    buffer_load_dwordx4 v14, s[8:11], s31 offen offset:2048 sc1 lds
    s_add_u32 m0, s30, 65536
    s_add_u32 s31, s47, 40960
    buffer_load_dwordx4 v14, s[8:11], s31 offen sc1 lds
    buffer_load_dwordx4 v14, s[8:11], s31 offen offset:2048 sc1 lds
    s_add_u32 m0, s30, 69632
    s_add_u32 s31, s47, 45056
    buffer_load_dwordx4 v14, s[8:11], s31 offen sc1 lds
    buffer_load_dwordx4 v14, s[8:11], s31 offen offset:2048 sc1 lds
    s_add_u32 m0, s30, 73728
    s_add_u32 s31, s47, 212992
    buffer_load_dwordx4 v14, s[8:11], s31 offen sc1 lds
    s_waitcnt vmcnt(21)
    s_barrier
    s_add_u32 m0, s30, 16384
    s_add_u32 s31, s43, 229376
    buffer_load_dwordx4 v14, s[8:11], s31 offen sc1 lds
    buffer_load_dwordx4 v14, s[8:11], s31 offen offset:2048 sc1 lds
    s_add_u32 m0, s30, 20480
    s_add_u32 s31, s43, 237568
    buffer_load_dwordx4 v14, s[8:11], s31 offen sc1 lds
    buffer_load_dwordx4 v14, s[8:11], s31 offen offset:2048 sc1 lds
    s_add_u32 m0, s30, 24576
    s_add_u32 s31, s43, 245760
    buffer_load_dwordx4 v14, s[8:11], s31 offen sc1 lds
    buffer_load_dwordx4 v14, s[8:11], s31 offen offset:2048 sc1 lds
    s_add_u32 m0, s30, 28672
    s_add_u32 s31, s43, 253952
    buffer_load_dwordx4 v14, s[8:11], s31 offen sc1 lds
    buffer_load_dwordx4 v14, s[8:11], s31 offen offset:2048 sc1 lds
    s_add_u32 m0, s30, 75776
    s_add_u32 s31, s47, 215040
    buffer_load_dwordx4 v14, s[8:11], s31 offen sc1 lds
    buffer_load_dwordx4 v14, s[8:11], s31 offen offset:2048 sc1 lds
    s_add_u32 m0, s30, 79872
    s_add_u32 s31, s47, 219136
    buffer_load_dwordx4 v14, s[8:11], s31 offen sc1 lds
    buffer_load_dwordx4 v14, s[8:11], s31 offen offset:2048 sc1 lds
    s_add_u32 m0, s30, 83968
    s_add_u32 s31, s47, 223232
    buffer_load_dwordx4 v14, s[8:11], s31 offen sc1 lds
    s_waitcnt vmcnt(26)
    s_barrier
    s_add_u32 m0, s30, 32768
    s_add_u32 s31, s43, 262144
    buffer_load_dwordx4 v14, s[8:11], s31 offen sc1 lds
    buffer_load_dwordx4 v14, s[8:11], s31 offen offset:2048 sc1 lds
    s_add_u32 m0, s30, 36864
    s_add_u32 s31, s43, 270336
    buffer_load_dwordx4 v14, s[8:11], s31 offen sc1 lds
    buffer_load_dwordx4 v14, s[8:11], s31 offen offset:2048 sc1 lds
    s_add_u32 m0, s30, 40960
    s_add_u32 s31, s43, 278528
    buffer_load_dwordx4 v14, s[8:11], s31 offen sc1 lds
    buffer_load_dwordx4 v14, s[8:11], s31 offen offset:2048 sc1 lds
    s_add_u32 m0, s30, 45056
    s_add_u32 s31, s43, 286720
    buffer_load_dwordx4 v14, s[8:11], s31 offen sc1 lds
    buffer_load_dwordx4 v14, s[8:11], s31 offen offset:2048 sc1 lds
    s_add_u32 m0, s30, 86016
    s_add_u32 s31, s47, 225280
    buffer_load_dwordx4 v14, s[8:11], s31 offen sc1 lds
    buffer_load_dwordx4 v14, s[8:11], s31 offen offset:2048 sc1 lds
    s_add_u32 m0, s30, 90112
    s_add_u32 s31, s47, 229376
    buffer_load_dwordx4 v14, s[8:11], s31 offen sc1 lds
    buffer_load_dwordx4 v14, s[8:11], s31 offen offset:2048 sc1 lds
    s_add_u32 m0, s30, 94208
    s_add_u32 s31, s47, 233472
    buffer_load_dwordx4 v14, s[8:11], s31 offen sc1 lds
    s_waitcnt vmcnt(31)
    s_barrier
    s_add_u32 m0, s30, 49152
    s_add_u32 s31, s43, 294912
    buffer_load_dwordx4 v14, s[8:11], s31 offen sc1 lds
    buffer_load_dwordx4 v14, s[8:11], s31 offen offset:2048 sc1 lds
    s_add_u32 m0, s30, 53248
    s_add_u32 s31, s43, 303104
    buffer_load_dwordx4 v14, s[8:11], s31 offen sc1 lds
    buffer_load_dwordx4 v14, s[8:11], s31 offen offset:2048 sc1 lds
    s_add_u32 m0, s30, 57344
    s_add_u32 s31, s43, 311296
    buffer_load_dwordx4 v14, s[8:11], s31 offen sc1 lds
    buffer_load_dwordx4 v14, s[8:11], s31 offen offset:2048 sc1 lds
    s_add_u32 m0, s30, 61440
    s_add_u32 s31, s43, 319488
    buffer_load_dwordx4 v14, s[8:11], s31 offen sc1 lds
    buffer_load_dwordx4 v14, s[8:11], s31 offen offset:2048 sc1 lds
    s_add_u32 m0, s30, 96256
    s_add_u32 s31, s47, 235520
    buffer_load_dwordx4 v14, s[8:11], s31 offen sc1 lds
    buffer_load_dwordx4 v14, s[8:11], s31 offen offset:2048 sc1 lds
    s_add_u32 m0, s30, 100352
    s_add_u32 s31, s47, 239616
    buffer_load_dwordx4 v14, s[8:11], s31 offen sc1 lds
    buffer_load_dwordx4 v14, s[8:11], s31 offen offset:2048 sc1 lds
    s_add_u32 m0, s30, 104448
    s_add_u32 s31, s47, 243712
    buffer_load_dwordx4 v14, s[8:11], s31 offen sc1 lds
    s_waitcnt vmcnt(31)
    s_barrier
    s_add_u32 m0, s30, 0
    s_add_u32 s31, s43, 327680
    buffer_load_dwordx4 v14, s[8:11], s31 offen sc1 lds
    buffer_load_dwordx4 v14, s[8:11], s31 offen offset:2048 sc1 lds
    s_add_u32 m0, s30, 4096
    s_add_u32 s31, s43, 335872
    buffer_load_dwordx4 v14, s[8:11], s31 offen sc1 lds
    buffer_load_dwordx4 v14, s[8:11], s31 offen offset:2048 sc1 lds
    s_add_u32 m0, s30, 8192
    s_add_u32 s31, s43, 344064
    buffer_load_dwordx4 v14, s[8:11], s31 offen sc1 lds
    buffer_load_dwordx4 v14, s[8:11], s31 offen offset:2048 sc1 lds
    s_add_u32 m0, s30, 12288
    s_add_u32 s31, s43, 352256
    buffer_load_dwordx4 v14, s[8:11], s31 offen sc1 lds
    buffer_load_dwordx4 v14, s[8:11], s31 offen offset:2048 sc1 lds
    s_waitcnt vmcnt(26)
    s_barrier
    s_add_u32 m0, s30, 16384
    s_add_u32 s31, s43, 360448
    buffer_load_dwordx4 v14, s[8:11], s31 offen sc1 lds
    buffer_load_dwordx4 v14, s[8:11], s31 offen offset:2048 sc1 lds
    s_add_u32 m0, s30, 20480
    s_add_u32 s31, s43, 368640
    buffer_load_dwordx4 v14, s[8:11], s31 offen sc1 lds
    buffer_load_dwordx4 v14, s[8:11], s31 offen offset:2048 sc1 lds
    s_add_u32 m0, s30, 24576
    s_add_u32 s31, s43, 376832
    buffer_load_dwordx4 v14, s[8:11], s31 offen sc1 lds
    buffer_load_dwordx4 v14, s[8:11], s31 offen offset:2048 sc1 lds
    s_add_u32 m0, s30, 28672
    s_add_u32 s31, s43, 385024
    buffer_load_dwordx4 v14, s[8:11], s31 offen sc1 lds
    buffer_load_dwordx4 v14, s[8:11], s31 offen offset:2048 sc1 lds
    s_waitcnt vmcnt(21)
    s_barrier
    s_waitcnt vmcnt(8)
    s_barrier
    s_waitcnt vmcnt(0)
    s_barrier
    s_barrier
    s_barrier
    s_branch x_join
main_kernel_cloop:
    s_lshl_b32 s22, s16, 11
    v_add_u32 v2, s22, v1
    v_add_u32 v3, 65536, v1
    v_add_u32 v4, 0x10000, v3
    s_lshl_b32 s22, s16, 7
    s_add_u32 s22, s22, 155648
    v_lshl_add_u32 v7, v6, 4, s22
    v_lshl_add_u32 v8, v5, 2, s22
    v_lshlrev_b32 v9, 2, v5
    v_add_u32 v9, 156672, v9
    v_lshlrev_b32 v10, 4, v6
    v_add_u32 v10, 156672, v10
    s_lshl_b32 s22, s16, 12
    s_add_u32 s22, s22, 0
    v_add_u32 v11, s22, v1
    v_cmp_gt_u32 s[36:37], 8, v5
    v_cmp_eq_u32 s[38:39], 1, v5
    v_cmp_le_u32 s[40:41], 12, v5
    s_nop 1
    s_or_b64 s[38:39], s[38:39], s[40:41]
    v_cmp_eq_u32 s[40:41], 1, v6
    v_cmp_eq_u32 s[42:43], 0, v6
    s_mov_b32 s21, 0x358637bd
    s_mov_b32 s26, 0x35c1a2a0
    s_mov_b32 s27, 0x35c1a2a0
    s_mov_b32 s28, 0x3f317218
    s_mov_b32 s29, 0x3f317218
p1_in:
    s_barrier
    s_cmp_lg_u32 s19, 0
    s_cbranch_scc1 p1_l1
    s_barrier
    ds_read_b128 v[56:59], v3 offset:0
    ds_read_b128 v[60:63], v3 offset:5120
    ds_read_b128 v[64:67], v3 offset:1024
    ds_read_b128 v[68:71], v3 offset:6144
    ds_read_b128 v[72:75], v3 offset:4096
    ds_read_b128 v[76:79], v3 offset:9216
    ds_read_b128 v[80:83], v3 offset:2048
    ds_read_b128 v[84:87], v3 offset:7168
    ds_read_b128 v[88:91], v3 offset:3072
    ds_read_b128 v[92:95], v3 offset:8192
    s_waitcnt lgkmcnt(9)
    v_mfma_f32_16x16x32_bf16 v[16:19], v[96:99], v[56:59], 0
    s_waitcnt lgkmcnt(8)
    v_mfma_f32_16x16x32_bf16 v[16:19], v[104:107], v[60:63], v[16:19]
    v_mfma_f32_16x16x32_bf16 v[36:39], v[100:103], v[56:59], 0
    v_mfma_f32_16x16x32_bf16 v[36:39], v[108:111], v[60:63], v[36:39]
    s_waitcnt lgkmcnt(7)
    v_mfma_f32_16x16x32_bf16 v[20:23], v[96:99], v[64:67], 0
    s_waitcnt lgkmcnt(6)
    v_mfma_f32_16x16x32_bf16 v[20:23], v[104:107], v[68:71], v[20:23]
    v_mfma_f32_16x16x32_bf16 v[40:43], v[100:103], v[64:67], 0
    v_mfma_f32_16x16x32_bf16 v[40:43], v[108:111], v[68:71], v[40:43]
    s_waitcnt lgkmcnt(5)
    v_mfma_f32_16x16x32_bf16 v[32:35], v[96:99], v[72:75], 0
    s_waitcnt lgkmcnt(4)
    v_mfma_f32_16x16x32_bf16 v[32:35], v[104:107], v[76:79], v[32:35]
    v_mfma_f32_16x16x32_bf16 v[52:55], v[100:103], v[72:75], 0
    v_mfma_f32_16x16x32_bf16 v[52:55], v[108:111], v[76:79], v[52:55]
    s_waitcnt lgkmcnt(0)
    s_barrier
    v_mfma_f32_16x16x32_bf16 v[24:27], v[96:99], v[80:83], 0
    ds_read_b128 v[56:59], v3 offset:10240
    v_mfma_f32_16x16x32_bf16 v[24:27], v[104:107], v[84:87], v[24:27]
    ds_read_b128 v[60:63], v3 offset:15360
    v_mfma_f32_16x16x32_bf16 v[44:47], v[100:103], v[80:83], 0
    ds_read_b128 v[64:67], v3 offset:11264
    v_mfma_f32_16x16x32_bf16 v[44:47], v[108:111], v[84:87], v[44:47]
    ds_read_b128 v[68:71], v3 offset:16384
    v_mfma_f32_16x16x32_bf16 v[28:31], v[96:99], v[88:91], 0
    ds_read_b128 v[72:75], v3 offset:14336
    v_mfma_f32_16x16x32_bf16 v[28:31], v[104:107], v[92:95], v[28:31]
    ds_read_b128 v[76:79], v3 offset:19456
    v_mfma_f32_16x16x32_bf16 v[48:51], v[100:103], v[88:91], 0
    ds_read_b128 v[80:83], v3 offset:12288
    v_mfma_f32_16x16x32_bf16 v[48:51], v[108:111], v[92:95], v[48:51]
    ds_read_b128 v[84:87], v3 offset:17408
    s_waitcnt lgkmcnt(7)
    v_mfma_f32_16x16x32_bf16 v[16:19], v[112:115], v[56:59], v[16:19]
    ds_read_b128 v[88:91], v3 offset:13312
    s_waitcnt lgkmcnt(7)
    v_mfma_f32_16x16x32_bf16 v[16:19], v[120:123], v[60:63], v[16:19]
    ds_read_b128 v[92:95], v3 offset:18432
    v_mfma_f32_16x16x32_bf16 v[36:39], v[116:119], v[56:59], v[36:39]
    v_mfma_f32_16x16x32_bf16 v[36:39], v[124:127], v[60:63], v[36:39]
    s_waitcnt lgkmcnt(7)
    v_mfma_f32_16x16x32_bf16 v[20:23], v[112:115], v[64:67], v[20:23]
    s_waitcnt lgkmcnt(6)
    v_mfma_f32_16x16x32_bf16 v[20:23], v[120:123], v[68:71], v[20:23]
    v_mfma_f32_16x16x32_bf16 v[40:43], v[116:119], v[64:67], v[40:43]
    v_mfma_f32_16x16x32_bf16 v[40:43], v[124:127], v[68:71], v[40:43]
    s_waitcnt lgkmcnt(5)
    v_mfma_f32_16x16x32_bf16 v[32:35], v[112:115], v[72:75], v[32:35]
    s_waitcnt lgkmcnt(4)
    v_mfma_f32_16x16x32_bf16 v[32:35], v[120:123], v[76:79], v[32:35]
    v_mfma_f32_16x16x32_bf16 v[52:55], v[116:119], v[72:75], v[52:55]
    v_mfma_f32_16x16x32_bf16 v[52:55], v[124:127], v[76:79], v[52:55]
    s_waitcnt lgkmcnt(0)
    s_barrier
    v_mfma_f32_16x16x32_bf16 v[24:27], v[112:115], v[80:83], v[24:27]
    ds_read_b128 v[56:59], v3 offset:20480
    v_mfma_f32_16x16x32_bf16 v[24:27], v[120:123], v[84:87], v[24:27]
    ds_read_b128 v[60:63], v3 offset:25600
    v_mfma_f32_16x16x32_bf16 v[44:47], v[116:119], v[80:83], v[44:47]
    ds_read_b128 v[64:67], v3 offset:21504
    v_mfma_f32_16x16x32_bf16 v[44:47], v[124:127], v[84:87], v[44:47]
    ds_read_b128 v[68:71], v3 offset:26624
    v_mfma_f32_16x16x32_bf16 v[28:31], v[112:115], v[88:91], v[28:31]
    ds_read_b128 v[72:75], v3 offset:24576
    v_mfma_f32_16x16x32_bf16 v[28:31], v[120:123], v[92:95], v[28:31]
    ds_read_b128 v[76:79], v3 offset:29696
    v_mfma_f32_16x16x32_bf16 v[48:51], v[116:119], v[88:91], v[48:51]
    ds_read_b128 v[80:83], v3 offset:22528
    v_mfma_f32_16x16x32_bf16 v[48:51], v[124:127], v[92:95], v[48:51]
    ds_read_b128 v[84:87], v3 offset:27648
    s_waitcnt lgkmcnt(7)
    v_mfma_f32_16x16x32_bf16 v[16:19], v[128:131], v[56:59], v[16:19]
    ds_read_b128 v[88:91], v3 offset:23552
    s_waitcnt lgkmcnt(7)
    v_mfma_f32_16x16x32_bf16 v[16:19], v[136:139], v[60:63], v[16:19]
    ds_read_b128 v[92:95], v3 offset:28672
    v_mfma_f32_16x16x32_bf16 v[36:39], v[132:135], v[56:59], v[36:39]
    v_mfma_f32_16x16x32_bf16 v[36:39], v[140:143], v[60:63], v[36:39]
    s_waitcnt lgkmcnt(7)
    v_mfma_f32_16x16x32_bf16 v[20:23], v[128:131], v[64:67], v[20:23]
    s_waitcnt lgkmcnt(6)
    v_mfma_f32_16x16x32_bf16 v[20:23], v[136:139], v[68:71], v[20:23]
    v_mfma_f32_16x16x32_bf16 v[40:43], v[132:135], v[64:67], v[40:43]
    v_mfma_f32_16x16x32_bf16 v[40:43], v[140:143], v[68:71], v[40:43]
    s_waitcnt lgkmcnt(5)
    v_mfma_f32_16x16x32_bf16 v[32:35], v[128:131], v[72:75], v[32:35]
    s_waitcnt lgkmcnt(4)
    v_mfma_f32_16x16x32_bf16 v[32:35], v[136:139], v[76:79], v[32:35]
    v_mfma_f32_16x16x32_bf16 v[52:55], v[132:135], v[72:75], v[52:55]
    v_mfma_f32_16x16x32_bf16 v[52:55], v[140:143], v[76:79], v[52:55]
    s_waitcnt lgkmcnt(0)
    s_barrier
    v_mfma_f32_16x16x32_bf16 v[24:27], v[128:131], v[80:83], v[24:27]
    ds_read_b128 v[56:59], v3 offset:30720
    v_mfma_f32_16x16x32_bf16 v[24:27], v[136:139], v[84:87], v[24:27]
    ds_read_b128 v[60:63], v3 offset:35840
    v_mfma_f32_16x16x32_bf16 v[44:47], v[132:135], v[80:83], v[44:47]
    ds_read_b128 v[64:67], v3 offset:31744
    v_mfma_f32_16x16x32_bf16 v[44:47], v[140:143], v[84:87], v[44:47]
    ds_read_b128 v[68:71], v3 offset:36864
    v_mfma_f32_16x16x32_bf16 v[28:31], v[128:131], v[88:91], v[28:31]
    ds_read_b128 v[72:75], v3 offset:34816
    v_mfma_f32_16x16x32_bf16 v[28:31], v[136:139], v[92:95], v[28:31]
    ds_read_b128 v[76:79], v3 offset:39936
    v_mfma_f32_16x16x32_bf16 v[48:51], v[132:135], v[88:91], v[48:51]
    ds_read_b128 v[80:83], v3 offset:32768
    v_mfma_f32_16x16x32_bf16 v[48:51], v[140:143], v[92:95], v[48:51]
    ds_read_b128 v[84:87], v3 offset:37888
    s_waitcnt lgkmcnt(7)
    v_mfma_f32_16x16x32_bf16 v[16:19], v[144:147], v[56:59], v[16:19]
    ds_read_b128 v[88:91], v3 offset:33792
    s_waitcnt lgkmcnt(7)
    v_mfma_f32_16x16x32_bf16 v[16:19], v[152:155], v[60:63], v[16:19]
    ds_read_b128 v[92:95], v3 offset:38912
    v_mfma_f32_16x16x32_bf16 v[36:39], v[148:151], v[56:59], v[36:39]
    v_mfma_f32_16x16x32_bf16 v[36:39], v[156:159], v[60:63], v[36:39]
    s_waitcnt lgkmcnt(7)
    v_mfma_f32_16x16x32_bf16 v[20:23], v[144:147], v[64:67], v[20:23]
    s_waitcnt lgkmcnt(6)
    v_mfma_f32_16x16x32_bf16 v[20:23], v[152:155], v[68:71], v[20:23]
    v_mfma_f32_16x16x32_bf16 v[40:43], v[148:151], v[64:67], v[40:43]
    v_mfma_f32_16x16x32_bf16 v[40:43], v[156:159], v[68:71], v[40:43]
    s_waitcnt lgkmcnt(5)
    v_mfma_f32_16x16x32_bf16 v[32:35], v[144:147], v[72:75], v[32:35]
    s_waitcnt lgkmcnt(4)
    v_mfma_f32_16x16x32_bf16 v[32:35], v[152:155], v[76:79], v[32:35]
    v_mfma_f32_16x16x32_bf16 v[52:55], v[148:151], v[72:75], v[52:55]
    v_mfma_f32_16x16x32_bf16 v[52:55], v[156:159], v[76:79], v[52:55]
    s_waitcnt lgkmcnt(0)
    s_barrier
    v_mfma_f32_16x16x32_bf16 v[24:27], v[144:147], v[80:83], v[24:27]
    ds_read_b128 v[56:59], v3 offset:40960
    v_mfma_f32_16x16x32_bf16 v[24:27], v[152:155], v[84:87], v[24:27]
    ds_read_b128 v[60:63], v3 offset:46080
    v_mfma_f32_16x16x32_bf16 v[44:47], v[148:151], v[80:83], v[44:47]
    ds_read_b128 v[64:67], v3 offset:41984
    v_mfma_f32_16x16x32_bf16 v[44:47], v[156:159], v[84:87], v[44:47]
    ds_read_b128 v[68:71], v3 offset:47104
    v_mfma_f32_16x16x32_bf16 v[28:31], v[144:147], v[88:91], v[28:31]
    ds_read_b128 v[72:75], v3 offset:45056
    v_mfma_f32_16x16x32_bf16 v[28:31], v[152:155], v[92:95], v[28:31]
    ds_read_b128 v[76:79], v3 offset:50176
    v_mfma_f32_16x16x32_bf16 v[48:51], v[148:151], v[88:91], v[48:51]
    ds_read_b128 v[80:83], v3 offset:43008
    v_mfma_f32_16x16x32_bf16 v[48:51], v[156:159], v[92:95], v[48:51]
    ds_read_b128 v[84:87], v3 offset:48128
    s_waitcnt lgkmcnt(7)
    v_mfma_f32_16x16x32_bf16 v[16:19], v[160:163], v[56:59], v[16:19]
    ds_read_b128 v[88:91], v3 offset:44032
    s_waitcnt lgkmcnt(7)
    v_mfma_f32_16x16x32_bf16 v[16:19], v[168:171], v[60:63], v[16:19]
    ds_read_b128 v[92:95], v3 offset:49152
    v_mfma_f32_16x16x32_bf16 v[36:39], v[164:167], v[56:59], v[36:39]
    v_mfma_f32_16x16x32_bf16 v[36:39], v[172:175], v[60:63], v[36:39]
    s_waitcnt lgkmcnt(7)
    v_mfma_f32_16x16x32_bf16 v[20:23], v[160:163], v[64:67], v[20:23]
    s_waitcnt lgkmcnt(6)
    v_mfma_f32_16x16x32_bf16 v[20:23], v[168:171], v[68:71], v[20:23]
    v_mfma_f32_16x16x32_bf16 v[40:43], v[164:167], v[64:67], v[40:43]
    v_mfma_f32_16x16x32_bf16 v[40:43], v[172:175], v[68:71], v[40:43]
    s_waitcnt lgkmcnt(5)
    v_mfma_f32_16x16x32_bf16 v[32:35], v[160:163], v[72:75], v[32:35]
    s_waitcnt lgkmcnt(4)
    v_mfma_f32_16x16x32_bf16 v[32:35], v[168:171], v[76:79], v[32:35]
    v_mfma_f32_16x16x32_bf16 v[52:55], v[164:167], v[72:75], v[52:55]
    v_mfma_f32_16x16x32_bf16 v[52:55], v[172:175], v[76:79], v[52:55]
    s_waitcnt lgkmcnt(0)
    s_barrier
    v_mfma_f32_16x16x32_bf16 v[24:27], v[160:163], v[80:83], v[24:27]
    ds_read_b128 v[56:59], v3 offset:51200
    v_mfma_f32_16x16x32_bf16 v[24:27], v[168:171], v[84:87], v[24:27]
    ds_read_b128 v[60:63], v3 offset:56320
    v_mfma_f32_16x16x32_bf16 v[44:47], v[164:167], v[80:83], v[44:47]
    ds_read_b128 v[64:67], v3 offset:52224
    v_mfma_f32_16x16x32_bf16 v[44:47], v[172:175], v[84:87], v[44:47]
    ds_read_b128 v[68:71], v3 offset:57344
    v_mfma_f32_16x16x32_bf16 v[28:31], v[160:163], v[88:91], v[28:31]
    ds_read_b128 v[72:75], v3 offset:55296
    v_mfma_f32_16x16x32_bf16 v[28:31], v[168:171], v[92:95], v[28:31]
    ds_read_b128 v[76:79], v3 offset:60416
    v_mfma_f32_16x16x32_bf16 v[48:51], v[164:167], v[88:91], v[48:51]
    ds_read_b128 v[80:83], v3 offset:53248
    v_mfma_f32_16x16x32_bf16 v[48:51], v[172:175], v[92:95], v[48:51]
    ds_read_b128 v[84:87], v3 offset:58368
    s_waitcnt lgkmcnt(7)
    v_mfma_f32_16x16x32_bf16 v[16:19], v[176:179], v[56:59], v[16:19]
    ds_read_b128 v[88:91], v3 offset:54272
    s_waitcnt lgkmcnt(7)
    v_mfma_f32_16x16x32_bf16 v[16:19], v[184:187], v[60:63], v[16:19]
    ds_read_b128 v[92:95], v3 offset:59392
    v_mfma_f32_16x16x32_bf16 v[36:39], v[180:183], v[56:59], v[36:39]
    v_mfma_f32_16x16x32_bf16 v[36:39], v[188:191], v[60:63], v[36:39]
    s_waitcnt lgkmcnt(7)
    v_mfma_f32_16x16x32_bf16 v[20:23], v[176:179], v[64:67], v[20:23]
    s_waitcnt lgkmcnt(6)
    v_mfma_f32_16x16x32_bf16 v[20:23], v[184:187], v[68:71], v[20:23]
    v_mfma_f32_16x16x32_bf16 v[40:43], v[180:183], v[64:67], v[40:43]
    v_mfma_f32_16x16x32_bf16 v[40:43], v[188:191], v[68:71], v[40:43]
    s_waitcnt lgkmcnt(5)
    v_mfma_f32_16x16x32_bf16 v[32:35], v[176:179], v[72:75], v[32:35]
    s_waitcnt lgkmcnt(4)
    v_mfma_f32_16x16x32_bf16 v[32:35], v[184:187], v[76:79], v[32:35]
    v_mfma_f32_16x16x32_bf16 v[52:55], v[180:183], v[72:75], v[52:55]
    v_mfma_f32_16x16x32_bf16 v[52:55], v[188:191], v[76:79], v[52:55]
    s_waitcnt lgkmcnt(0)
    s_barrier
    v_mfma_f32_16x16x32_bf16 v[24:27], v[176:179], v[80:83], v[24:27]
    ds_read_b128 v[56:59], v3 offset:61440
    v_mfma_f32_16x16x32_bf16 v[24:27], v[184:187], v[84:87], v[24:27]
    ds_read_b128 v[60:63], v4 offset:1024
    v_mfma_f32_16x16x32_bf16 v[44:47], v[180:183], v[80:83], v[44:47]
    ds_read_b128 v[64:67], v3 offset:62464
    v_mfma_f32_16x16x32_bf16 v[44:47], v[188:191], v[84:87], v[44:47]
    ds_read_b128 v[68:71], v4 offset:2048
    v_mfma_f32_16x16x32_bf16 v[28:31], v[176:179], v[88:91], v[28:31]
    ds_read_b128 v[72:75], v4 offset:0
    v_mfma_f32_16x16x32_bf16 v[28:31], v[184:187], v[92:95], v[28:31]
    ds_read_b128 v[76:79], v4 offset:5120
    v_mfma_f32_16x16x32_bf16 v[48:51], v[180:183], v[88:91], v[48:51]
    ds_read_b128 v[80:83], v3 offset:63488
    v_mfma_f32_16x16x32_bf16 v[48:51], v[188:191], v[92:95], v[48:51]
    ds_read_b128 v[84:87], v4 offset:3072
    s_waitcnt lgkmcnt(7)
    v_mfma_f32_16x16x32_bf16 v[16:19], v[192:195], v[56:59], v[16:19]
    ds_read_b128 v[88:91], v3 offset:64512
    s_waitcnt lgkmcnt(7)
    v_mfma_f32_16x16x32_bf16 v[16:19], v[200:203], v[60:63], v[16:19]
    ds_read_b128 v[92:95], v4 offset:4096
    v_mfma_f32_16x16x32_bf16 v[36:39], v[196:199], v[56:59], v[36:39]
    v_mfma_f32_16x16x32_bf16 v[36:39], v[204:207], v[60:63], v[36:39]
    s_waitcnt lgkmcnt(7)
    v_mfma_f32_16x16x32_bf16 v[20:23], v[192:195], v[64:67], v[20:23]
    s_waitcnt lgkmcnt(6)
    v_mfma_f32_16x16x32_bf16 v[20:23], v[200:203], v[68:71], v[20:23]
    v_mfma_f32_16x16x32_bf16 v[40:43], v[196:199], v[64:67], v[40:43]
    v_mfma_f32_16x16x32_bf16 v[40:43], v[204:207], v[68:71], v[40:43]
    s_waitcnt lgkmcnt(5)
    v_mfma_f32_16x16x32_bf16 v[32:35], v[192:195], v[72:75], v[32:35]
    s_waitcnt lgkmcnt(4)
    v_mfma_f32_16x16x32_bf16 v[32:35], v[200:203], v[76:79], v[32:35]
    v_mfma_f32_16x16x32_bf16 v[52:55], v[196:199], v[72:75], v[52:55]
    v_mfma_f32_16x16x32_bf16 v[52:55], v[204:207], v[76:79], v[52:55]
    s_waitcnt lgkmcnt(0)
    s_barrier
    v_mfma_f32_16x16x32_bf16 v[24:27], v[192:195], v[80:83], v[24:27]
    ds_read_b128 v[56:59], v4 offset:6144
    v_mfma_f32_16x16x32_bf16 v[24:27], v[200:203], v[84:87], v[24:27]
    ds_read_b128 v[60:63], v4 offset:11264
    ds_read_b128 v[240:243], v7 offset:0
    v_mfma_f32_16x16x32_bf16 v[44:47], v[196:199], v[80:83], v[44:47]
    ds_read_b128 v[64:67], v4 offset:7168
    ds_read_b128 v[244:247], v7 offset:64
    v_mfma_f32_16x16x32_bf16 v[44:47], v[204:207], v[84:87], v[44:47]
    ds_read_b128 v[68:71], v4 offset:12288
    ds_read_b32 v248, v9 offset:0
    v_mfma_f32_16x16x32_bf16 v[28:31], v[192:195], v[88:91], v[28:31]
    ds_read_b128 v[72:75], v4 offset:10240
    ds_read_b32 v249, v9 offset:64
    v_mfma_f32_16x16x32_bf16 v[28:31], v[200:203], v[92:95], v[28:31]
    ds_read_b128 v[76:79], v4 offset:15360
    ds_read_b32 v250, v9 offset:128
    v_mfma_f32_16x16x32_bf16 v[48:51], v[196:199], v[88:91], v[48:51]
    ds_read_b128 v[80:83], v4 offset:8192
    ds_read_b32 v251, v9 offset:192
    v_mfma_f32_16x16x32_bf16 v[48:51], v[204:207], v[92:95], v[48:51]
    ds_read_b128 v[84:87], v4 offset:13312
    ds_read_b32 v252, v9 offset:256
    s_waitcnt lgkmcnt(14)
    v_mfma_f32_16x16x32_bf16 v[16:19], v[208:211], v[56:59], v[16:19]
    ds_read_b128 v[88:91], v4 offset:9216
    s_waitcnt lgkmcnt(14)
    v_mfma_f32_16x16x32_bf16 v[16:19], v[216:219], v[60:63], v[16:19]
    ds_read_b128 v[92:95], v4 offset:14336
    v_mfma_f32_16x16x32_bf16 v[36:39], v[212:215], v[56:59], v[36:39]
    v_mfma_f32_16x16x32_bf16 v[36:39], v[220:223], v[60:63], v[36:39]
    s_waitcnt lgkmcnt(13)
    v_mfma_f32_16x16x32_bf16 v[20:23], v[208:211], v[64:67], v[20:23]
    s_waitcnt lgkmcnt(11)
    v_mfma_f32_16x16x32_bf16 v[20:23], v[216:219], v[68:71], v[20:23]
    v_mfma_f32_16x16x32_bf16 v[40:43], v[212:215], v[64:67], v[40:43]
    v_mfma_f32_16x16x32_bf16 v[40:43], v[220:223], v[68:71], v[40:43]
    s_waitcnt lgkmcnt(9)
    v_mfma_f32_16x16x32_bf16 v[32:35], v[208:211], v[72:75], v[32:35]
    s_waitcnt lgkmcnt(7)
    v_mfma_f32_16x16x32_bf16 v[32:35], v[216:219], v[76:79], v[32:35]
    v_fmac_f32 v16, v240, v248
    v_fmac_f32 v17, v241, v248
    v_mfma_f32_16x16x32_bf16 v[52:55], v[212:215], v[72:75], v[52:55]
    v_fmac_f32 v18, v242, v248
    v_fmac_f32 v19, v243, v248
    v_mfma_f32_16x16x32_bf16 v[52:55], v[220:223], v[76:79], v[52:55]
    v_fmac_f32 v36, v244, v248
    v_fmac_f32 v37, v245, v248
    s_waitcnt lgkmcnt(0)
    s_barrier
    v_mfma_f32_16x16x32_bf16 v[24:27], v[208:211], v[80:83], v[24:27]
    ds_read_b128 v[56:59], v3 offset:0
    v_fmac_f32 v38, v246, v248
    v_fmac_f32 v39, v247, v248
    v_mfma_f32_16x16x32_bf16 v[24:27], v[216:219], v[84:87], v[24:27]
    ds_read_b128 v[60:63], v3 offset:5120
    v_fmac_f32 v20, v240, v249
    v_fmac_f32 v21, v241, v249
    v_mfma_f32_16x16x32_bf16 v[44:47], v[212:215], v[80:83], v[44:47]
    ds_read_b128 v[64:67], v3 offset:1024
    v_fmac_f32 v22, v242, v249
    v_fmac_f32 v23, v243, v249
    v_mfma_f32_16x16x32_bf16 v[44:47], v[220:223], v[84:87], v[44:47]
    ds_read_b128 v[68:71], v3 offset:6144
    v_fmac_f32 v40, v244, v249
    v_fmac_f32 v41, v245, v249
    v_mfma_f32_16x16x32_bf16 v[28:31], v[208:211], v[88:91], v[28:31]
    ds_read_b128 v[72:75], v3 offset:4096
    v_fmac_f32 v42, v246, v249
    v_fmac_f32 v43, v247, v249
    v_mfma_f32_16x16x32_bf16 v[28:31], v[216:219], v[92:95], v[28:31]
    ds_read_b128 v[76:79], v3 offset:9216
    v_fmac_f32 v32, v240, v252
    v_fmac_f32 v33, v241, v252
    v_mfma_f32_16x16x32_bf16 v[48:51], v[212:215], v[88:91], v[48:51]
    ds_read_b128 v[80:83], v3 offset:2048
    v_fmac_f32 v34, v242, v252
    v_fmac_f32 v35, v243, v252
    v_mfma_f32_16x16x32_bf16 v[48:51], v[220:223], v[92:95], v[48:51]
    ds_read_b128 v[84:87], v3 offset:7168
    v_fmac_f32 v52, v244, v252
    v_fmac_f32 v53, v245, v252
    s_waitcnt lgkmcnt(7)
    v_mfma_f32_16x16x32_bf16 v[16:19], v[224:227], v[56:59], v[16:19]
    ds_read_b128 v[88:91], v3 offset:3072
    v_fmac_f32 v54, v246, v252
    v_fmac_f32 v55, v247, v252
    s_waitcnt lgkmcnt(7)
    v_mfma_f32_16x16x32_bf16 v[16:19], v[232:235], v[60:63], v[16:19]
    ds_read_b128 v[92:95], v3 offset:8192
    v_fmac_f32 v24, v240, v250
    v_fmac_f32 v25, v241, v250
    v_mfma_f32_16x16x32_bf16 v[36:39], v[228:231], v[56:59], v[36:39]
    v_fmac_f32 v26, v242, v250
    v_fmac_f32 v27, v243, v250
    v_mfma_f32_16x16x32_bf16 v[36:39], v[236:239], v[60:63], v[36:39]
    v_fmac_f32 v44, v244, v250
    v_fmac_f32 v45, v245, v250
    s_waitcnt lgkmcnt(7)
    v_mfma_f32_16x16x32_bf16 v[20:23], v[224:227], v[64:67], v[20:23]
    v_fmac_f32 v46, v246, v250
    v_fmac_f32 v47, v247, v250
    s_waitcnt lgkmcnt(6)
    v_mfma_f32_16x16x32_bf16 v[20:23], v[232:235], v[68:71], v[20:23]
    v_fmac_f32 v28, v240, v251
    v_fmac_f32 v29, v241, v251
    v_mfma_f32_16x16x32_bf16 v[40:43], v[228:231], v[64:67], v[40:43]
    v_fmac_f32 v30, v242, v251
    v_fmac_f32 v31, v243, v251
    v_mfma_f32_16x16x32_bf16 v[40:43], v[236:239], v[68:71], v[40:43]
    v_fmac_f32 v48, v244, v251
    v_fmac_f32 v49, v245, v251
    s_waitcnt lgkmcnt(5)
    v_mfma_f32_16x16x32_bf16 v[32:35], v[224:227], v[72:75], v[32:35]
    v_fmac_f32 v50, v246, v251
    v_fmac_f32 v51, v247, v251
    s_waitcnt lgkmcnt(4)
    v_mfma_f32_16x16x32_bf16 v[32:35], v[232:235], v[76:79], v[32:35]
    v_mfma_f32_16x16x32_bf16 v[52:55], v[228:231], v[72:75], v[52:55]
    v_mfma_f32_16x16x32_bf16 v[52:55], v[236:239], v[76:79], v[52:55]
    s_waitcnt lgkmcnt(0)
    s_barrier
    v_mfma_f32_16x16x32_bf16 v[24:27], v[224:227], v[80:83], v[24:27]
    ds_read_b128 v[240:243], v12 offset:16384
    v_mfma_f32_16x16x32_bf16 v[24:27], v[232:235], v[84:87], v[24:27]
    ds_read_b128 v[56:59], v3 offset:10240
    v_mfma_f32_16x16x32_bf16 v[44:47], v[228:231], v[80:83], v[44:47]
    ds_read_b128 v[248:251], v13 offset:16384
    v_mfma_f32_16x16x32_bf16 v[44:47], v[236:239], v[84:87], v[44:47]
    ds_read_b128 v[60:63], v3 offset:15360
    v_mfma_f32_16x16x32_bf16 v[28:31], v[224:227], v[88:91], v[28:31]
    ds_read_b128 v[244:247], v12 offset:18432
    v_mfma_f32_16x16x32_bf16 v[28:31], v[232:235], v[92:95], v[28:31]
    ds_read_b128 v[252:255], v13 offset:18432
    v_mfma_f32_16x16x32_bf16 v[48:51], v[228:231], v[88:91], v[48:51]
    ds_read_b128 v[64:67], v3 offset:11264
    v_mfma_f32_16x16x32_bf16 v[48:51], v[236:239], v[92:95], v[48:51]
    ds_read_b128 v[68:71], v3 offset:16384
    s_waitcnt lgkmcnt(6)
    v_mfma_f32_16x16x32_bf16 v[16:19], v[240:243], v[56:59], v[16:19]
    ds_read_b128 v[72:75], v3 offset:14336
    s_waitcnt lgkmcnt(5)
    v_mfma_f32_16x16x32_bf16 v[16:19], v[248:251], v[60:63], v[16:19]
    ds_read_b128 v[76:79], v3 offset:19456
    s_waitcnt lgkmcnt(5)
    v_mfma_f32_16x16x32_bf16 v[36:39], v[244:247], v[56:59], v[36:39]
    ds_read_b128 v[80:83], v3 offset:12288
    s_waitcnt lgkmcnt(5)
    v_mfma_f32_16x16x32_bf16 v[36:39], v[252:255], v[60:63], v[36:39]
    ds_read_b128 v[84:87], v3 offset:17408
    s_waitcnt lgkmcnt(5)
    v_mfma_f32_16x16x32_bf16 v[20:23], v[240:243], v[64:67], v[20:23]
    ds_read_b128 v[88:91], v3 offset:13312
    s_waitcnt lgkmcnt(5)
    v_mfma_f32_16x16x32_bf16 v[20:23], v[248:251], v[68:71], v[20:23]
    ds_read_b128 v[92:95], v3 offset:18432
    v_mfma_f32_16x16x32_bf16 v[40:43], v[244:247], v[64:67], v[40:43]
    v_mfma_f32_16x16x32_bf16 v[40:43], v[252:255], v[68:71], v[40:43]
    s_waitcnt lgkmcnt(5)
    v_mfma_f32_16x16x32_bf16 v[32:35], v[240:243], v[72:75], v[32:35]
    ds_read_b128 v[56:59], v7 offset:5120
    s_waitcnt lgkmcnt(5)
    v_mfma_f32_16x16x32_bf16 v[32:35], v[248:251], v[76:79], v[32:35]
    v_mfma_f32_16x16x32_bf16 v[52:55], v[244:247], v[72:75], v[52:55]
    ds_read_b128 v[60:63], v7 offset:5184
    v_mfma_f32_16x16x32_bf16 v[52:55], v[252:255], v[76:79], v[52:55]
    s_waitcnt lgkmcnt(5)
    v_mfma_f32_16x16x32_bf16 v[24:27], v[240:243], v[80:83], v[24:27]
    ds_read_b128 v[64:67], v7 offset:512
    s_waitcnt lgkmcnt(5)
    v_mfma_f32_16x16x32_bf16 v[24:27], v[248:251], v[84:87], v[24:27]
    v_mfma_f32_16x16x32_bf16 v[44:47], v[244:247], v[80:83], v[44:47]
    ds_read_b128 v[68:71], v7 offset:576
    v_mfma_f32_16x16x32_bf16 v[44:47], v[252:255], v[84:87], v[44:47]
    s_waitcnt lgkmcnt(5)
    v_mfma_f32_16x16x32_bf16 v[28:31], v[240:243], v[88:91], v[28:31]
    s_waitcnt lgkmcnt(4)
    v_mfma_f32_16x16x32_bf16 v[28:31], v[248:251], v[92:95], v[28:31]
    v_mfma_f32_16x16x32_bf16 v[48:51], v[244:247], v[88:91], v[48:51]
    v_mfma_f32_16x16x32_bf16 v[48:51], v[252:255], v[92:95], v[48:51]
    s_waitcnt lgkmcnt(0)
    s_branch p1_j
p1_l1:
    s_barrier
    ds_read_b128 v[96:99], v2 offset:0
    ds_read_b128 v[56:59], v3 offset:0
    ds_read_b128 v[104:107], v2 offset:8192
    ds_read_b128 v[60:63], v3 offset:5120
    ds_read_b128 v[100:103], v2 offset:1024
    ds_read_b128 v[108:111], v2 offset:9216
    ds_read_b128 v[64:67], v3 offset:1024
    ds_read_b128 v[68:71], v3 offset:6144
    ds_read_b128 v[72:75], v3 offset:4096
    ds_read_b128 v[76:79], v3 offset:9216
    s_waitcnt lgkmcnt(8)
    v_mfma_f32_16x16x32_bf16 v[16:19], v[96:99], v[56:59], 0
    ds_read_b128 v[80:83], v3 offset:2048
    s_waitcnt lgkmcnt(7)
    v_mfma_f32_16x16x32_bf16 v[16:19], v[104:107], v[60:63], v[16:19]
    ds_read_b128 v[84:87], v3 offset:7168
    s_waitcnt lgkmcnt(7)
    v_mfma_f32_16x16x32_bf16 v[36:39], v[100:103], v[56:59], 0
    ds_read_b128 v[88:91], v3 offset:3072
    s_waitcnt lgkmcnt(7)
    v_mfma_f32_16x16x32_bf16 v[36:39], v[108:111], v[60:63], v[36:39]
    ds_read_b128 v[92:95], v3 offset:8192
    s_waitcnt lgkmcnt(7)
    v_mfma_f32_16x16x32_bf16 v[20:23], v[96:99], v[64:67], 0
    s_waitcnt lgkmcnt(6)
    v_mfma_f32_16x16x32_bf16 v[20:23], v[104:107], v[68:71], v[20:23]
    v_mfma_f32_16x16x32_bf16 v[40:43], v[100:103], v[64:67], 0
    v_mfma_f32_16x16x32_bf16 v[40:43], v[108:111], v[68:71], v[40:43]
    s_waitcnt lgkmcnt(5)
    v_mfma_f32_16x16x32_bf16 v[32:35], v[96:99], v[72:75], 0
    s_waitcnt lgkmcnt(4)
    v_mfma_f32_16x16x32_bf16 v[32:35], v[104:107], v[76:79], v[32:35]
    v_mfma_f32_16x16x32_bf16 v[52:55], v[100:103], v[72:75], 0
    v_mfma_f32_16x16x32_bf16 v[52:55], v[108:111], v[76:79], v[52:55]
    s_waitcnt lgkmcnt(0)
    s_barrier
    v_mfma_f32_16x16x32_bf16 v[24:27], v[96:99], v[80:83], 0
    ds_read_b128 v[112:115], v2 offset:16384
    v_mfma_f32_16x16x32_bf16 v[24:27], v[104:107], v[84:87], v[24:27]
    ds_read_b128 v[56:59], v3 offset:10240
    v_mfma_f32_16x16x32_bf16 v[44:47], v[100:103], v[80:83], 0
    ds_read_b128 v[120:123], v2 offset:24576
    v_mfma_f32_16x16x32_bf16 v[44:47], v[108:111], v[84:87], v[44:47]
    ds_read_b128 v[60:63], v3 offset:15360
    v_mfma_f32_16x16x32_bf16 v[28:31], v[96:99], v[88:91], 0
    ds_read_b128 v[116:119], v2 offset:17408
    v_mfma_f32_16x16x32_bf16 v[28:31], v[104:107], v[92:95], v[28:31]
    ds_read_b128 v[124:127], v2 offset:25600
    v_mfma_f32_16x16x32_bf16 v[48:51], v[100:103], v[88:91], 0
    ds_read_b128 v[64:67], v3 offset:11264
    v_mfma_f32_16x16x32_bf16 v[48:51], v[108:111], v[92:95], v[48:51]
    ds_read_b128 v[68:71], v3 offset:16384
    s_waitcnt lgkmcnt(6)
    v_mfma_f32_16x16x32_bf16 v[16:19], v[112:115], v[56:59], v[16:19]
    ds_read_b128 v[72:75], v3 offset:14336
    s_waitcnt lgkmcnt(5)
    v_mfma_f32_16x16x32_bf16 v[16:19], v[120:123], v[60:63], v[16:19]
    ds_read_b128 v[76:79], v3 offset:19456
    s_waitcnt lgkmcnt(5)
    v_mfma_f32_16x16x32_bf16 v[36:39], v[116:119], v[56:59], v[36:39]
    ds_read_b128 v[80:83], v3 offset:12288
    s_waitcnt lgkmcnt(5)
    v_mfma_f32_16x16x32_bf16 v[36:39], v[124:127], v[60:63], v[36:39]
    ds_read_b128 v[84:87], v3 offset:17408
    s_waitcnt lgkmcnt(5)
    v_mfma_f32_16x16x32_bf16 v[20:23], v[112:115], v[64:67], v[20:23]
    ds_read_b128 v[88:91], v3 offset:13312
    s_waitcnt lgkmcnt(5)
    v_mfma_f32_16x16x32_bf16 v[20:23], v[120:123], v[68:71], v[20:23]
    ds_read_b128 v[92:95], v3 offset:18432
    v_mfma_f32_16x16x32_bf16 v[40:43], v[116:119], v[64:67], v[40:43]
    v_mfma_f32_16x16x32_bf16 v[40:43], v[124:127], v[68:71], v[40:43]
    s_waitcnt lgkmcnt(5)
    v_mfma_f32_16x16x32_bf16 v[32:35], v[112:115], v[72:75], v[32:35]
    s_waitcnt lgkmcnt(4)
    v_mfma_f32_16x16x32_bf16 v[32:35], v[120:123], v[76:79], v[32:35]
    v_mfma_f32_16x16x32_bf16 v[52:55], v[116:119], v[72:75], v[52:55]
    v_mfma_f32_16x16x32_bf16 v[52:55], v[124:127], v[76:79], v[52:55]
    s_waitcnt lgkmcnt(0)
    s_barrier
    v_mfma_f32_16x16x32_bf16 v[24:27], v[112:115], v[80:83], v[24:27]
    ds_read_b128 v[128:131], v2 offset:32768
    v_mfma_f32_16x16x32_bf16 v[24:27], v[120:123], v[84:87], v[24:27]
    ds_read_b128 v[56:59], v3 offset:20480
    v_mfma_f32_16x16x32_bf16 v[44:47], v[116:119], v[80:83], v[44:47]
    ds_read_b128 v[136:139], v2 offset:40960
    v_mfma_f32_16x16x32_bf16 v[44:47], v[124:127], v[84:87], v[44:47]
    ds_read_b128 v[60:63], v3 offset:25600
    v_mfma_f32_16x16x32_bf16 v[28:31], v[112:115], v[88:91], v[28:31]
    ds_read_b128 v[132:135], v2 offset:33792
    v_mfma_f32_16x16x32_bf16 v[28:31], v[120:123], v[92:95], v[28:31]
    ds_read_b128 v[140:143], v2 offset:41984
    v_mfma_f32_16x16x32_bf16 v[48:51], v[116:119], v[88:91], v[48:51]
    ds_read_b128 v[64:67], v3 offset:21504
    v_mfma_f32_16x16x32_bf16 v[48:51], v[124:127], v[92:95], v[48:51]
    ds_read_b128 v[68:71], v3 offset:26624
    s_waitcnt lgkmcnt(6)
    v_mfma_f32_16x16x32_bf16 v[16:19], v[128:131], v[56:59], v[16:19]
    ds_read_b128 v[72:75], v3 offset:24576
    s_waitcnt lgkmcnt(5)
    v_mfma_f32_16x16x32_bf16 v[16:19], v[136:139], v[60:63], v[16:19]
    ds_read_b128 v[76:79], v3 offset:29696
    s_waitcnt lgkmcnt(5)
    v_mfma_f32_16x16x32_bf16 v[36:39], v[132:135], v[56:59], v[36:39]
    ds_read_b128 v[80:83], v3 offset:22528
    s_waitcnt lgkmcnt(5)
    v_mfma_f32_16x16x32_bf16 v[36:39], v[140:143], v[60:63], v[36:39]
    ds_read_b128 v[84:87], v3 offset:27648
    s_waitcnt lgkmcnt(5)
    v_mfma_f32_16x16x32_bf16 v[20:23], v[128:131], v[64:67], v[20:23]
    ds_read_b128 v[88:91], v3 offset:23552
    s_waitcnt lgkmcnt(5)
    v_mfma_f32_16x16x32_bf16 v[20:23], v[136:139], v[68:71], v[20:23]
    ds_read_b128 v[92:95], v3 offset:28672
    v_mfma_f32_16x16x32_bf16 v[40:43], v[132:135], v[64:67], v[40:43]
    v_mfma_f32_16x16x32_bf16 v[40:43], v[140:143], v[68:71], v[40:43]
    s_waitcnt lgkmcnt(5)
    v_mfma_f32_16x16x32_bf16 v[32:35], v[128:131], v[72:75], v[32:35]
    s_waitcnt lgkmcnt(4)
    v_mfma_f32_16x16x32_bf16 v[32:35], v[136:139], v[76:79], v[32:35]
    v_mfma_f32_16x16x32_bf16 v[52:55], v[132:135], v[72:75], v[52:55]
    v_mfma_f32_16x16x32_bf16 v[52:55], v[140:143], v[76:79], v[52:55]
    s_waitcnt lgkmcnt(0)
    s_barrier
    v_mfma_f32_16x16x32_bf16 v[24:27], v[128:131], v[80:83], v[24:27]
    ds_read_b128 v[144:147], v2 offset:49152
    v_mfma_f32_16x16x32_bf16 v[24:27], v[136:139], v[84:87], v[24:27]
    ds_read_b128 v[56:59], v3 offset:30720
    v_mfma_f32_16x16x32_bf16 v[44:47], v[132:135], v[80:83], v[44:47]
    ds_read_b128 v[152:155], v2 offset:57344
    v_mfma_f32_16x16x32_bf16 v[44:47], v[140:143], v[84:87], v[44:47]
    ds_read_b128 v[60:63], v3 offset:35840
    v_mfma_f32_16x16x32_bf16 v[28:31], v[128:131], v[88:91], v[28:31]
    ds_read_b128 v[148:151], v2 offset:50176
    v_mfma_f32_16x16x32_bf16 v[28:31], v[136:139], v[92:95], v[28:31]
    ds_read_b128 v[156:159], v2 offset:58368
    v_mfma_f32_16x16x32_bf16 v[48:51], v[132:135], v[88:91], v[48:51]
    ds_read_b128 v[64:67], v3 offset:31744
    v_mfma_f32_16x16x32_bf16 v[48:51], v[140:143], v[92:95], v[48:51]
    ds_read_b128 v[68:71], v3 offset:36864
    s_waitcnt lgkmcnt(6)
    v_mfma_f32_16x16x32_bf16 v[16:19], v[144:147], v[56:59], v[16:19]
    ds_read_b128 v[72:75], v3 offset:34816
    s_waitcnt lgkmcnt(5)
    v_mfma_f32_16x16x32_bf16 v[16:19], v[152:155], v[60:63], v[16:19]
    ds_read_b128 v[76:79], v3 offset:39936
    s_waitcnt lgkmcnt(5)
    v_mfma_f32_16x16x32_bf16 v[36:39], v[148:151], v[56:59], v[36:39]
    ds_read_b128 v[80:83], v3 offset:32768
    s_waitcnt lgkmcnt(5)
    v_mfma_f32_16x16x32_bf16 v[36:39], v[156:159], v[60:63], v[36:39]
    ds_read_b128 v[84:87], v3 offset:37888
    s_waitcnt lgkmcnt(5)
    v_mfma_f32_16x16x32_bf16 v[20:23], v[144:147], v[64:67], v[20:23]
    ds_read_b128 v[88:91], v3 offset:33792
    s_waitcnt lgkmcnt(5)
    v_mfma_f32_16x16x32_bf16 v[20:23], v[152:155], v[68:71], v[20:23]
    ds_read_b128 v[92:95], v3 offset:38912
    v_mfma_f32_16x16x32_bf16 v[40:43], v[148:151], v[64:67], v[40:43]
    v_mfma_f32_16x16x32_bf16 v[40:43], v[156:159], v[68:71], v[40:43]
    s_waitcnt lgkmcnt(5)
    v_mfma_f32_16x16x32_bf16 v[32:35], v[144:147], v[72:75], v[32:35]
    s_waitcnt lgkmcnt(4)
    v_mfma_f32_16x16x32_bf16 v[32:35], v[152:155], v[76:79], v[32:35]
    v_mfma_f32_16x16x32_bf16 v[52:55], v[148:151], v[72:75], v[52:55]
    v_mfma_f32_16x16x32_bf16 v[52:55], v[156:159], v[76:79], v[52:55]
    s_waitcnt lgkmcnt(0)
    s_barrier
    v_mfma_f32_16x16x32_bf16 v[24:27], v[144:147], v[80:83], v[24:27]
    ds_read_b128 v[160:163], v2 offset:0
    v_mfma_f32_16x16x32_bf16 v[24:27], v[152:155], v[84:87], v[24:27]
    ds_read_b128 v[56:59], v3 offset:40960
    v_mfma_f32_16x16x32_bf16 v[44:47], v[148:151], v[80:83], v[44:47]
    ds_read_b128 v[168:171], v2 offset:8192
    v_mfma_f32_16x16x32_bf16 v[44:47], v[156:159], v[84:87], v[44:47]
    ds_read_b128 v[60:63], v3 offset:46080
    v_mfma_f32_16x16x32_bf16 v[28:31], v[144:147], v[88:91], v[28:31]
    ds_read_b128 v[164:167], v2 offset:1024
    v_mfma_f32_16x16x32_bf16 v[28:31], v[152:155], v[92:95], v[28:31]
    ds_read_b128 v[172:175], v2 offset:9216
    v_mfma_f32_16x16x32_bf16 v[48:51], v[148:151], v[88:91], v[48:51]
    ds_read_b128 v[64:67], v3 offset:41984
    v_mfma_f32_16x16x32_bf16 v[48:51], v[156:159], v[92:95], v[48:51]
    ds_read_b128 v[68:71], v3 offset:47104
    s_waitcnt lgkmcnt(6)
    v_mfma_f32_16x16x32_bf16 v[16:19], v[160:163], v[56:59], v[16:19]
    ds_read_b128 v[72:75], v3 offset:45056
    s_waitcnt lgkmcnt(5)
    v_mfma_f32_16x16x32_bf16 v[16:19], v[168:171], v[60:63], v[16:19]
    ds_read_b128 v[76:79], v3 offset:50176
    s_waitcnt lgkmcnt(5)
    v_mfma_f32_16x16x32_bf16 v[36:39], v[164:167], v[56:59], v[36:39]
    ds_read_b128 v[80:83], v3 offset:43008
    s_waitcnt lgkmcnt(5)
    v_mfma_f32_16x16x32_bf16 v[36:39], v[172:175], v[60:63], v[36:39]
    ds_read_b128 v[84:87], v3 offset:48128
    s_waitcnt lgkmcnt(5)
    v_mfma_f32_16x16x32_bf16 v[20:23], v[160:163], v[64:67], v[20:23]
    ds_read_b128 v[88:91], v3 offset:44032
    s_waitcnt lgkmcnt(5)
    v_mfma_f32_16x16x32_bf16 v[20:23], v[168:171], v[68:71], v[20:23]
    ds_read_b128 v[92:95], v3 offset:49152
    v_mfma_f32_16x16x32_bf16 v[40:43], v[164:167], v[64:67], v[40:43]
    v_mfma_f32_16x16x32_bf16 v[40:43], v[172:175], v[68:71], v[40:43]
    s_waitcnt lgkmcnt(5)
    v_mfma_f32_16x16x32_bf16 v[32:35], v[160:163], v[72:75], v[32:35]
    s_waitcnt lgkmcnt(4)
    v_mfma_f32_16x16x32_bf16 v[32:35], v[168:171], v[76:79], v[32:35]
    v_mfma_f32_16x16x32_bf16 v[52:55], v[164:167], v[72:75], v[52:55]
    v_mfma_f32_16x16x32_bf16 v[52:55], v[172:175], v[76:79], v[52:55]
    s_waitcnt lgkmcnt(0)
    s_barrier
    v_mfma_f32_16x16x32_bf16 v[24:27], v[160:163], v[80:83], v[24:27]
    ds_read_b128 v[176:179], v2 offset:16384
    v_mfma_f32_16x16x32_bf16 v[24:27], v[168:171], v[84:87], v[24:27]
    ds_read_b128 v[56:59], v3 offset:51200
    v_mfma_f32_16x16x32_bf16 v[44:47], v[164:167], v[80:83], v[44:47]
    ds_read_b128 v[184:187], v2 offset:24576
    v_mfma_f32_16x16x32_bf16 v[44:47], v[172:175], v[84:87], v[44:47]
    ds_read_b128 v[60:63], v3 offset:56320
    v_mfma_f32_16x16x32_bf16 v[28:31], v[160:163], v[88:91], v[28:31]
    ds_read_b128 v[180:183], v2 offset:17408
    v_mfma_f32_16x16x32_bf16 v[28:31], v[168:171], v[92:95], v[28:31]
    ds_read_b128 v[188:191], v2 offset:25600
    v_mfma_f32_16x16x32_bf16 v[48:51], v[164:167], v[88:91], v[48:51]
    ds_read_b128 v[64:67], v3 offset:52224
    v_mfma_f32_16x16x32_bf16 v[48:51], v[172:175], v[92:95], v[48:51]
    ds_read_b128 v[68:71], v3 offset:57344
    s_waitcnt lgkmcnt(6)
    v_mfma_f32_16x16x32_bf16 v[16:19], v[176:179], v[56:59], v[16:19]
    ds_read_b128 v[72:75], v3 offset:55296
    s_waitcnt lgkmcnt(5)
    v_mfma_f32_16x16x32_bf16 v[16:19], v[184:187], v[60:63], v[16:19]
    ds_read_b128 v[76:79], v3 offset:60416
    s_waitcnt lgkmcnt(5)
    v_mfma_f32_16x16x32_bf16 v[36:39], v[180:183], v[56:59], v[36:39]
    ds_read_b128 v[80:83], v3 offset:53248
    s_waitcnt lgkmcnt(5)
    v_mfma_f32_16x16x32_bf16 v[36:39], v[188:191], v[60:63], v[36:39]
    ds_read_b128 v[84:87], v3 offset:58368
    s_waitcnt lgkmcnt(5)
    v_mfma_f32_16x16x32_bf16 v[20:23], v[176:179], v[64:67], v[20:23]
    ds_read_b128 v[88:91], v3 offset:54272
    s_waitcnt lgkmcnt(5)
    v_mfma_f32_16x16x32_bf16 v[20:23], v[184:187], v[68:71], v[20:23]
    ds_read_b128 v[92:95], v3 offset:59392
    v_mfma_f32_16x16x32_bf16 v[40:43], v[180:183], v[64:67], v[40:43]
    v_mfma_f32_16x16x32_bf16 v[40:43], v[188:191], v[68:71], v[40:43]
    s_waitcnt lgkmcnt(5)
    v_mfma_f32_16x16x32_bf16 v[32:35], v[176:179], v[72:75], v[32:35]
    s_waitcnt lgkmcnt(4)
    v_mfma_f32_16x16x32_bf16 v[32:35], v[184:187], v[76:79], v[32:35]
    v_mfma_f32_16x16x32_bf16 v[52:55], v[180:183], v[72:75], v[52:55]
    v_mfma_f32_16x16x32_bf16 v[52:55], v[188:191], v[76:79], v[52:55]
    s_waitcnt lgkmcnt(0)
    s_barrier
    v_mfma_f32_16x16x32_bf16 v[24:27], v[176:179], v[80:83], v[24:27]
    ds_read_b128 v[192:195], v2 offset:32768
    v_mfma_f32_16x16x32_bf16 v[24:27], v[184:187], v[84:87], v[24:27]
    ds_read_b128 v[56:59], v3 offset:61440
    v_mfma_f32_16x16x32_bf16 v[44:47], v[180:183], v[80:83], v[44:47]
    ds_read_b128 v[200:203], v2 offset:40960
    v_mfma_f32_16x16x32_bf16 v[44:47], v[188:191], v[84:87], v[44:47]
    ds_read_b128 v[60:63], v4 offset:1024
    v_mfma_f32_16x16x32_bf16 v[28:31], v[176:179], v[88:91], v[28:31]
    ds_read_b128 v[196:199], v2 offset:33792
    v_mfma_f32_16x16x32_bf16 v[28:31], v[184:187], v[92:95], v[28:31]
    ds_read_b128 v[204:207], v2 offset:41984
    v_mfma_f32_16x16x32_bf16 v[48:51], v[180:183], v[88:91], v[48:51]
    ds_read_b128 v[64:67], v3 offset:62464
    v_mfma_f32_16x16x32_bf16 v[48:51], v[188:191], v[92:95], v[48:51]
    ds_read_b128 v[68:71], v4 offset:2048
    s_waitcnt lgkmcnt(6)
    v_mfma_f32_16x16x32_bf16 v[16:19], v[192:195], v[56:59], v[16:19]
    ds_read_b128 v[72:75], v4 offset:0
    s_waitcnt lgkmcnt(5)
    v_mfma_f32_16x16x32_bf16 v[16:19], v[200:203], v[60:63], v[16:19]
    ds_read_b128 v[76:79], v4 offset:5120
    s_waitcnt lgkmcnt(5)
    v_mfma_f32_16x16x32_bf16 v[36:39], v[196:199], v[56:59], v[36:39]
    ds_read_b128 v[80:83], v3 offset:63488
    s_waitcnt lgkmcnt(5)
    v_mfma_f32_16x16x32_bf16 v[36:39], v[204:207], v[60:63], v[36:39]
    ds_read_b128 v[84:87], v4 offset:3072
    s_waitcnt lgkmcnt(5)
    v_mfma_f32_16x16x32_bf16 v[20:23], v[192:195], v[64:67], v[20:23]
    ds_read_b128 v[88:91], v3 offset:64512
    s_waitcnt lgkmcnt(5)
    v_mfma_f32_16x16x32_bf16 v[20:23], v[200:203], v[68:71], v[20:23]
    ds_read_b128 v[92:95], v4 offset:4096
    v_mfma_f32_16x16x32_bf16 v[40:43], v[196:199], v[64:67], v[40:43]
    v_mfma_f32_16x16x32_bf16 v[40:43], v[204:207], v[68:71], v[40:43]
    s_waitcnt lgkmcnt(5)
    v_mfma_f32_16x16x32_bf16 v[32:35], v[192:195], v[72:75], v[32:35]
    s_waitcnt lgkmcnt(4)
    v_mfma_f32_16x16x32_bf16 v[32:35], v[200:203], v[76:79], v[32:35]
    v_mfma_f32_16x16x32_bf16 v[52:55], v[196:199], v[72:75], v[52:55]
    v_mfma_f32_16x16x32_bf16 v[52:55], v[204:207], v[76:79], v[52:55]
    s_waitcnt lgkmcnt(0)
    s_barrier
    v_mfma_f32_16x16x32_bf16 v[24:27], v[192:195], v[80:83], v[24:27]
    ds_read_b128 v[208:211], v2 offset:49152
    v_mfma_f32_16x16x32_bf16 v[24:27], v[200:203], v[84:87], v[24:27]
    ds_read_b128 v[56:59], v4 offset:6144
    ds_read_b128 v[240:243], v7 offset:0
    v_mfma_f32_16x16x32_bf16 v[44:47], v[196:199], v[80:83], v[44:47]
    ds_read_b128 v[216:219], v2 offset:57344
    ds_read_b128 v[244:247], v7 offset:64
    v_mfma_f32_16x16x32_bf16 v[44:47], v[204:207], v[84:87], v[44:47]
    ds_read_b128 v[60:63], v4 offset:11264
    ds_read_b32 v248, v9 offset:0
    v_mfma_f32_16x16x32_bf16 v[28:31], v[192:195], v[88:91], v[28:31]
    ds_read_b128 v[212:215], v2 offset:50176
    ds_read_b32 v249, v9 offset:64
    v_mfma_f32_16x16x32_bf16 v[28:31], v[200:203], v[92:95], v[28:31]
    ds_read_b128 v[220:223], v2 offset:58368
    ds_read_b32 v250, v9 offset:128
    v_mfma_f32_16x16x32_bf16 v[48:51], v[196:199], v[88:91], v[48:51]
    ds_read_b128 v[64:67], v4 offset:7168
    ds_read_b32 v251, v9 offset:192
    v_mfma_f32_16x16x32_bf16 v[48:51], v[204:207], v[92:95], v[48:51]
    ds_read_b128 v[68:71], v4 offset:12288
    ds_read_b32 v252, v9 offset:256
    s_waitcnt lgkmcnt(13)
    v_mfma_f32_16x16x32_bf16 v[16:19], v[208:211], v[56:59], v[16:19]
    ds_read_b128 v[72:75], v4 offset:10240
    s_waitcnt lgkmcnt(10)
    v_mfma_f32_16x16x32_bf16 v[16:19], v[216:219], v[60:63], v[16:19]
    ds_read_b128 v[76:79], v4 offset:15360
    s_waitcnt lgkmcnt(9)
    v_mfma_f32_16x16x32_bf16 v[36:39], v[212:215], v[56:59], v[36:39]
    ds_read_b128 v[80:83], v4 offset:8192
    s_waitcnt lgkmcnt(8)
    v_mfma_f32_16x16x32_bf16 v[36:39], v[220:223], v[60:63], v[36:39]
    ds_read_b128 v[84:87], v4 offset:13312
    s_waitcnt lgkmcnt(7)
    v_mfma_f32_16x16x32_bf16 v[20:23], v[208:211], v[64:67], v[20:23]
    ds_read_b128 v[88:91], v4 offset:9216
    s_waitcnt lgkmcnt(6)
    v_mfma_f32_16x16x32_bf16 v[20:23], v[216:219], v[68:71], v[20:23]
    ds_read_b128 v[92:95], v4 offset:14336
    v_mfma_f32_16x16x32_bf16 v[40:43], v[212:215], v[64:67], v[40:43]
    v_mfma_f32_16x16x32_bf16 v[40:43], v[220:223], v[68:71], v[40:43]
    s_waitcnt lgkmcnt(5)
    v_mfma_f32_16x16x32_bf16 v[32:35], v[208:211], v[72:75], v[32:35]
    s_waitcnt lgkmcnt(4)
    v_mfma_f32_16x16x32_bf16 v[32:35], v[216:219], v[76:79], v[32:35]
    v_fmac_f32 v16, v240, v248
    v_fmac_f32 v17, v241, v248
    v_mfma_f32_16x16x32_bf16 v[52:55], v[212:215], v[72:75], v[52:55]
    v_fmac_f32 v18, v242, v248
    v_fmac_f32 v19, v243, v248
    v_mfma_f32_16x16x32_bf16 v[52:55], v[220:223], v[76:79], v[52:55]
    v_fmac_f32 v36, v244, v248
    v_fmac_f32 v37, v245, v248
    s_waitcnt lgkmcnt(0)
    s_barrier
    v_mfma_f32_16x16x32_bf16 v[24:27], v[208:211], v[80:83], v[24:27]
    ds_read_b128 v[224:227], v2 offset:0
    v_fmac_f32 v38, v246, v248
    v_fmac_f32 v39, v247, v248
    v_mfma_f32_16x16x32_bf16 v[24:27], v[216:219], v[84:87], v[24:27]
    ds_read_b128 v[56:59], v3 offset:0
    v_fmac_f32 v20, v240, v249
    v_fmac_f32 v21, v241, v249
    v_mfma_f32_16x16x32_bf16 v[44:47], v[212:215], v[80:83], v[44:47]
    ds_read_b128 v[232:235], v2 offset:8192
    v_fmac_f32 v22, v242, v249
    v_fmac_f32 v23, v243, v249
    v_mfma_f32_16x16x32_bf16 v[44:47], v[220:223], v[84:87], v[44:47]
    ds_read_b128 v[60:63], v3 offset:5120
    v_fmac_f32 v40, v244, v249
    v_fmac_f32 v41, v245, v249
    v_mfma_f32_16x16x32_bf16 v[28:31], v[208:211], v[88:91], v[28:31]
    ds_read_b128 v[228:231], v2 offset:1024
    v_fmac_f32 v42, v246, v249
    v_fmac_f32 v43, v247, v249
    v_mfma_f32_16x16x32_bf16 v[28:31], v[216:219], v[92:95], v[28:31]
    ds_read_b128 v[236:239], v2 offset:9216
    v_fmac_f32 v32, v240, v252
    v_fmac_f32 v33, v241, v252
    v_mfma_f32_16x16x32_bf16 v[48:51], v[212:215], v[88:91], v[48:51]
    ds_read_b128 v[64:67], v3 offset:1024
    v_fmac_f32 v34, v242, v252
    v_fmac_f32 v35, v243, v252
    v_mfma_f32_16x16x32_bf16 v[48:51], v[220:223], v[92:95], v[48:51]
    ds_read_b128 v[68:71], v3 offset:6144
    v_fmac_f32 v52, v244, v252
    v_fmac_f32 v53, v245, v252
    s_waitcnt lgkmcnt(6)
    v_mfma_f32_16x16x32_bf16 v[16:19], v[224:227], v[56:59], v[16:19]
    ds_read_b128 v[72:75], v3 offset:4096
    v_fmac_f32 v54, v246, v252
    v_fmac_f32 v55, v247, v252
    s_waitcnt lgkmcnt(5)
    v_mfma_f32_16x16x32_bf16 v[16:19], v[232:235], v[60:63], v[16:19]
    ds_read_b128 v[76:79], v3 offset:9216
    v_fmac_f32 v24, v240, v250
    v_fmac_f32 v25, v241, v250
    s_waitcnt lgkmcnt(5)
    v_mfma_f32_16x16x32_bf16 v[36:39], v[228:231], v[56:59], v[36:39]
    ds_read_b128 v[80:83], v3 offset:2048
    v_fmac_f32 v26, v242, v250
    v_fmac_f32 v27, v243, v250
    s_waitcnt lgkmcnt(5)
    v_mfma_f32_16x16x32_bf16 v[36:39], v[236:239], v[60:63], v[36:39]
    ds_read_b128 v[84:87], v3 offset:7168
    v_fmac_f32 v44, v244, v250
    v_fmac_f32 v45, v245, v250
    s_waitcnt lgkmcnt(5)
    v_mfma_f32_16x16x32_bf16 v[20:23], v[224:227], v[64:67], v[20:23]
    ds_read_b128 v[88:91], v3 offset:3072
    v_fmac_f32 v46, v246, v250
    v_fmac_f32 v47, v247, v250
    s_waitcnt lgkmcnt(5)
    v_mfma_f32_16x16x32_bf16 v[20:23], v[232:235], v[68:71], v[20:23]
    ds_read_b128 v[92:95], v3 offset:8192
    v_fmac_f32 v28, v240, v251
    v_fmac_f32 v29, v241, v251
    v_mfma_f32_16x16x32_bf16 v[40:43], v[228:231], v[64:67], v[40:43]
    v_fmac_f32 v30, v242, v251
    v_fmac_f32 v31, v243, v251
    v_mfma_f32_16x16x32_bf16 v[40:43], v[236:239], v[68:71], v[40:43]
    v_fmac_f32 v48, v244, v251
    v_fmac_f32 v49, v245, v251
    s_waitcnt lgkmcnt(5)
    v_mfma_f32_16x16x32_bf16 v[32:35], v[224:227], v[72:75], v[32:35]
    v_fmac_f32 v50, v246, v251
    v_fmac_f32 v51, v247, v251
    s_waitcnt lgkmcnt(4)
    v_mfma_f32_16x16x32_bf16 v[32:35], v[232:235], v[76:79], v[32:35]
    v_mfma_f32_16x16x32_bf16 v[52:55], v[228:231], v[72:75], v[52:55]
    v_mfma_f32_16x16x32_bf16 v[52:55], v[236:239], v[76:79], v[52:55]
    s_waitcnt lgkmcnt(0)
    s_barrier
    v_mfma_f32_16x16x32_bf16 v[24:27], v[224:227], v[80:83], v[24:27]
    ds_read_b128 v[240:243], v2 offset:16384
    v_mfma_f32_16x16x32_bf16 v[24:27], v[232:235], v[84:87], v[24:27]
    ds_read_b128 v[56:59], v3 offset:10240
    v_mfma_f32_16x16x32_bf16 v[44:47], v[228:231], v[80:83], v[44:47]
    ds_read_b128 v[248:251], v2 offset:24576
    v_mfma_f32_16x16x32_bf16 v[44:47], v[236:239], v[84:87], v[44:47]
    ds_read_b128 v[60:63], v3 offset:15360
    v_mfma_f32_16x16x32_bf16 v[28:31], v[224:227], v[88:91], v[28:31]
    ds_read_b128 v[244:247], v2 offset:17408
    v_mfma_f32_16x16x32_bf16 v[28:31], v[232:235], v[92:95], v[28:31]
    ds_read_b128 v[252:255], v2 offset:25600
    v_mfma_f32_16x16x32_bf16 v[48:51], v[228:231], v[88:91], v[48:51]
    ds_read_b128 v[64:67], v3 offset:11264
    v_mfma_f32_16x16x32_bf16 v[48:51], v[236:239], v[92:95], v[48:51]
    ds_read_b128 v[68:71], v3 offset:16384
    s_waitcnt lgkmcnt(6)
    v_mfma_f32_16x16x32_bf16 v[16:19], v[240:243], v[56:59], v[16:19]
    ds_read_b128 v[72:75], v3 offset:14336
    s_waitcnt lgkmcnt(5)
    v_mfma_f32_16x16x32_bf16 v[16:19], v[248:251], v[60:63], v[16:19]
    ds_read_b128 v[76:79], v3 offset:19456
    s_waitcnt lgkmcnt(5)
    v_mfma_f32_16x16x32_bf16 v[36:39], v[244:247], v[56:59], v[36:39]
    ds_read_b128 v[80:83], v3 offset:12288
    s_waitcnt lgkmcnt(5)
    v_mfma_f32_16x16x32_bf16 v[36:39], v[252:255], v[60:63], v[36:39]
    ds_read_b128 v[84:87], v3 offset:17408
    s_waitcnt lgkmcnt(5)
    v_mfma_f32_16x16x32_bf16 v[20:23], v[240:243], v[64:67], v[20:23]
    ds_read_b128 v[88:91], v3 offset:13312
    s_waitcnt lgkmcnt(5)
    v_mfma_f32_16x16x32_bf16 v[20:23], v[248:251], v[68:71], v[20:23]
    ds_read_b128 v[92:95], v3 offset:18432
    v_mfma_f32_16x16x32_bf16 v[40:43], v[244:247], v[64:67], v[40:43]
    v_mfma_f32_16x16x32_bf16 v[40:43], v[252:255], v[68:71], v[40:43]
    s_waitcnt lgkmcnt(5)
    v_mfma_f32_16x16x32_bf16 v[32:35], v[240:243], v[72:75], v[32:35]
    ds_read_b128 v[56:59], v7 offset:5120
    s_waitcnt lgkmcnt(5)
    v_mfma_f32_16x16x32_bf16 v[32:35], v[248:251], v[76:79], v[32:35]
    v_mfma_f32_16x16x32_bf16 v[52:55], v[244:247], v[72:75], v[52:55]
    ds_read_b128 v[60:63], v7 offset:5184
    v_mfma_f32_16x16x32_bf16 v[52:55], v[252:255], v[76:79], v[52:55]
    s_waitcnt lgkmcnt(5)
    v_mfma_f32_16x16x32_bf16 v[24:27], v[240:243], v[80:83], v[24:27]
    ds_read_b128 v[64:67], v7 offset:512
    s_waitcnt lgkmcnt(5)
    v_mfma_f32_16x16x32_bf16 v[24:27], v[248:251], v[84:87], v[24:27]
    v_mfma_f32_16x16x32_bf16 v[44:47], v[244:247], v[80:83], v[44:47]
    ds_read_b128 v[68:71], v7 offset:576
    v_mfma_f32_16x16x32_bf16 v[44:47], v[252:255], v[84:87], v[44:47]
    s_waitcnt lgkmcnt(5)
    v_mfma_f32_16x16x32_bf16 v[28:31], v[240:243], v[88:91], v[28:31]
    s_waitcnt lgkmcnt(4)
    v_mfma_f32_16x16x32_bf16 v[28:31], v[248:251], v[92:95], v[28:31]
    v_mfma_f32_16x16x32_bf16 v[48:51], v[244:247], v[88:91], v[48:51]
    v_mfma_f32_16x16x32_bf16 v[48:51], v[252:255], v[92:95], v[48:51]
    s_waitcnt lgkmcnt(0)
p1_j:
    s_nop 7
    v_pk_fma_f32 v[16:17], v[16:17], v[56:57], s[26:27]
    v_pk_fma_f32 v[18:19], v[18:19], v[58:59], s[26:27]
    v_exp_f32 v72, v16 clamp
    v_exp_f32 v73, v17 clamp
    v_exp_f32 v74, v18 clamp
    v_exp_f32 v75, v19 clamp
    v_max_f32 v16, s26, v16
    v_max_f32 v17, s26, v17
    v_max_f32 v18, s26, v18
    v_max_f32 v19, s26, v19
    v_pk_fma_f32 v[16:17], v[16:17], s[28:29], v[72:73]
    v_pk_fma_f32 v[18:19], v[18:19], s[28:29], v[74:75]
    v_cvt_pk_bf16_f32 v16, v16, v17
    v_cvt_pk_bf16_f32 v17, v18, v19
    v_pk_fma_f32 v[36:37], v[36:37], v[60:61], s[26:27]
    v_pk_fma_f32 v[38:39], v[38:39], v[62:63], s[26:27]
    v_exp_f32 v72, v36 clamp
    v_exp_f32 v73, v37 clamp
    v_exp_f32 v74, v38 clamp
    v_exp_f32 v75, v39 clamp
    v_max_f32 v36, s26, v36
    v_max_f32 v37, s26, v37
    v_max_f32 v38, s26, v38
    v_max_f32 v39, s26, v39
    v_pk_fma_f32 v[36:37], v[36:37], s[28:29], v[72:73]
    v_pk_fma_f32 v[38:39], v[38:39], s[28:29], v[74:75]
    v_cvt_pk_bf16_f32 v18, v36, v37
    v_cvt_pk_bf16_f32 v19, v38, v39
    v_pk_fma_f32 v[20:21], v[20:21], v[56:57], s[26:27]
    v_pk_fma_f32 v[22:23], v[22:23], v[58:59], s[26:27]
    v_exp_f32 v72, v20 clamp
    v_exp_f32 v73, v21 clamp
    v_exp_f32 v74, v22 clamp
    v_exp_f32 v75, v23 clamp
    v_max_f32 v20, s26, v20
    v_max_f32 v21, s26, v21
    v_max_f32 v22, s26, v22
    v_max_f32 v23, s26, v23
    v_pk_fma_f32 v[20:21], v[20:21], s[28:29], v[72:73]
    v_pk_fma_f32 v[22:23], v[22:23], s[28:29], v[74:75]
    v_cvt_pk_bf16_f32 v20, v20, v21
    v_cvt_pk_bf16_f32 v21, v22, v23
    v_pk_fma_f32 v[40:41], v[40:41], v[60:61], s[26:27]
    v_pk_fma_f32 v[42:43], v[42:43], v[62:63], s[26:27]
    v_exp_f32 v72, v40 clamp
    v_exp_f32 v73, v41 clamp
    v_exp_f32 v74, v42 clamp
    v_exp_f32 v75, v43 clamp
    v_max_f32 v40, s26, v40
    v_max_f32 v41, s26, v41
    v_max_f32 v42, s26, v42
    v_max_f32 v43, s26, v43
    v_pk_fma_f32 v[40:41], v[40:41], s[28:29], v[72:73]
    v_pk_fma_f32 v[42:43], v[42:43], s[28:29], v[74:75]
    v_cvt_pk_bf16_f32 v22, v40, v41
    v_cvt_pk_bf16_f32 v23, v42, v43
    v_pk_mul_f32 v[24:25], v[24:25], v[64:65]
    v_pk_mul_f32 v[26:27], v[26:27], v[66:67]
    v_cvt_pk_bf16_f32 v24, v24, v25
    v_cvt_pk_bf16_f32 v25, v26, v27
    v_pk_mul_f32 v[44:45], v[44:45], v[68:69]
    v_pk_mul_f32 v[46:47], v[46:47], v[70:71]
    v_cvt_pk_bf16_f32 v26, v44, v45
    v_cvt_pk_bf16_f32 v27, v46, v47
    v_pk_mul_f32 v[28:29], v[28:29], v[64:65]
    v_pk_mul_f32 v[30:31], v[30:31], v[66:67]
    v_cvt_pk_bf16_f32 v28, v28, v29
    v_cvt_pk_bf16_f32 v29, v30, v31
    v_pk_mul_f32 v[48:49], v[48:49], v[68:69]
    v_pk_mul_f32 v[50:51], v[50:51], v[70:71]
    v_cvt_pk_bf16_f32 v30, v48, v49
    v_cvt_pk_bf16_f32 v31, v50, v51
    v_mfma_f32_16x16x32_bf16 v[80:83], v[16:19], v[24:27], 0
    s_nop 0
    v_mfma_f32_16x16x32_bf16 v[84:87], v[20:23], v[28:31], 0
    v_mov_b32 v12, 0x3f803f80
    v_pk_fma_f32 v[76:77], v[32:33], v[56:57], s[26:27]
    v_pk_fma_f32 v[78:79], v[34:35], v[58:59], s[26:27]
    v_exp_f32 v72, v76 clamp
    v_exp_f32 v73, v77 clamp
    v_exp_f32 v74, v78 clamp
    v_exp_f32 v75, v79 clamp
    v_max_f32 v76, s26, v76
    v_max_f32 v77, s26, v77
    v_max_f32 v78, s26, v78
    v_max_f32 v79, s26, v79
    v_pk_fma_f32 v[76:77], v[76:77], s[28:29], v[72:73]
    v_pk_fma_f32 v[78:79], v[78:79], s[28:29], v[74:75]
    v_pk_mul_f32 v[32:33], v[32:33], v[64:65]
    v_pk_mul_f32 v[34:35], v[34:35], v[66:67]
    v_cvt_pk_bf16_f32 v36, v32, v33
    v_cvt_pk_bf16_f32 v37, v34, v35
    v_cvt_pk_bf16_f32 v32, v76, v77
    v_cvt_pk_bf16_f32 v33, v78, v79
    v_cndmask_b32 v36, v36, v12, s[36:37]
    v_cndmask_b32 v37, v37, v12, s[36:37]
    ds_write_b128 v11, v[80:83]
    ds_write_b128 v11, v[84:87] offset:1024
    v_pk_fma_f32 v[76:77], v[52:53], v[60:61], s[26:27]
    v_pk_fma_f32 v[78:79], v[54:55], v[62:63], s[26:27]
    v_exp_f32 v72, v76 clamp
    v_exp_f32 v73, v77 clamp
    v_exp_f32 v74, v78 clamp
    v_exp_f32 v75, v79 clamp
    v_max_f32 v76, s26, v76
    v_max_f32 v77, s26, v77
    v_max_f32 v78, s26, v78
    v_max_f32 v79, s26, v79
    v_pk_fma_f32 v[76:77], v[76:77], s[28:29], v[72:73]
    v_pk_fma_f32 v[78:79], v[78:79], s[28:29], v[74:75]
    v_pk_mul_f32 v[52:53], v[52:53], v[68:69]
    v_pk_mul_f32 v[54:55], v[54:55], v[70:71]
    v_cvt_pk_bf16_f32 v38, v52, v53
    v_cvt_pk_bf16_f32 v39, v54, v55
    v_cvt_pk_bf16_f32 v34, v76, v77
    v_cvt_pk_bf16_f32 v35, v78, v79
    v_cndmask_b32 v38, v38, v12, s[36:37]
    v_cndmask_b32 v39, v39, v12, s[36:37]
    v_mfma_f32_16x16x32_bf16 v[88:91], v[32:35], v[24:27], 0
    v_mfma_f32_16x16x32_bf16 v[92:95], v[32:35], v[28:31], 0
    v_mfma_f32_16x16x32_bf16 v[40:43], v[16:19], v[36:39], 0
    v_mfma_f32_16x16x32_bf16 v[44:47], v[20:23], v[36:39], 0
    v_mfma_f32_16x16x32_bf16 v[48:51], v[32:35], v[36:39], 0
    ds_read_b32 v14, v8 offset:0
    ds_read_b32 v12, v8 offset:5120
    ds_read_b32 v15, v8 offset:64
    ds_read_b32 v13, v8 offset:5184
    ds_read_b128 v[72:75], v10 offset:320
    ds_read_b128 v[76:79], v10 offset:384
    ds_read_b128 v[64:67], v10 offset:448
    v_cndmask_b32 v88, v88, v92, s[40:41]
    v_cndmask_b32 v89, v89, v93, s[40:41]
    v_cndmask_b32 v90, v90, v94, s[40:41]
    v_cndmask_b32 v91, v91, v95, s[40:41]
    v_cndmask_b32 v40, v40, v44, s[38:39]
    v_cndmask_b32 v41, v41, v45, s[38:39]
    v_cndmask_b32 v42, v42, v46, s[38:39]
    v_cndmask_b32 v43, v43, v47, s[38:39]
    ds_write_b128 v11, v[40:43] offset:3072
    s_mov_b32 exec_hi, 0
    ds_write_b128 v11, v[88:91] offset:2048
    ds_write_b128 v11, v[48:51] offset:2560
    s_mov_b32 exec_hi, -1
    s_waitcnt lgkmcnt(3)
    v_pk_mul_f32 v[16:17], v[72:73], v[14:15] op_sel_hi:[1,0]
    v_pk_mul_f32 v[18:19], v[74:75], v[14:15] op_sel_hi:[1,0]
    v_pk_mul_f32 v[20:21], v[76:77], v[14:15] op_sel_hi:[1,0]
    v_pk_mul_f32 v[22:23], v[78:79], v[14:15] op_sel_hi:[1,0]
    v_pk_mul_f32 v[24:25], v[64:65], v[14:15] op_sel_hi:[1,0]
    v_pk_mul_f32 v[26:27], v[66:67], v[14:15] op_sel_hi:[1,0]
    v_pk_mul_f32 v[28:29], v[72:73], v[14:15] op_sel:[0,1] op_sel_hi:[1,1]
    v_pk_mul_f32 v[30:31], v[74:75], v[14:15] op_sel:[0,1] op_sel_hi:[1,1]
    v_pk_mul_f32 v[32:33], v[76:77], v[14:15] op_sel:[0,1] op_sel_hi:[1,1]
    v_pk_mul_f32 v[34:35], v[78:79], v[14:15] op_sel:[0,1] op_sel_hi:[1,1]
    v_pk_mul_f32 v[36:37], v[64:65], v[14:15] op_sel:[0,1] op_sel_hi:[1,1]
    v_pk_mul_f32 v[38:39], v[66:67], v[14:15] op_sel:[0,1] op_sel_hi:[1,1]
    s_waitcnt lgkmcnt(0)
    s_barrier
    ds_read_b128 v[56:59], v3 offset:20480
    ds_read_b128 v[60:63], v3 offset:23552
    ds_read_b128 v[64:67], v3 offset:26624
    ds_read_b128 v[68:71], v3 offset:29696
    ds_read_b128 v[72:75], v3 offset:32768
    ds_read_b128 v[76:79], v3 offset:35840
    ds_read_b128 v[80:83], v3 offset:38912
    ds_read_b128 v[84:87], v3 offset:41984
    ds_read_b128 v[88:91], v3 offset:45056
    ds_read_b128 v[92:95], v3 offset:48128
    s_waitcnt lgkmcnt(9)
    v_mfma_f32_16x16x32_bf16 v[16:19], v[56:59], v[96:99], v[16:19]
    s_waitcnt lgkmcnt(8)
    v_mfma_f32_16x16x32_bf16 v[16:19], v[60:63], v[104:107], v[16:19]
    s_waitcnt lgkmcnt(7)
    v_mfma_f32_16x16x32_bf16 v[16:19], v[64:67], v[112:115], v[16:19]
    s_waitcnt lgkmcnt(6)
    v_mfma_f32_16x16x32_bf16 v[16:19], v[68:71], v[120:123], v[16:19]
    v_mfma_f32_16x16x32_bf16 v[28:31], v[56:59], v[100:103], v[28:31]
    ds_read_b128 v[56:59], v3 offset:51200
    s_mul_i32 s30, s18, 5
    v_mfma_f32_16x16x32_bf16 v[28:31], v[60:63], v[108:111], v[28:31]
    ds_read_b128 v[60:63], v3 offset:54272
    v_mfma_f32_16x16x32_bf16 v[28:31], v[64:67], v[116:119], v[28:31]
    ds_read_b128 v[64:67], v3 offset:57344
    s_add_u32 s22, s30, 4
    v_mfma_f32_16x16x32_bf16 v[28:31], v[68:71], v[124:127], v[28:31]
    ds_read_b128 v[68:71], v3 offset:60416
    s_waitcnt lgkmcnt(9)
    v_mfma_f32_16x16x32_bf16 v[16:19], v[72:75], v[128:131], v[16:19]
    s_lshr_b32 s23, s22, 2
    s_waitcnt lgkmcnt(8)
    v_mfma_f32_16x16x32_bf16 v[16:19], v[76:79], v[136:139], v[16:19]
    s_waitcnt lgkmcnt(7)
    v_mfma_f32_16x16x32_bf16 v[16:19], v[80:83], v[144:147], v[16:19]
    s_lshl_b32 s23, s23, 13
    s_waitcnt lgkmcnt(6)
    v_mfma_f32_16x16x32_bf16 v[16:19], v[84:87], v[152:155], v[16:19]
    v_mfma_f32_16x16x32_bf16 v[28:31], v[72:75], v[132:135], v[28:31]
    ds_read_b128 v[72:75], v3 offset:63488
    s_and_b32 s22, s22, 3
    v_mfma_f32_16x16x32_bf16 v[28:31], v[76:79], v[140:143], v[28:31]
    ds_read_b128 v[76:79], v4 offset:1024
    v_mfma_f32_16x16x32_bf16 v[28:31], v[80:83], v[148:151], v[28:31]
    ds_read_b128 v[80:83], v4 offset:4096
    s_lshl_b32 s22, s22, 8
    v_mfma_f32_16x16x32_bf16 v[28:31], v[84:87], v[156:159], v[28:31]
    ds_read_b128 v[84:87], v4 offset:7168
    s_waitcnt lgkmcnt(9)
    v_mfma_f32_16x16x32_bf16 v[16:19], v[88:91], v[160:163], v[16:19]
    s_add_u32 s31, s22, s23
    s_waitcnt lgkmcnt(8)
    v_mfma_f32_16x16x32_bf16 v[16:19], v[92:95], v[168:171], v[16:19]
    s_waitcnt lgkmcnt(7)
    v_mfma_f32_16x16x32_bf16 v[16:19], v[56:59], v[176:179], v[16:19]
    s_mul_i32 s24, s19, 2621440
    s_waitcnt lgkmcnt(6)
    v_mfma_f32_16x16x32_bf16 v[16:19], v[60:63], v[184:187], v[16:19]
    v_mfma_f32_16x16x32_bf16 v[28:31], v[88:91], v[164:167], v[28:31]
    ds_read_b128 v[88:91], v4 offset:10240
    s_add_u32 s24, s24, 5373952
    v_mfma_f32_16x16x32_bf16 v[28:31], v[92:95], v[172:175], v[28:31]
    ds_read_b128 v[92:95], v4 offset:13312
    v_mfma_f32_16x16x32_bf16 v[28:31], v[56:59], v[180:183], v[28:31]
    ds_read_b128 v[56:59], v3 offset:21504
    s_mul_i32 s25, s17, 163840
    v_mfma_f32_16x16x32_bf16 v[28:31], v[60:63], v[188:191], v[28:31]
    ds_read_b128 v[60:63], v3 offset:24576
    s_waitcnt lgkmcnt(9)
    v_mfma_f32_16x16x32_bf16 v[16:19], v[64:67], v[192:195], v[16:19]
    s_add_u32 s24, s24, s25
    s_waitcnt lgkmcnt(8)
    v_mfma_f32_16x16x32_bf16 v[16:19], v[68:71], v[200:203], v[16:19]
    s_waitcnt lgkmcnt(7)
    v_mfma_f32_16x16x32_bf16 v[16:19], v[72:75], v[208:211], v[16:19]
    s_lshl_b32 s25, s16, 11
    s_waitcnt lgkmcnt(6)
    v_mfma_f32_16x16x32_bf16 v[16:19], v[76:79], v[216:219], v[16:19]
    v_mfma_f32_16x16x32_bf16 v[28:31], v[64:67], v[196:199], v[28:31]
    ds_read_b128 v[64:67], v3 offset:27648
    s_add_u32 s24, s24, s25
    v_mfma_f32_16x16x32_bf16 v[28:31], v[68:71], v[204:207], v[28:31]
    ds_read_b128 v[68:71], v3 offset:30720
    v_mfma_f32_16x16x32_bf16 v[28:31], v[72:75], v[212:215], v[28:31]
    ds_read_b128 v[72:75], v3 offset:33792
    v_mfma_f32_16x16x32_bf16 v[28:31], v[76:79], v[220:223], v[28:31]
    ds_read_b128 v[76:79], v3 offset:36864
    s_waitcnt lgkmcnt(9)
    v_mfma_f32_16x16x32_bf16 v[16:19], v[80:83], v[224:227], v[16:19]
    s_waitcnt lgkmcnt(8)
    v_mfma_f32_16x16x32_bf16 v[16:19], v[84:87], v[232:235], v[16:19]
    s_waitcnt lgkmcnt(7)
    v_mfma_f32_16x16x32_bf16 v[16:19], v[88:91], v[240:243], v[16:19]
    s_waitcnt lgkmcnt(6)
    v_mfma_f32_16x16x32_bf16 v[16:19], v[92:95], v[248:251], v[16:19]
    v_mfma_f32_16x16x32_bf16 v[28:31], v[80:83], v[228:231], v[28:31]
    ds_read_b128 v[80:83], v3 offset:39936
    v_mfma_f32_16x16x32_bf16 v[28:31], v[84:87], v[236:239], v[28:31]
    ds_read_b128 v[84:87], v3 offset:43008
    v_mfma_f32_16x16x32_bf16 v[28:31], v[88:91], v[244:247], v[28:31]
    ds_read_b128 v[88:91], v3 offset:46080
    v_mfma_f32_16x16x32_bf16 v[28:31], v[92:95], v[252:255], v[28:31]
    ds_read_b128 v[92:95], v3 offset:49152
    s_waitcnt lgkmcnt(9)
    v_mfma_f32_16x16x32_bf16 v[20:23], v[56:59], v[96:99], v[20:23]
    s_waitcnt lgkmcnt(8)
    v_mfma_f32_16x16x32_bf16 v[20:23], v[60:63], v[104:107], v[20:23]
    s_waitcnt lgkmcnt(7)
    v_mfma_f32_16x16x32_bf16 v[20:23], v[64:67], v[112:115], v[20:23]
    s_waitcnt lgkmcnt(6)
    v_mfma_f32_16x16x32_bf16 v[20:23], v[68:71], v[120:123], v[20:23]
    v_fma_f32 v16, v16, v12, s26
    v_fma_f32 v17, v17, v12, s26
    v_mfma_f32_16x16x32_bf16 v[32:35], v[56:59], v[100:103], v[32:35]
    ds_read_b128 v[56:59], v3 offset:52224
    v_fma_f32 v18, v18, v12, s26
    v_fma_f32 v19, v19, v12, s26
    v_mfma_f32_16x16x32_bf16 v[32:35], v[60:63], v[108:111], v[32:35]
    ds_read_b128 v[60:63], v3 offset:55296
    v_mfma_f32_16x16x32_bf16 v[32:35], v[64:67], v[116:119], v[32:35]
    ds_read_b128 v[64:67], v3 offset:58368
    v_exp_f32 v52, v16 clamp
    v_mfma_f32_16x16x32_bf16 v[32:35], v[68:71], v[124:127], v[32:35]
    ds_read_b128 v[68:71], v3 offset:61440
    v_exp_f32 v53, v17 clamp
    s_waitcnt lgkmcnt(9)
    v_mfma_f32_16x16x32_bf16 v[20:23], v[72:75], v[128:131], v[20:23]
    s_waitcnt lgkmcnt(8)
    v_mfma_f32_16x16x32_bf16 v[20:23], v[76:79], v[136:139], v[20:23]
    v_exp_f32 v54, v18 clamp
    s_waitcnt lgkmcnt(7)
    v_mfma_f32_16x16x32_bf16 v[20:23], v[80:83], v[144:147], v[20:23]
    v_exp_f32 v55, v19 clamp
    s_waitcnt lgkmcnt(6)
    v_mfma_f32_16x16x32_bf16 v[20:23], v[84:87], v[152:155], v[20:23]
    v_mfma_f32_16x16x32_bf16 v[32:35], v[72:75], v[132:135], v[32:35]
    ds_read_b128 v[72:75], v3 offset:64512
    v_max_f32 v16, s26, v16
    v_max_f32 v17, s26, v17
    v_mfma_f32_16x16x32_bf16 v[32:35], v[76:79], v[140:143], v[32:35]
    ds_read_b128 v[76:79], v4 offset:2048
    v_max_f32 v18, s26, v18
    v_max_f32 v19, s26, v19
    v_mfma_f32_16x16x32_bf16 v[32:35], v[80:83], v[148:151], v[32:35]
    ds_read_b128 v[80:83], v4 offset:5120
    v_mfma_f32_16x16x32_bf16 v[32:35], v[84:87], v[156:159], v[32:35]
    ds_read_b128 v[84:87], v4 offset:8192
    v_fma_f32 v16, v16, s28, v52
    v_fma_f32 v17, v17, s28, v53
    s_waitcnt lgkmcnt(9)
    v_mfma_f32_16x16x32_bf16 v[20:23], v[88:91], v[160:163], v[20:23]
    v_fma_f32 v18, v18, s28, v54
    v_fma_f32 v19, v19, s28, v55
    s_waitcnt lgkmcnt(8)
    v_mfma_f32_16x16x32_bf16 v[20:23], v[92:95], v[168:171], v[20:23]
    s_waitcnt lgkmcnt(7)
    v_mfma_f32_16x16x32_bf16 v[20:23], v[56:59], v[176:179], v[20:23]
    v_cvt_pk_bf16_f32 v40, v16, v17
    v_cvt_pk_bf16_f32 v41, v18, v19
    s_waitcnt lgkmcnt(6)
    v_mfma_f32_16x16x32_bf16 v[20:23], v[60:63], v[184:187], v[20:23]
    v_fma_f32 v28, v28, v13, s26
    v_fma_f32 v29, v29, v13, s26
    v_mfma_f32_16x16x32_bf16 v[32:35], v[88:91], v[164:167], v[32:35]
    ds_read_b128 v[88:91], v4 offset:11264
    v_mfma_f32_16x16x32_bf16 v[32:35], v[92:95], v[172:175], v[32:35]
    ds_read_b128 v[92:95], v4 offset:14336
    v_fma_f32 v30, v30, v13, s26
    v_fma_f32 v31, v31, v13, s26
    v_mfma_f32_16x16x32_bf16 v[32:35], v[56:59], v[180:183], v[32:35]
    ds_read_b128 v[56:59], v3 offset:22528
    v_exp_f32 v52, v28 clamp
    v_mfma_f32_16x16x32_bf16 v[32:35], v[60:63], v[188:191], v[32:35]
    ds_read_b128 v[60:63], v3 offset:25600
    s_waitcnt lgkmcnt(9)
    v_mfma_f32_16x16x32_bf16 v[20:23], v[64:67], v[192:195], v[20:23]
    v_exp_f32 v53, v29 clamp
    s_waitcnt lgkmcnt(8)
    v_mfma_f32_16x16x32_bf16 v[20:23], v[68:71], v[200:203], v[20:23]
    v_exp_f32 v54, v30 clamp
    s_waitcnt lgkmcnt(7)
    v_mfma_f32_16x16x32_bf16 v[20:23], v[72:75], v[208:211], v[20:23]
    s_waitcnt lgkmcnt(6)
    v_mfma_f32_16x16x32_bf16 v[20:23], v[76:79], v[216:219], v[20:23]
    v_exp_f32 v55, v31 clamp
    v_mfma_f32_16x16x32_bf16 v[32:35], v[64:67], v[196:199], v[32:35]
    ds_read_b128 v[64:67], v3 offset:28672
    v_max_f32 v28, s26, v28
    v_max_f32 v29, s26, v29
    v_mfma_f32_16x16x32_bf16 v[32:35], v[68:71], v[204:207], v[32:35]
    ds_read_b128 v[68:71], v3 offset:31744
    v_mfma_f32_16x16x32_bf16 v[32:35], v[72:75], v[212:215], v[32:35]
    ds_read_b128 v[72:75], v3 offset:34816
    v_max_f32 v30, s26, v30
    v_max_f32 v31, s26, v31
    v_mfma_f32_16x16x32_bf16 v[32:35], v[76:79], v[220:223], v[32:35]
    ds_read_b128 v[76:79], v3 offset:37888
    v_fma_f32 v28, v28, s28, v52
    v_fma_f32 v29, v29, s28, v53
    s_waitcnt lgkmcnt(9)
    v_mfma_f32_16x16x32_bf16 v[20:23], v[80:83], v[224:227], v[20:23]
    s_waitcnt lgkmcnt(8)
    v_mfma_f32_16x16x32_bf16 v[20:23], v[84:87], v[232:235], v[20:23]
    v_fma_f32 v30, v30, s28, v54
    v_fma_f32 v31, v31, s28, v55
    s_waitcnt lgkmcnt(7)
    v_mfma_f32_16x16x32_bf16 v[20:23], v[88:91], v[240:243], v[20:23]
    v_cvt_pk_bf16_f32 v46, v28, v29
    v_cvt_pk_bf16_f32 v47, v30, v31
    s_waitcnt lgkmcnt(6)
    v_mfma_f32_16x16x32_bf16 v[20:23], v[92:95], v[248:251], v[20:23]
    v_mfma_f32_16x16x32_bf16 v[32:35], v[80:83], v[228:231], v[32:35]
    ds_read_b128 v[80:83], v3 offset:40960
    v_mfma_f32_16x16x32_bf16 v[32:35], v[84:87], v[236:239], v[32:35]
    ds_read_b128 v[84:87], v3 offset:44032
    v_mfma_f32_16x16x32_bf16 v[32:35], v[88:91], v[244:247], v[32:35]
    ds_read_b128 v[88:91], v3 offset:47104
    v_mfma_f32_16x16x32_bf16 v[32:35], v[92:95], v[252:255], v[32:35]
    ds_read_b128 v[92:95], v3 offset:50176
    s_waitcnt lgkmcnt(9)
    v_mfma_f32_16x16x32_bf16 v[24:27], v[56:59], v[96:99], v[24:27]
    s_waitcnt lgkmcnt(8)
    v_mfma_f32_16x16x32_bf16 v[24:27], v[60:63], v[104:107], v[24:27]
    s_waitcnt lgkmcnt(7)
    v_mfma_f32_16x16x32_bf16 v[24:27], v[64:67], v[112:115], v[24:27]
    s_waitcnt lgkmcnt(6)
    v_mfma_f32_16x16x32_bf16 v[24:27], v[68:71], v[120:123], v[24:27]
    v_fma_f32 v20, v20, v12, s26
    v_fma_f32 v21, v21, v12, s26
    v_mfma_f32_16x16x32_bf16 v[36:39], v[56:59], v[100:103], v[36:39]
    ds_read_b128 v[56:59], v3 offset:53248
    v_fma_f32 v22, v22, v12, s26
    v_fma_f32 v23, v23, v12, s26
    v_mfma_f32_16x16x32_bf16 v[36:39], v[60:63], v[108:111], v[36:39]
    ds_read_b128 v[60:63], v3 offset:56320
    v_exp_f32 v52, v20 clamp
    v_mfma_f32_16x16x32_bf16 v[36:39], v[64:67], v[116:119], v[36:39]
    ds_read_b128 v[64:67], v3 offset:59392
    v_exp_f32 v53, v21 clamp
    v_mfma_f32_16x16x32_bf16 v[36:39], v[68:71], v[124:127], v[36:39]
    ds_read_b128 v[68:71], v3 offset:62464
    v_exp_f32 v54, v22 clamp
    s_waitcnt lgkmcnt(9)
    v_mfma_f32_16x16x32_bf16 v[24:27], v[72:75], v[128:131], v[24:27]
    v_exp_f32 v55, v23 clamp
    s_waitcnt lgkmcnt(8)
    v_mfma_f32_16x16x32_bf16 v[24:27], v[76:79], v[136:139], v[24:27]
    v_max_f32 v20, s26, v20
    v_max_f32 v21, s26, v21
    s_waitcnt lgkmcnt(7)
    v_mfma_f32_16x16x32_bf16 v[24:27], v[80:83], v[144:147], v[24:27]
    v_max_f32 v22, s26, v22
    v_max_f32 v23, s26, v23
    s_waitcnt lgkmcnt(6)
    v_mfma_f32_16x16x32_bf16 v[24:27], v[84:87], v[152:155], v[24:27]
    v_fma_f32 v20, v20, s28, v52
    v_fma_f32 v21, v21, s28, v53
    v_mfma_f32_16x16x32_bf16 v[36:39], v[72:75], v[132:135], v[36:39]
    ds_read_b128 v[72:75], v4 offset:0
    v_fma_f32 v22, v22, s28, v54
    v_fma_f32 v23, v23, s28, v55
    v_mfma_f32_16x16x32_bf16 v[36:39], v[76:79], v[140:143], v[36:39]
    ds_read_b128 v[76:79], v4 offset:3072
    v_cvt_pk_bf16_f32 v44, v20, v21
    v_cvt_pk_bf16_f32 v45, v22, v23
    v_mfma_f32_16x16x32_bf16 v[36:39], v[80:83], v[148:151], v[36:39]
    ds_read_b128 v[80:83], v4 offset:6144
    v_fma_f32 v32, v32, v13, s26
    v_fma_f32 v33, v33, v13, s26
    v_mfma_f32_16x16x32_bf16 v[36:39], v[84:87], v[156:159], v[36:39]
    ds_read_b128 v[84:87], v4 offset:9216
    v_fma_f32 v34, v34, v13, s26
    v_fma_f32 v35, v35, v13, s26
    s_waitcnt lgkmcnt(9)
    v_mfma_f32_16x16x32_bf16 v[24:27], v[88:91], v[160:163], v[24:27]
    v_exp_f32 v52, v32 clamp
    s_waitcnt lgkmcnt(8)
    v_mfma_f32_16x16x32_bf16 v[24:27], v[92:95], v[168:171], v[24:27]
    v_exp_f32 v53, v33 clamp
    s_waitcnt lgkmcnt(7)
    v_mfma_f32_16x16x32_bf16 v[24:27], v[56:59], v[176:179], v[24:27]
    v_exp_f32 v54, v34 clamp
    s_waitcnt lgkmcnt(6)
    v_mfma_f32_16x16x32_bf16 v[24:27], v[60:63], v[184:187], v[24:27]
    v_exp_f32 v55, v35 clamp
    v_mfma_f32_16x16x32_bf16 v[36:39], v[88:91], v[164:167], v[36:39]
    ds_read_b128 v[88:91], v4 offset:12288
    v_max_f32 v32, s26, v32
    v_max_f32 v33, s26, v33
    v_mfma_f32_16x16x32_bf16 v[36:39], v[92:95], v[172:175], v[36:39]
    ds_read_b128 v[92:95], v4 offset:15360
    v_max_f32 v34, s26, v34
    v_max_f32 v35, s26, v35
    v_mfma_f32_16x16x32_bf16 v[36:39], v[56:59], v[180:183], v[36:39]
    v_fma_f32 v32, v32, s28, v52
    v_fma_f32 v33, v33, s28, v53
    v_mfma_f32_16x16x32_bf16 v[36:39], v[60:63], v[188:191], v[36:39]
    v_fma_f32 v34, v34, s28, v54
    v_fma_f32 v35, v35, s28, v55
    v_lshrrev_b32 v96, 1, v1
    v_add_u32 v96, 158208, v96
    s_waitcnt lgkmcnt(7)
    v_mfma_f32_16x16x32_bf16 v[24:27], v[64:67], v[192:195], v[24:27]
    v_cvt_pk_bf16_f32 v50, v32, v33
    v_cvt_pk_bf16_f32 v51, v34, v35
    v_mov_b32 v97, 160256
    v_add_u32 v98, 1024, v96
    s_waitcnt lgkmcnt(6)
    v_mfma_f32_16x16x32_bf16 v[24:27], v[68:71], v[200:203], v[24:27]
    v_cndmask_b32 v99, v97, v98, s[42:43]
    v_cndmask_b32 v100, v97, v98, s[40:41]
    s_waitcnt lgkmcnt(5)
    v_mfma_f32_16x16x32_bf16 v[24:27], v[72:75], v[208:211], v[24:27]
    v_and_b32 v101, 1, v5
    v_lshrrev_b32 v102, 2, v5
    s_waitcnt lgkmcnt(4)
    v_mfma_f32_16x16x32_bf16 v[24:27], v[76:79], v[216:219], v[24:27]
    v_lshl_add_u32 v102, v101, 2, v102
    v_add_u32 v102, 8, v102
    v_mfma_f32_16x16x32_bf16 v[36:39], v[64:67], v[196:199], v[36:39]
    v_and_b32 v103, 2, v5
    v_cmp_ne_u32 vcc, 0, v103
    v_mfma_f32_16x16x32_bf16 v[36:39], v[68:71], v[204:207], v[36:39]
    v_cmp_eq_u32 s[44:45], 0, v101
    v_add_u32 v109, s30, v6
    v_mfma_f32_16x16x32_bf16 v[36:39], v[72:75], v[212:215], v[36:39]
    v_cndmask_b32 v102, v102, v101, vcc
    v_lshl_add_u32 v102, v6, 4, v102
    v_mfma_f32_16x16x32_bf16 v[36:39], v[76:79], v[220:223], v[36:39]
    v_lshlrev_b32 v102, 3, v102
    v_add_u32 v103, 159744, v102
    s_waitcnt lgkmcnt(3)
    v_mfma_f32_16x16x32_bf16 v[24:27], v[80:83], v[224:227], v[24:27]
    v_add_u32 v104, 159488, v102
    s_and_b64 s[46:47], s[44:45], s[42:43]
    s_waitcnt lgkmcnt(2)
    v_mfma_f32_16x16x32_bf16 v[24:27], v[84:87], v[232:235], v[24:27]
    s_andn2_b64 s[48:49], s[40:41], s[44:45]
    v_cndmask_b32 v105, v97, v103, s[44:45]
    s_waitcnt lgkmcnt(1)
    v_mfma_f32_16x16x32_bf16 v[24:27], v[88:91], v[240:243], v[24:27]
    v_cndmask_b32 v106, v97, v104, s[46:47]
    v_cndmask_b32 v107, v103, v97, s[44:45]
    s_waitcnt lgkmcnt(0)
    v_mfma_f32_16x16x32_bf16 v[24:27], v[92:95], v[248:251], v[24:27]
    v_cndmask_b32 v108, v97, v104, s[48:49]
    v_lshrrev_b32 v110, 2, v109
    v_mfma_f32_16x16x32_bf16 v[36:39], v[80:83], v[228:231], v[36:39]
    v_and_b32 v109, 3, v109
    v_lshlrev_b32 v109, 8, v109
    v_mfma_f32_16x16x32_bf16 v[36:39], v[84:87], v[236:239], v[36:39]
    v_lshl_add_u32 v109, v110, 13, v109
    v_lshl_add_u32 v109, v5, 4, v109
    v_mfma_f32_16x16x32_bf16 v[36:39], v[88:91], v[244:247], v[36:39]
    v_lshlrev_b32 v110, 4, v5
    v_lshl_add_u32 v110, v6, 2, v110
    v_mfma_f32_16x16x32_bf16 v[36:39], v[92:95], v[252:255], v[36:39]
    v_add_u32 v110, s31, v110
    v_pk_fma_f32 v[24:25], v[24:25], v[12:13], s[26:27] op_sel_hi:[1,0,1]
    v_pk_fma_f32 v[26:27], v[26:27], v[12:13], s[26:27] op_sel_hi:[1,0,1]
    v_exp_f32 v52, v24 clamp
    v_exp_f32 v53, v25 clamp
    v_exp_f32 v54, v26 clamp
    v_exp_f32 v55, v27 clamp
    v_max_f32 v24, s26, v24
    v_max_f32 v25, s26, v25
    v_max_f32 v26, s26, v26
    v_max_f32 v27, s26, v27
    v_pk_fma_f32 v[24:25], v[24:25], s[28:29], v[52:53]
    v_pk_fma_f32 v[26:27], v[26:27], s[28:29], v[54:55]
    v_cvt_pk_bf16_f32 v42, v24, v25
    v_cvt_pk_bf16_f32 v43, v26, v27
    v_pk_fma_f32 v[36:37], v[36:37], v[12:13], s[26:27] op_sel:[0,1,0] op_sel_hi:[1,1,1]
    v_pk_fma_f32 v[38:39], v[38:39], v[12:13], s[26:27] op_sel:[0,1,0] op_sel_hi:[1,1,1]
    v_exp_f32 v52, v36 clamp
    v_exp_f32 v53, v37 clamp
    v_exp_f32 v54, v38 clamp
    v_exp_f32 v55, v39 clamp
    v_max_f32 v36, s26, v36
    v_max_f32 v37, s26, v37
    v_max_f32 v38, s26, v38
    v_max_f32 v39, s26, v39
    v_pk_fma_f32 v[36:37], v[36:37], s[28:29], v[52:53]
    v_pk_fma_f32 v[38:39], v[38:39], s[28:29], v[54:55]
    v_cvt_pk_bf16_f32 v48, v36, v37
    v_cvt_pk_bf16_f32 v49, v38, v39
    s_barrier
    ds_read_b64 v[64:65], v105
    ds_read_b64 v[66:67], v106
    ds_read_b64 v[68:69], v108
    ds_read_b64 v[70:71], v107
    ds_read_b64 v[56:57], v96
    ds_read_b64 v[58:59], v99
    ds_read_b64 v[60:61], v100
    ds_read_b64 v[62:63], v96 offset:512
    s_waitcnt lgkmcnt(4)
    v_mfma_f32_16x16x32_bf16 v[24:27], v[64:67], v[40:43], 0
    v_mfma_f32_16x16x32_bf16 v[24:27], v[68:71], v[42:45], v[24:27]
    v_mfma_f32_16x16x32_bf16 v[36:39], v[64:67], v[46:49], 0
    v_mfma_f32_16x16x32_bf16 v[36:39], v[68:71], v[48:51], v[36:39]
    s_waitcnt lgkmcnt(0)
    v_mfma_f32_16x16x32_bf16 v[16:19], v[56:59], v[40:43], 0
    v_mfma_f32_16x16x32_bf16 v[20:23], v[60:63], v[42:45], 0
    v_mfma_f32_16x16x32_bf16 v[28:31], v[56:59], v[46:49], 0
    v_mfma_f32_16x16x32_bf16 v[32:35], v[60:63], v[48:51], 0
    s_nop 0
    v_add_f32 v26, s21, v26
    v_add_f32 v27, s21, v27
    v_rcp_f32 v26, v26
    v_rcp_f32 v27, v27
    v_add_f32 v38, s21, v38
    v_add_f32 v39, s21, v39
    v_rcp_f32 v38, v38
    v_rcp_f32 v39, v39
    v_pk_mul_f32 v[16:17], v[16:17], v[26:27] op_sel_hi:[1,0]
    v_pk_mul_f32 v[18:19], v[18:19], v[26:27] op_sel_hi:[1,0]
    v_pk_mul_f32 v[20:21], v[20:21], v[26:27] op_sel:[0,1] op_sel_hi:[1,1]
    v_pk_mul_f32 v[22:23], v[22:23], v[26:27] op_sel:[0,1] op_sel_hi:[1,1]
    v_pk_mul_f32 v[24:25], v[24:25], v[26:27]
    v_cvt_pk_bf16_f32 v72, v16, v17
    v_cvt_pk_bf16_f32 v73, v18, v19
    v_cvt_pk_bf16_f32 v74, v20, v21
    v_cvt_pk_bf16_f32 v75, v22, v23
    v_cvt_pk_bf16_f32 v76, v24, v25
    buffer_store_dwordx4 v[72:75], v109, s[8:11], s24 offen offset:0 sc1
    buffer_store_dword v76, v110, s[8:11], s24 offen offset:0 sc1
    v_pk_mul_f32 v[28:29], v[28:29], v[38:39] op_sel_hi:[1,0]
    v_pk_mul_f32 v[30:31], v[30:31], v[38:39] op_sel_hi:[1,0]
    v_pk_mul_f32 v[32:33], v[32:33], v[38:39] op_sel:[0,1] op_sel_hi:[1,1]
    v_pk_mul_f32 v[34:35], v[34:35], v[38:39] op_sel:[0,1] op_sel_hi:[1,1]
    v_pk_mul_f32 v[36:37], v[36:37], v[38:39]
    v_cvt_pk_bf16_f32 v80, v28, v29
    v_cvt_pk_bf16_f32 v81, v30, v31
    v_cvt_pk_bf16_f32 v82, v32, v33
    v_cvt_pk_bf16_f32 v83, v34, v35
    v_cvt_pk_bf16_f32 v84, v36, v37
    buffer_store_dwordx4 v[80:83], v109, s[8:11], s24 offen offset:1024 sc1
    buffer_store_dword v84, v110, s[8:11], s24 offen offset:1024 sc1
    s_waitcnt vmcnt(0)
    s_barrier
    s_lshl_b32 s22, s16, 10
    v_add_u32 v2, s22, v1
    v_add_u32 v14, 65536, v1
    v_add_u32 v15, 0x10000, v14
    s_lshr_b32 s26, s18, 1
    s_and_b32 s27, s18, 1
    s_lshl_b32 s27, s27, 2
    s_add_u32 s27, s27, s16
    s_mul_i32 s22, s26, 10
    v_add_u32 v7, s22, v6
    v_add_u32 v8, 4, v7
    v_lshrrev_b32 v9, 1, v6
    v_add3_u32 v9, v9, s22, 8
    v_and_b32 v13, 1, v6
    v_lshlrev_b32 v13, 3, v13
    s_mul_i32 s25, s17, 163840
    s_lshl_b32 s28, s27, 10
    s_add_u32 s25, s25, s28
    s_cmp_lg_u32 s19, 0
    s_cbranch_scc1 p2_r1
    v_mul_u32_u24 v3, 1280, v5
    v_lshl_add_u32 v7, v7, 4, v3
    v_lshl_add_u32 v8, v8, 4, v3
    v_lshl_add_u32 v9, v9, 4, v3
    v_add_u32 v9, v9, v13
    s_lshl_b32 s35, s17, 3
    s_add_u32 s35, s35, s27
    s_mul_i32 s35, s35, 20480
    buffer_load_dwordx4 v[36:39], v7, s[88:91], s35 offen
    buffer_load_dwordx4 v[40:43], v8, s[88:91], s35 offen
    buffer_load_dwordx2 v[44:45], v9, s[88:91], s35 offen
    s_branch p2_r2
p2_r1:
    v_lshrrev_b32 v3, 2, v7
    v_and_b32 v7, 3, v7
    v_lshlrev_b32 v7, 8, v7
    v_lshl_add_u32 v7, v3, 13, v7
    v_lshl_add_u32 v7, v5, 4, v7
    v_lshrrev_b32 v3, 2, v8
    v_and_b32 v8, 3, v8
    v_lshlrev_b32 v8, 8, v8
    v_lshl_add_u32 v8, v3, 13, v8
    v_lshl_add_u32 v8, v5, 4, v8
    v_lshrrev_b32 v3, 2, v9
    v_and_b32 v9, 3, v9
    v_lshlrev_b32 v9, 8, v9
    v_lshl_add_u32 v9, v3, 13, v9
    v_lshl_add_u32 v9, v5, 4, v9
    v_add_u32 v9, v9, v13
    s_add_u32 s24, s25, 2752512
    buffer_load_dwordx4 v[36:39], v7, s[8:11], s24 offen sc1
    buffer_load_dwordx4 v[40:43], v8, s[8:11], s24 offen sc1
    buffer_load_dwordx2 v[44:45], v9, s[8:11], s24 offen sc1
p2_r2:
    s_lshl_b32 s22, s26, 13
    v_add_u32 v10, s22, v1
    v_add_u32 v11, 65536, v10
    s_lshr_b32 s22, s26, 1
    s_lshl_b32 s22, s22, 4
    s_and_b32 s23, s26, 1
    s_add_u32 s22, s22, s23
    s_lshl_b32 s22, s22, 9
    s_add_u32 s22, s22, 131072
    v_lshrrev_b32 v12, 1, v6
    v_lshl_add_u32 v12, v12, 8, s22
    v_lshl_add_u32 v12, v5, 4, v12
    v_add_u32 v12, v12, v13
    s_mul_i32 s24, s19, 2621440
    s_add_u32 s24, s24, 10616832
    s_add_u32 s24, s24, s25
    s_mul_i32 s28, s19, 131072
    s_add_u32 s28, s28, 28704768
    s_lshl_b32 s29, s17, 3
    s_add_u32 s29, s29, s26
    s_lshl_b32 s29, s29, 10
    s_add_u32 s28, s28, s29
    s_lshl_b32 s29, s27, 7
    s_add_u32 s28, s28, s29
    v_lshlrev_b32 v13, 3, v5
    s_barrier
    ds_read_b128 v[132:135], v14 offset:0
    ds_read_b128 v[136:139], v14 offset:2048
    ds_read_b128 v[140:143], v14 offset:4096
    ds_read_b128 v[144:147], v14 offset:6144
    ds_read_b128 v[148:151], v14 offset:1024
    ds_read_b128 v[152:155], v14 offset:3072
    ds_read_b128 v[156:159], v14 offset:5120
    ds_read_b128 v[160:163], v14 offset:7168
    ds_read_b128 v[164:167], v14 offset:8192
    ds_read_b128 v[168:171], v14 offset:10240
    ds_read_b128 v[172:175], v14 offset:12288
    ds_read_b128 v[176:179], v14 offset:14336
    ds_read_b128 v[180:183], v14 offset:9216
    ds_read_b128 v[184:187], v14 offset:11264
    ds_read_b128 v[188:191], v14 offset:13312
    ds_read_b128 v[192:195], v14 offset:15360
    ds_read_b128 v[196:199], v14 offset:16384
    ds_read_b128 v[200:203], v14 offset:18432
    ds_read_b128 v[204:207], v14 offset:20480
    ds_read_b128 v[208:211], v14 offset:22528
    ds_read_b128 v[212:215], v14 offset:17408
    ds_read_b128 v[216:219], v14 offset:19456
    ds_read_b128 v[220:223], v14 offset:21504
    ds_read_b128 v[224:227], v14 offset:23552
    s_waitcnt vmcnt(0)
    v_lshlrev_b32 v16, 16, v36
    v_and_b32 v17, 0xffff0000, v36
    v_lshlrev_b32 v18, 16, v37
    v_and_b32 v19, 0xffff0000, v37
    v_lshlrev_b32 v20, 16, v38
    v_and_b32 v21, 0xffff0000, v38
    v_lshlrev_b32 v22, 16, v39
    v_and_b32 v23, 0xffff0000, v39
    v_lshlrev_b32 v24, 16, v40
    v_and_b32 v25, 0xffff0000, v40
    v_lshlrev_b32 v26, 16, v41
    v_and_b32 v27, 0xffff0000, v41
    v_lshlrev_b32 v28, 16, v42
    v_and_b32 v29, 0xffff0000, v42
    v_lshlrev_b32 v30, 16, v43
    v_and_b32 v31, 0xffff0000, v43
    v_lshlrev_b32 v32, 16, v44
    v_and_b32 v33, 0xffff0000, v44
    v_lshlrev_b32 v34, 16, v45
    v_and_b32 v35, 0xffff0000, v45
    s_waitcnt lgkmcnt(2)
    s_barrier
    ds_read_b128 v[52:55], v2 offset:0
    ds_read_b128 v[56:59], v2 offset:4096
    ds_read_b128 v[60:63], v2 offset:8192
    ds_read_b128 v[64:67], v2 offset:12288
    ds_read_b128 v[228:231], v14 offset:40960
    ds_read_b128 v[232:235], v14 offset:41984
    ds_read_b128 v[236:239], v14 offset:43008
    ds_read_b128 v[240:243], v14 offset:44032
    ds_read_b128 v[244:247], v14 offset:45056
    ds_read_b128 v[248:251], v14 offset:46080
    s_waitcnt lgkmcnt(9)
    v_mfma_f32_16x16x32_bf16 v[16:19], v[132:135], v[52:55], v[16:19]
    ds_read_b128 v[132:135], v14 offset:24576
    ds_read_b128 v[252:255], v14 offset:47104
    s_waitcnt lgkmcnt(10)
    v_mfma_f32_16x16x32_bf16 v[16:19], v[136:139], v[56:59], v[16:19]
    ds_read_b128 v[136:139], v14 offset:26624
    s_waitcnt lgkmcnt(10)
    v_mfma_f32_16x16x32_bf16 v[16:19], v[140:143], v[60:63], v[16:19]
    ds_read_b128 v[140:143], v14 offset:28672
    s_waitcnt lgkmcnt(10)
    v_mfma_f32_16x16x32_bf16 v[16:19], v[144:147], v[64:67], v[16:19]
    ds_read_b128 v[144:147], v14 offset:30720
    v_mfma_f32_16x16x32_bf16 v[20:23], v[148:151], v[52:55], v[20:23]
    ds_read_b128 v[148:151], v14 offset:25600
    v_mfma_f32_16x16x32_bf16 v[20:23], v[152:155], v[56:59], v[20:23]
    ds_read_b128 v[152:155], v14 offset:27648
    v_mfma_f32_16x16x32_bf16 v[20:23], v[156:159], v[60:63], v[20:23]
    ds_read_b128 v[156:159], v14 offset:29696
    v_mfma_f32_16x16x32_bf16 v[20:23], v[160:163], v[64:67], v[20:23]
    ds_read_b128 v[160:163], v14 offset:31744
    s_waitcnt lgkmcnt(14)
    v_mfma_f32_16x16x32_bf16 v[24:27], v[228:231], v[52:55], v[24:27]
    ds_read_b128 v[228:231], v14 offset:48128
    s_waitcnt lgkmcnt(14)
    v_mfma_f32_16x16x32_bf16 v[28:31], v[232:235], v[52:55], v[28:31]
    ds_read_b128 v[232:235], v14 offset:49152
    s_barrier
    ds_read_b128 v[68:71], v2 offset:16384
    s_waitcnt lgkmcnt(0)
    v_mfma_f32_16x16x32_bf16 v[16:19], v[164:167], v[68:71], v[16:19]
    ds_read_b128 v[72:75], v2 offset:20480
    ds_read_b128 v[76:79], v2 offset:24576
    s_waitcnt lgkmcnt(1)
    v_mfma_f32_16x16x32_bf16 v[16:19], v[168:171], v[72:75], v[16:19]
    ds_read_b128 v[80:83], v2 offset:28672
    ds_read_b128 v[164:167], v14 offset:32768
    s_waitcnt lgkmcnt(2)
    v_mfma_f32_16x16x32_bf16 v[16:19], v[172:175], v[76:79], v[16:19]
    ds_read_b128 v[168:171], v14 offset:34816
    ds_read_b128 v[172:175], v14 offset:36864
    s_waitcnt lgkmcnt(3)
    v_mfma_f32_16x16x32_bf16 v[16:19], v[176:179], v[80:83], v[16:19]
    ds_read_b128 v[176:179], v14 offset:38912
    v_mfma_f32_16x16x32_bf16 v[20:23], v[180:183], v[68:71], v[20:23]
    ds_read_b128 v[180:183], v14 offset:33792
    v_mfma_f32_16x16x32_bf16 v[20:23], v[184:187], v[72:75], v[20:23]
    ds_read_b128 v[184:187], v14 offset:35840
    v_mfma_f32_16x16x32_bf16 v[20:23], v[188:191], v[76:79], v[20:23]
    ds_read_b128 v[188:191], v14 offset:37888
    v_mfma_f32_16x16x32_bf16 v[20:23], v[192:195], v[80:83], v[20:23]
    ds_read_b128 v[192:195], v14 offset:39936
    v_mfma_f32_16x16x32_bf16 v[32:35], v[236:239], v[52:55], v[32:35]
    ds_read_b128 v[236:239], v14 offset:50176
    v_mfma_f32_16x16x32_bf16 v[24:27], v[240:243], v[56:59], v[24:27]
    ds_read_b128 v[240:243], v14 offset:51200
    s_barrier
    ds_read_b128 v[84:87], v2 offset:32768
    s_waitcnt lgkmcnt(0)
    v_mfma_f32_16x16x32_bf16 v[16:19], v[196:199], v[84:87], v[16:19]
    ds_read_b128 v[88:91], v2 offset:36864
    ds_read_b128 v[92:95], v2 offset:40960
    s_waitcnt lgkmcnt(1)
    v_mfma_f32_16x16x32_bf16 v[16:19], v[200:203], v[88:91], v[16:19]
    ds_read_b128 v[96:99], v2 offset:45056
    ds_read_b128 v[196:199], v14 offset:52224
    s_waitcnt lgkmcnt(2)
    v_mfma_f32_16x16x32_bf16 v[16:19], v[204:207], v[92:95], v[16:19]
    ds_read_b128 v[200:203], v14 offset:53248
    ds_read_b128 v[204:207], v14 offset:54272
    s_waitcnt lgkmcnt(3)
    v_mfma_f32_16x16x32_bf16 v[16:19], v[208:211], v[96:99], v[16:19]
    ds_read_b128 v[208:211], v14 offset:55296
    v_mfma_f32_16x16x32_bf16 v[20:23], v[212:215], v[84:87], v[20:23]
    ds_read_b128 v[212:215], v14 offset:56320
    v_mfma_f32_16x16x32_bf16 v[20:23], v[216:219], v[88:91], v[20:23]
    ds_read_b128 v[216:219], v14 offset:57344
    v_mfma_f32_16x16x32_bf16 v[20:23], v[220:223], v[92:95], v[20:23]
    ds_read_b128 v[220:223], v14 offset:58368
    v_mfma_f32_16x16x32_bf16 v[20:23], v[224:227], v[96:99], v[20:23]
    ds_read_b128 v[224:227], v14 offset:59392
    v_mfma_f32_16x16x32_bf16 v[28:31], v[244:247], v[56:59], v[28:31]
    ds_read_b128 v[244:247], v14 offset:60416
    v_mfma_f32_16x16x32_bf16 v[32:35], v[248:251], v[56:59], v[32:35]
    ds_read_b128 v[248:251], v14 offset:61440
    s_barrier
    ds_read_b128 v[100:103], v2 offset:49152
    s_waitcnt lgkmcnt(0)
    v_mfma_f32_16x16x32_bf16 v[16:19], v[132:135], v[100:103], v[16:19]
    ds_read_b128 v[104:107], v2 offset:53248
    ds_read_b128 v[108:111], v2 offset:57344
    s_waitcnt lgkmcnt(1)
    v_mfma_f32_16x16x32_bf16 v[16:19], v[136:139], v[104:107], v[16:19]
    ds_read_b128 v[112:115], v2 offset:61440
    ds_read_b128 v[132:135], v14 offset:62464
    s_waitcnt lgkmcnt(2)
    v_mfma_f32_16x16x32_bf16 v[16:19], v[140:143], v[108:111], v[16:19]
    ds_read_b128 v[136:139], v14 offset:63488
    ds_read_b128 v[140:143], v14 offset:64512
    s_waitcnt lgkmcnt(3)
    v_mfma_f32_16x16x32_bf16 v[16:19], v[144:147], v[112:115], v[16:19]
    ds_read_b128 v[144:147], v15 offset:0
    v_mfma_f32_16x16x32_bf16 v[20:23], v[148:151], v[100:103], v[20:23]
    ds_read_b128 v[148:151], v15 offset:1024
    v_mfma_f32_16x16x32_bf16 v[20:23], v[152:155], v[104:107], v[20:23]
    ds_read_b128 v[152:155], v15 offset:2048
    v_mfma_f32_16x16x32_bf16 v[20:23], v[156:159], v[108:111], v[20:23]
    ds_read_b128 v[156:159], v15 offset:3072
    v_mfma_f32_16x16x32_bf16 v[20:23], v[160:163], v[112:115], v[20:23]
    ds_read_b128 v[160:163], v15 offset:4096
    v_mfma_f32_16x16x32_bf16 v[24:27], v[252:255], v[60:63], v[24:27]
    ds_read_b128 v[252:255], v15 offset:5120
    v_mfma_f32_16x16x32_bf16 v[28:31], v[228:231], v[60:63], v[28:31]
    ds_read_b128 v[228:231], v15 offset:6144
    s_barrier
    ds_read_b128 v[116:119], v2 offset:0
    s_waitcnt lgkmcnt(0)
    v_mfma_f32_16x16x32_bf16 v[16:19], v[164:167], v[116:119], v[16:19]
    ds_read_b128 v[120:123], v2 offset:4096
    ds_read_b128 v[124:127], v2 offset:8192
    s_waitcnt lgkmcnt(1)
    v_mfma_f32_16x16x32_bf16 v[16:19], v[168:171], v[120:123], v[16:19]
    ds_read_b128 v[128:131], v2 offset:12288
    ds_read_b128 v[164:167], v15 offset:7168
    s_waitcnt lgkmcnt(2)
    v_mfma_f32_16x16x32_bf16 v[16:19], v[172:175], v[124:127], v[16:19]
    ds_read_b128 v[168:171], v15 offset:8192
    ds_read_b128 v[172:175], v15 offset:9216
    s_waitcnt lgkmcnt(3)
    v_mfma_f32_16x16x32_bf16 v[16:19], v[176:179], v[128:131], v[16:19]
    ds_read_b128 v[176:179], v15 offset:10240
    v_mfma_f32_16x16x32_bf16 v[20:23], v[180:183], v[116:119], v[20:23]
    ds_read_b128 v[180:183], v15 offset:11264
    v_mfma_f32_16x16x32_bf16 v[20:23], v[184:187], v[120:123], v[20:23]
    ds_read_b128 v[184:187], v15 offset:12288
    v_mfma_f32_16x16x32_bf16 v[20:23], v[188:191], v[124:127], v[20:23]
    ds_read_b128 v[188:191], v15 offset:13312
    v_mfma_f32_16x16x32_bf16 v[20:23], v[192:195], v[128:131], v[20:23]
    ds_read_b128 v[192:195], v15 offset:14336
    v_mfma_f32_16x16x32_bf16 v[32:35], v[232:235], v[60:63], v[32:35]
    ds_read_b128 v[232:235], v15 offset:15360
    v_mfma_f32_16x16x32_bf16 v[24:27], v[236:239], v[64:67], v[24:27]
    v_cvt_pk_bf16_f32 v36, v16, v17
    v_cvt_pk_bf16_f32 v37, v18, v19
    s_nop 1
    v_cvt_pk_bf16_f32 v38, v20, v21
    v_cvt_pk_bf16_f32 v39, v22, v23
    buffer_store_dwordx4 v[36:39], v10, s[8:11], s24 offen sc1
    v_mfma_f32_16x16x32_bf16 v[28:31], v[240:243], v[64:67], v[28:31]
    v_mfma_f32_16x16x32_bf16 v[32:35], v[196:199], v[64:67], v[32:35]
    v_mfma_f32_16x16x32_bf16 v[24:27], v[200:203], v[68:71], v[24:27]
    v_mfma_f32_16x16x32_bf16 v[28:31], v[204:207], v[68:71], v[28:31]
    v_mfma_f32_16x16x32_bf16 v[32:35], v[208:211], v[68:71], v[32:35]
    v_mfma_f32_16x16x32_bf16 v[24:27], v[212:215], v[72:75], v[24:27]
    v_mfma_f32_16x16x32_bf16 v[28:31], v[216:219], v[72:75], v[28:31]
    v_mfma_f32_16x16x32_bf16 v[32:35], v[220:223], v[72:75], v[32:35]
    v_mfma_f32_16x16x32_bf16 v[24:27], v[224:227], v[76:79], v[24:27]
    v_mfma_f32_16x16x32_bf16 v[28:31], v[244:247], v[76:79], v[28:31]
    v_mfma_f32_16x16x32_bf16 v[32:35], v[248:251], v[76:79], v[32:35]
    v_mfma_f32_16x16x32_bf16 v[24:27], v[132:135], v[80:83], v[24:27]
    v_mfma_f32_16x16x32_bf16 v[28:31], v[136:139], v[80:83], v[28:31]
    v_mfma_f32_16x16x32_bf16 v[32:35], v[140:143], v[80:83], v[32:35]
    v_mfma_f32_16x16x32_bf16 v[24:27], v[144:147], v[84:87], v[24:27]
    v_mfma_f32_16x16x32_bf16 v[28:31], v[148:151], v[84:87], v[28:31]
    v_mfma_f32_16x16x32_bf16 v[32:35], v[152:155], v[84:87], v[32:35]
    v_mfma_f32_16x16x32_bf16 v[24:27], v[156:159], v[88:91], v[24:27]
    v_mfma_f32_16x16x32_bf16 v[28:31], v[160:163], v[88:91], v[28:31]
    v_mfma_f32_16x16x32_bf16 v[32:35], v[252:255], v[88:91], v[32:35]
    v_mfma_f32_16x16x32_bf16 v[24:27], v[228:231], v[92:95], v[24:27]
    s_waitcnt lgkmcnt(8)
    v_mfma_f32_16x16x32_bf16 v[28:31], v[164:167], v[92:95], v[28:31]
    s_waitcnt lgkmcnt(7)
    v_mfma_f32_16x16x32_bf16 v[32:35], v[168:171], v[92:95], v[32:35]
    s_waitcnt lgkmcnt(6)
    v_mfma_f32_16x16x32_bf16 v[24:27], v[172:175], v[96:99], v[24:27]
    s_waitcnt lgkmcnt(5)
    v_mfma_f32_16x16x32_bf16 v[28:31], v[176:179], v[96:99], v[28:31]
    s_waitcnt lgkmcnt(4)
    v_mfma_f32_16x16x32_bf16 v[32:35], v[180:183], v[96:99], v[32:35]
    s_waitcnt lgkmcnt(3)
    v_mfma_f32_16x16x32_bf16 v[24:27], v[184:187], v[100:103], v[24:27]
    s_waitcnt lgkmcnt(2)
    v_mfma_f32_16x16x32_bf16 v[28:31], v[188:191], v[100:103], v[28:31]
    s_waitcnt lgkmcnt(1)
    v_mfma_f32_16x16x32_bf16 v[32:35], v[192:195], v[100:103], v[32:35]
    s_waitcnt lgkmcnt(0)
    v_mfma_f32_16x16x32_bf16 v[24:27], v[232:235], v[104:107], v[24:27]
    s_waitcnt vmcnt(0)
    s_barrier
    ds_read_b128 v[236:239], v14 offset:0
    s_waitcnt lgkmcnt(0)
    v_mfma_f32_16x16x32_bf16 v[28:31], v[236:239], v[104:107], v[28:31]
    ds_read_b128 v[240:243], v14 offset:1024
    ds_read_b128 v[196:199], v14 offset:2048
    s_waitcnt lgkmcnt(1)
    v_mfma_f32_16x16x32_bf16 v[32:35], v[240:243], v[104:107], v[32:35]
    ds_read_b128 v[200:203], v14 offset:3072
    ds_read_b128 v[204:207], v14 offset:4096
    s_waitcnt lgkmcnt(2)
    v_mfma_f32_16x16x32_bf16 v[24:27], v[196:199], v[108:111], v[24:27]
    ds_read_b128 v[208:211], v14 offset:5120
    ds_read_b128 v[212:215], v14 offset:6144
    s_waitcnt lgkmcnt(3)
    v_mfma_f32_16x16x32_bf16 v[28:31], v[200:203], v[108:111], v[28:31]
    ds_read_b128 v[216:219], v14 offset:7168
    ds_read_b128 v[220:223], v14 offset:8192
    s_waitcnt lgkmcnt(4)
    v_mfma_f32_16x16x32_bf16 v[32:35], v[204:207], v[108:111], v[32:35]
    ds_read_b128 v[224:227], v14 offset:9216
    ds_read_b128 v[244:247], v14 offset:10240
    s_waitcnt lgkmcnt(5)
    v_mfma_f32_16x16x32_bf16 v[24:27], v[208:211], v[112:115], v[24:27]
    ds_read_b128 v[248:251], v14 offset:11264
    ds_read_b128 v[132:135], v14 offset:12288
    s_waitcnt lgkmcnt(6)
    v_mfma_f32_16x16x32_bf16 v[28:31], v[212:215], v[112:115], v[28:31]
    ds_read_b128 v[136:139], v14 offset:13312
    ds_read_b128 v[140:143], v14 offset:14336
    s_waitcnt lgkmcnt(7)
    v_mfma_f32_16x16x32_bf16 v[32:35], v[216:219], v[112:115], v[32:35]
    ds_read_b128 v[144:147], v14 offset:15360
    ds_read_b128 v[148:151], v14 offset:16384
    s_waitcnt lgkmcnt(8)
    v_mfma_f32_16x16x32_bf16 v[24:27], v[220:223], v[116:119], v[24:27]
    ds_read_b128 v[152:155], v14 offset:17408
    ds_read_b128 v[156:159], v14 offset:18432
    s_waitcnt lgkmcnt(9)
    v_mfma_f32_16x16x32_bf16 v[28:31], v[224:227], v[116:119], v[28:31]
    ds_read_b128 v[160:163], v14 offset:19456
    s_waitcnt lgkmcnt(9)
    v_mfma_f32_16x16x32_bf16 v[32:35], v[244:247], v[116:119], v[32:35]
    s_waitcnt lgkmcnt(8)
    v_mfma_f32_16x16x32_bf16 v[24:27], v[248:251], v[120:123], v[24:27]
    s_waitcnt lgkmcnt(7)
    v_mfma_f32_16x16x32_bf16 v[28:31], v[132:135], v[120:123], v[28:31]
    s_waitcnt lgkmcnt(6)
    v_mfma_f32_16x16x32_bf16 v[32:35], v[136:139], v[120:123], v[32:35]
    s_waitcnt lgkmcnt(5)
    v_mfma_f32_16x16x32_bf16 v[24:27], v[140:143], v[124:127], v[24:27]
    s_waitcnt lgkmcnt(4)
    v_mfma_f32_16x16x32_bf16 v[28:31], v[144:147], v[124:127], v[28:31]
    s_waitcnt lgkmcnt(3)
    v_mfma_f32_16x16x32_bf16 v[32:35], v[148:151], v[124:127], v[32:35]
    s_waitcnt lgkmcnt(2)
    v_mfma_f32_16x16x32_bf16 v[24:27], v[152:155], v[128:131], v[24:27]
    s_waitcnt lgkmcnt(1)
    v_mfma_f32_16x16x32_bf16 v[28:31], v[156:159], v[128:131], v[28:31]
    s_waitcnt lgkmcnt(0)
    v_mfma_f32_16x16x32_bf16 v[32:35], v[160:163], v[128:131], v[32:35]
    s_nop 3
    v_cvt_pk_bf16_f32 v40, v24, v25
    v_cvt_pk_bf16_f32 v41, v26, v27
    v_cvt_pk_bf16_f32 v42, v28, v29
    v_cvt_pk_bf16_f32 v43, v30, v31
    buffer_store_dwordx4 v[40:43], v11, s[8:11], s24 offen sc1
    v_cvt_pk_bf16_f32 v44, v32, v33
    v_cvt_pk_bf16_f32 v45, v34, v35
    buffer_store_dwordx2 v[44:45], v12, s[8:11], s24 offen sc1
    v_pk_mul_f32 v[50:51], v[16:17], v[16:17]
    v_pk_fma_f32 v[50:51], v[18:19], v[18:19], v[50:51]
    v_pk_add_f32 v[16:17], v[16:17], v[18:19]
    v_pk_fma_f32 v[50:51], v[20:21], v[20:21], v[50:51]
    v_pk_add_f32 v[16:17], v[16:17], v[20:21]
    v_pk_fma_f32 v[50:51], v[22:23], v[22:23], v[50:51]
    v_pk_add_f32 v[16:17], v[16:17], v[22:23]
    v_pk_fma_f32 v[50:51], v[24:25], v[24:25], v[50:51]
    v_pk_add_f32 v[16:17], v[16:17], v[24:25]
    v_pk_fma_f32 v[50:51], v[26:27], v[26:27], v[50:51]
    v_pk_add_f32 v[16:17], v[16:17], v[26:27]
    v_pk_fma_f32 v[50:51], v[28:29], v[28:29], v[50:51]
    v_pk_add_f32 v[16:17], v[16:17], v[28:29]
    v_pk_fma_f32 v[50:51], v[30:31], v[30:31], v[50:51]
    v_pk_add_f32 v[16:17], v[16:17], v[30:31]
    v_pk_fma_f32 v[50:51], v[32:33], v[32:33], v[50:51]
    v_pk_add_f32 v[16:17], v[16:17], v[32:33]
    v_pk_fma_f32 v[50:51], v[34:35], v[34:35], v[50:51]
    v_pk_add_f32 v[16:17], v[16:17], v[34:35]
    v_add_f32 v48, v16, v17
    v_add_f32 v49, v50, v51
    s_nop 1
    v_permlane32_swap_b32 v48, v49
    v_add_f32 v48, v48, v49
    v_mov_b32 v49, v48
    s_nop 1
    v_permlane16_swap_b32 v49, v48
    v_add_f32 v48, v48, v49
    v_lshrrev_b32 v50, 1, v6
    v_lshl_add_u32 v13, v50, 2, v13
    s_mov_b32 exec_lo, 0xffff
    s_mov_b32 exec_hi, 0xffff
    buffer_store_dword v48, v13, s[8:11], s28 offen sc1
    s_mov_b64 exec, -1
    s_lshr_b32 s20, s16, 1
    s_and_b32 s21, s16, 1
    s_lshl_b32 s22, s20, 12
    v_add_u32 v2, s22, v1
    s_mul_i32 s22, s21, 6144
    s_add_u32 s22, s22, 65536
    v_add_u32 v3, s22, v1
    v_add_u32 v4, 0x10000, v3
    s_lshl_b32 s22, s20, 8
    s_add_u32 s22, s22, 155648
    v_lshl_add_u32 v7, v5, 2, s22
    s_mul_i32 s22, s21, 384
    s_add_u32 s22, s22, 157184
    v_lshl_add_u32 v8, v6, 4, s22
    s_lshl_b32 s22, s18, 13
    s_lshl_b32 s23, s21, 9
    s_add_u32 s22, s22, s23
    v_lshrrev_b32 v10, 1, v6
    v_lshl_add_u32 v10, v10, 8, s22
    v_lshl_add_u32 v10, v5, 4, v10
    v_and_b32 v11, 1, v6
    v_lshl_add_u32 v10, v11, 3, v10
    s_mul_i32 s24, s19, 6291456
    s_add_u32 s24, s24, 15859712
    s_mul_i32 s25, s17, 393216
    s_add_u32 s24, s24, s25
    s_lshl_b32 s25, s20, 12
    s_add_u32 s24, s24, s25
    s_add_u32 s25, s24, 131072
    s_add_u32 s26, s24, 262144
    s_barrier
    s_waitcnt vmcnt(0)
    s_barrier
    ds_read_b128 v[160:163], v2 offset:0
    ds_read_b128 v[112:115], v3 offset:24576
    ds_read_b128 v[164:167], v2 offset:8192
    ds_read_b128 v[116:119], v3 offset:36864
    ds_read_b128 v[168:171], v2 offset:1024
    ds_read_b128 v[172:175], v2 offset:9216
    ds_read_b128 v[176:179], v2 offset:2048
    ds_read_b128 v[180:183], v2 offset:10240
    ds_read_b128 v[184:187], v2 offset:3072
    ds_read_b128 v[188:191], v2 offset:11264
    s_waitcnt lgkmcnt(8)
    v_mfma_f32_16x16x32_bf16 v[16:19], v[112:115], v[160:163], 0
    ds_read_b128 v[120:123], v3 offset:25600
    s_waitcnt lgkmcnt(7)
    v_mfma_f32_16x16x32_bf16 v[16:19], v[116:119], v[164:167], v[16:19]
    ds_read_b128 v[124:127], v3 offset:37888
    s_waitcnt lgkmcnt(7)
    v_mfma_f32_16x16x32_bf16 v[40:43], v[112:115], v[168:171], 0
    ds_read_b128 v[128:131], v3 offset:26624
    s_waitcnt lgkmcnt(7)
    v_mfma_f32_16x16x32_bf16 v[40:43], v[116:119], v[172:175], v[40:43]
    ds_read_b128 v[132:135], v3 offset:38912
    s_waitcnt lgkmcnt(7)
    v_mfma_f32_16x16x32_bf16 v[64:67], v[112:115], v[176:179], 0
    ds_read_b128 v[136:139], v3 offset:27648
    s_waitcnt lgkmcnt(7)
    v_mfma_f32_16x16x32_bf16 v[64:67], v[116:119], v[180:183], v[64:67]
    ds_read_b128 v[140:143], v3 offset:39936
    s_waitcnt lgkmcnt(7)
    v_mfma_f32_16x16x32_bf16 v[88:91], v[112:115], v[184:187], 0
    ds_read_b128 v[144:147], v3 offset:28672
    s_waitcnt lgkmcnt(7)
    v_mfma_f32_16x16x32_bf16 v[88:91], v[116:119], v[188:191], v[88:91]
    ds_read_b128 v[148:151], v3 offset:40960
    s_waitcnt lgkmcnt(7)
    v_mfma_f32_16x16x32_bf16 v[20:23], v[120:123], v[160:163], 0
    ds_read_b128 v[152:155], v3 offset:29696
    s_waitcnt lgkmcnt(7)
    v_mfma_f32_16x16x32_bf16 v[20:23], v[124:127], v[164:167], v[20:23]
    ds_read_b128 v[156:159], v3 offset:41984
    v_mfma_f32_16x16x32_bf16 v[44:47], v[120:123], v[168:171], 0
    v_mfma_f32_16x16x32_bf16 v[44:47], v[124:127], v[172:175], v[44:47]
    v_mfma_f32_16x16x32_bf16 v[68:71], v[120:123], v[176:179], 0
    v_mfma_f32_16x16x32_bf16 v[68:71], v[124:127], v[180:183], v[68:71]
    v_mfma_f32_16x16x32_bf16 v[92:95], v[120:123], v[184:187], 0
    v_mfma_f32_16x16x32_bf16 v[92:95], v[124:127], v[188:191], v[92:95]
    s_waitcnt lgkmcnt(7)
    v_mfma_f32_16x16x32_bf16 v[24:27], v[128:131], v[160:163], 0
    s_waitcnt lgkmcnt(6)
    v_mfma_f32_16x16x32_bf16 v[24:27], v[132:135], v[164:167], v[24:27]
    v_mfma_f32_16x16x32_bf16 v[48:51], v[128:131], v[168:171], 0
    v_mfma_f32_16x16x32_bf16 v[48:51], v[132:135], v[172:175], v[48:51]
    v_mfma_f32_16x16x32_bf16 v[72:75], v[128:131], v[176:179], 0
    v_mfma_f32_16x16x32_bf16 v[72:75], v[132:135], v[180:183], v[72:75]
    v_mfma_f32_16x16x32_bf16 v[96:99], v[128:131], v[184:187], 0
    v_mfma_f32_16x16x32_bf16 v[96:99], v[132:135], v[188:191], v[96:99]
    s_waitcnt lgkmcnt(0)
    s_barrier
    v_mfma_f32_16x16x32_bf16 v[28:31], v[136:139], v[160:163], 0
    ds_read_b128 v[192:195], v2 offset:16384
    v_mfma_f32_16x16x32_bf16 v[28:31], v[140:143], v[164:167], v[28:31]
    ds_read_b128 v[112:115], v3 offset:49152
    v_mfma_f32_16x16x32_bf16 v[52:55], v[136:139], v[168:171], 0
    ds_read_b128 v[196:199], v2 offset:24576
    v_mfma_f32_16x16x32_bf16 v[52:55], v[140:143], v[172:175], v[52:55]
    ds_read_b128 v[116:119], v3 offset:61440
    v_mfma_f32_16x16x32_bf16 v[76:79], v[136:139], v[176:179], 0
    ds_read_b128 v[200:203], v2 offset:17408
    v_mfma_f32_16x16x32_bf16 v[76:79], v[140:143], v[180:183], v[76:79]
    ds_read_b128 v[204:207], v2 offset:25600
    v_mfma_f32_16x16x32_bf16 v[100:103], v[136:139], v[184:187], 0
    ds_read_b128 v[208:211], v2 offset:18432
    v_mfma_f32_16x16x32_bf16 v[100:103], v[140:143], v[188:191], v[100:103]
    ds_read_b128 v[212:215], v2 offset:26624
    v_mfma_f32_16x16x32_bf16 v[32:35], v[144:147], v[160:163], 0
    ds_read_b128 v[216:219], v2 offset:19456
    v_mfma_f32_16x16x32_bf16 v[32:35], v[148:151], v[164:167], v[32:35]
    ds_read_b128 v[220:223], v2 offset:27648
    v_mfma_f32_16x16x32_bf16 v[56:59], v[144:147], v[168:171], 0
    ds_read_b128 v[120:123], v3 offset:50176
    v_mfma_f32_16x16x32_bf16 v[56:59], v[148:151], v[172:175], v[56:59]
    ds_read_b128 v[124:127], v3 offset:62464
    v_mfma_f32_16x16x32_bf16 v[80:83], v[144:147], v[176:179], 0
    ds_read_b128 v[128:131], v3 offset:51200
    v_mfma_f32_16x16x32_bf16 v[80:83], v[148:151], v[180:183], v[80:83]
    ds_read_b128 v[132:135], v3 offset:63488
    v_mfma_f32_16x16x32_bf16 v[104:107], v[144:147], v[184:187], 0
    ds_read_b128 v[136:139], v3 offset:52224
    v_mfma_f32_16x16x32_bf16 v[104:107], v[148:151], v[188:191], v[104:107]
    ds_read_b128 v[140:143], v3 offset:64512
    v_mfma_f32_16x16x32_bf16 v[36:39], v[152:155], v[160:163], 0
    ds_read_b128 v[144:147], v3 offset:53248
    v_mfma_f32_16x16x32_bf16 v[36:39], v[156:159], v[164:167], v[36:39]
    ds_read_b128 v[148:151], v4 offset:0
    v_mfma_f32_16x16x32_bf16 v[60:63], v[152:155], v[168:171], 0
    v_mfma_f32_16x16x32_bf16 v[60:63], v[156:159], v[172:175], v[60:63]
    v_mfma_f32_16x16x32_bf16 v[84:87], v[152:155], v[176:179], 0
    v_mfma_f32_16x16x32_bf16 v[84:87], v[156:159], v[180:183], v[84:87]
    v_mfma_f32_16x16x32_bf16 v[108:111], v[152:155], v[184:187], 0
    ds_read_b128 v[152:155], v3 offset:54272
    v_mfma_f32_16x16x32_bf16 v[108:111], v[156:159], v[188:191], v[108:111]
    ds_read_b128 v[156:159], v4 offset:1024
    s_waitcnt lgkmcnt(15)
    v_mfma_f32_16x16x32_bf16 v[16:19], v[112:115], v[192:195], v[16:19]
    v_mfma_f32_16x16x32_bf16 v[16:19], v[116:119], v[196:199], v[16:19]
    v_mfma_f32_16x16x32_bf16 v[40:43], v[112:115], v[200:203], v[40:43]
    s_waitcnt lgkmcnt(14)
    v_mfma_f32_16x16x32_bf16 v[40:43], v[116:119], v[204:207], v[40:43]
    s_waitcnt lgkmcnt(13)
    v_mfma_f32_16x16x32_bf16 v[64:67], v[112:115], v[208:211], v[64:67]
    s_waitcnt lgkmcnt(12)
    v_mfma_f32_16x16x32_bf16 v[64:67], v[116:119], v[212:215], v[64:67]
    s_waitcnt lgkmcnt(11)
    v_mfma_f32_16x16x32_bf16 v[88:91], v[112:115], v[216:219], v[88:91]
    s_waitcnt lgkmcnt(10)
    v_mfma_f32_16x16x32_bf16 v[88:91], v[116:119], v[220:223], v[88:91]
    s_waitcnt lgkmcnt(9)
    v_mfma_f32_16x16x32_bf16 v[20:23], v[120:123], v[192:195], v[20:23]
    s_waitcnt lgkmcnt(8)
    v_mfma_f32_16x16x32_bf16 v[20:23], v[124:127], v[196:199], v[20:23]
    v_mfma_f32_16x16x32_bf16 v[44:47], v[120:123], v[200:203], v[44:47]
    v_mfma_f32_16x16x32_bf16 v[44:47], v[124:127], v[204:207], v[44:47]
    v_mfma_f32_16x16x32_bf16 v[68:71], v[120:123], v[208:211], v[68:71]
    v_mfma_f32_16x16x32_bf16 v[68:71], v[124:127], v[212:215], v[68:71]
    v_mfma_f32_16x16x32_bf16 v[92:95], v[120:123], v[216:219], v[92:95]
    v_mfma_f32_16x16x32_bf16 v[92:95], v[124:127], v[220:223], v[92:95]
    s_waitcnt lgkmcnt(7)
    v_mfma_f32_16x16x32_bf16 v[24:27], v[128:131], v[192:195], v[24:27]
    s_waitcnt lgkmcnt(6)
    v_mfma_f32_16x16x32_bf16 v[24:27], v[132:135], v[196:199], v[24:27]
    v_mfma_f32_16x16x32_bf16 v[48:51], v[128:131], v[200:203], v[48:51]
    s_waitcnt lgkmcnt(0)
    s_barrier
    v_mfma_f32_16x16x32_bf16 v[48:51], v[132:135], v[204:207], v[48:51]
    ds_read_b128 v[160:163], v2 offset:32768
    v_mfma_f32_16x16x32_bf16 v[72:75], v[128:131], v[208:211], v[72:75]
    ds_read_b128 v[112:115], v3 offset:0
    v_mfma_f32_16x16x32_bf16 v[72:75], v[132:135], v[212:215], v[72:75]
    ds_read_b128 v[164:167], v2 offset:40960
    v_mfma_f32_16x16x32_bf16 v[96:99], v[128:131], v[216:219], v[96:99]
    ds_read_b128 v[116:119], v3 offset:12288
    v_mfma_f32_16x16x32_bf16 v[96:99], v[132:135], v[220:223], v[96:99]
    ds_read_b128 v[168:171], v2 offset:33792
    v_mfma_f32_16x16x32_bf16 v[28:31], v[136:139], v[192:195], v[28:31]
    ds_read_b128 v[172:175], v2 offset:41984
    v_mfma_f32_16x16x32_bf16 v[28:31], v[140:143], v[196:199], v[28:31]
    ds_read_b128 v[176:179], v2 offset:34816
    v_mfma_f32_16x16x32_bf16 v[52:55], v[136:139], v[200:203], v[52:55]
    ds_read_b128 v[180:183], v2 offset:43008
    v_mfma_f32_16x16x32_bf16 v[52:55], v[140:143], v[204:207], v[52:55]
    ds_read_b128 v[184:187], v2 offset:35840
    v_mfma_f32_16x16x32_bf16 v[76:79], v[136:139], v[208:211], v[76:79]
    ds_read_b128 v[188:191], v2 offset:44032
    v_mfma_f32_16x16x32_bf16 v[76:79], v[140:143], v[212:215], v[76:79]
    ds_read_b128 v[120:123], v3 offset:1024
    v_mfma_f32_16x16x32_bf16 v[100:103], v[136:139], v[216:219], v[100:103]
    ds_read_b128 v[124:127], v3 offset:13312
    v_mfma_f32_16x16x32_bf16 v[100:103], v[140:143], v[220:223], v[100:103]
    ds_read_b128 v[128:131], v3 offset:2048
    v_mfma_f32_16x16x32_bf16 v[32:35], v[144:147], v[192:195], v[32:35]
    ds_read_b128 v[132:135], v3 offset:14336
    v_mfma_f32_16x16x32_bf16 v[32:35], v[148:151], v[196:199], v[32:35]
    ds_read_b128 v[136:139], v3 offset:3072
    v_mfma_f32_16x16x32_bf16 v[56:59], v[144:147], v[200:203], v[56:59]
    ds_read_b128 v[140:143], v3 offset:15360
    v_mfma_f32_16x16x32_bf16 v[56:59], v[148:151], v[204:207], v[56:59]
    v_mfma_f32_16x16x32_bf16 v[80:83], v[144:147], v[208:211], v[80:83]
    v_mfma_f32_16x16x32_bf16 v[80:83], v[148:151], v[212:215], v[80:83]
    v_mfma_f32_16x16x32_bf16 v[104:107], v[144:147], v[216:219], v[104:107]
    ds_read_b128 v[144:147], v3 offset:4096
    v_mfma_f32_16x16x32_bf16 v[104:107], v[148:151], v[220:223], v[104:107]
    ds_read_b128 v[148:151], v3 offset:16384
    v_mfma_f32_16x16x32_bf16 v[36:39], v[152:155], v[192:195], v[36:39]
    v_mfma_f32_16x16x32_bf16 v[36:39], v[156:159], v[196:199], v[36:39]
    v_mfma_f32_16x16x32_bf16 v[60:63], v[152:155], v[200:203], v[60:63]
    v_mfma_f32_16x16x32_bf16 v[60:63], v[156:159], v[204:207], v[60:63]
    v_mfma_f32_16x16x32_bf16 v[84:87], v[152:155], v[208:211], v[84:87]
    v_mfma_f32_16x16x32_bf16 v[84:87], v[156:159], v[212:215], v[84:87]
    v_mfma_f32_16x16x32_bf16 v[108:111], v[152:155], v[216:219], v[108:111]
    ds_read_b128 v[152:155], v3 offset:5120
    v_mfma_f32_16x16x32_bf16 v[108:111], v[156:159], v[220:223], v[108:111]
    ds_read_b128 v[156:159], v3 offset:17408
    s_waitcnt lgkmcnt(15)
    v_mfma_f32_16x16x32_bf16 v[16:19], v[112:115], v[160:163], v[16:19]
    v_mfma_f32_16x16x32_bf16 v[16:19], v[116:119], v[164:167], v[16:19]
    v_mfma_f32_16x16x32_bf16 v[40:43], v[112:115], v[168:171], v[40:43]
    s_waitcnt lgkmcnt(14)
    v_mfma_f32_16x16x32_bf16 v[40:43], v[116:119], v[172:175], v[40:43]
    s_waitcnt lgkmcnt(13)
    v_mfma_f32_16x16x32_bf16 v[64:67], v[112:115], v[176:179], v[64:67]
    s_waitcnt lgkmcnt(12)
    v_mfma_f32_16x16x32_bf16 v[64:67], v[116:119], v[180:183], v[64:67]
    s_waitcnt lgkmcnt(11)
    v_mfma_f32_16x16x32_bf16 v[88:91], v[112:115], v[184:187], v[88:91]
    s_waitcnt lgkmcnt(10)
    v_mfma_f32_16x16x32_bf16 v[88:91], v[116:119], v[188:191], v[88:91]
    s_waitcnt lgkmcnt(9)
    v_mfma_f32_16x16x32_bf16 v[20:23], v[120:123], v[160:163], v[20:23]
    s_waitcnt lgkmcnt(8)
    v_mfma_f32_16x16x32_bf16 v[20:23], v[124:127], v[164:167], v[20:23]
    v_mfma_f32_16x16x32_bf16 v[44:47], v[120:123], v[168:171], v[44:47]
    v_mfma_f32_16x16x32_bf16 v[44:47], v[124:127], v[172:175], v[44:47]
    v_mfma_f32_16x16x32_bf16 v[68:71], v[120:123], v[176:179], v[68:71]
    v_mfma_f32_16x16x32_bf16 v[68:71], v[124:127], v[180:183], v[68:71]
    v_mfma_f32_16x16x32_bf16 v[92:95], v[120:123], v[184:187], v[92:95]
    v_mfma_f32_16x16x32_bf16 v[92:95], v[124:127], v[188:191], v[92:95]
    s_waitcnt lgkmcnt(7)
    v_mfma_f32_16x16x32_bf16 v[24:27], v[128:131], v[160:163], v[24:27]
    s_waitcnt lgkmcnt(6)
    v_mfma_f32_16x16x32_bf16 v[24:27], v[132:135], v[164:167], v[24:27]
    v_mfma_f32_16x16x32_bf16 v[48:51], v[128:131], v[168:171], v[48:51]
    s_waitcnt lgkmcnt(0)
    s_barrier
    v_mfma_f32_16x16x32_bf16 v[48:51], v[132:135], v[172:175], v[48:51]
    ds_read_b128 v[192:195], v2 offset:49152
    v_mfma_f32_16x16x32_bf16 v[72:75], v[128:131], v[176:179], v[72:75]
    ds_read_b128 v[112:115], v3 offset:24576
    v_mfma_f32_16x16x32_bf16 v[72:75], v[132:135], v[180:183], v[72:75]
    ds_read_b128 v[196:199], v2 offset:57344
    v_mfma_f32_16x16x32_bf16 v[96:99], v[128:131], v[184:187], v[96:99]
    ds_read_b128 v[116:119], v3 offset:36864
    v_mfma_f32_16x16x32_bf16 v[96:99], v[132:135], v[188:191], v[96:99]
    ds_read_b128 v[200:203], v2 offset:50176
    v_mfma_f32_16x16x32_bf16 v[28:31], v[136:139], v[160:163], v[28:31]
    ds_read_b128 v[204:207], v2 offset:58368
    v_mfma_f32_16x16x32_bf16 v[28:31], v[140:143], v[164:167], v[28:31]
    ds_read_b128 v[208:211], v2 offset:51200
    v_mfma_f32_16x16x32_bf16 v[52:55], v[136:139], v[168:171], v[52:55]
    ds_read_b128 v[212:215], v2 offset:59392
    v_mfma_f32_16x16x32_bf16 v[52:55], v[140:143], v[172:175], v[52:55]
    ds_read_b128 v[216:219], v2 offset:52224
    v_mfma_f32_16x16x32_bf16 v[76:79], v[136:139], v[176:179], v[76:79]
    ds_read_b128 v[220:223], v2 offset:60416
    v_mfma_f32_16x16x32_bf16 v[76:79], v[140:143], v[180:183], v[76:79]
    ds_read_b128 v[120:123], v3 offset:25600
    v_mfma_f32_16x16x32_bf16 v[100:103], v[136:139], v[184:187], v[100:103]
    ds_read_b128 v[124:127], v3 offset:37888
    v_mfma_f32_16x16x32_bf16 v[100:103], v[140:143], v[188:191], v[100:103]
    ds_read_b128 v[128:131], v3 offset:26624
    v_mfma_f32_16x16x32_bf16 v[32:35], v[144:147], v[160:163], v[32:35]
    ds_read_b128 v[132:135], v3 offset:38912
    v_mfma_f32_16x16x32_bf16 v[32:35], v[148:151], v[164:167], v[32:35]
    ds_read_b128 v[136:139], v3 offset:27648
    v_mfma_f32_16x16x32_bf16 v[56:59], v[144:147], v[168:171], v[56:59]
    ds_read_b128 v[140:143], v3 offset:39936
    v_mfma_f32_16x16x32_bf16 v[56:59], v[148:151], v[172:175], v[56:59]
    v_mfma_f32_16x16x32_bf16 v[80:83], v[144:147], v[176:179], v[80:83]
    v_mfma_f32_16x16x32_bf16 v[80:83], v[148:151], v[180:183], v[80:83]
    v_mfma_f32_16x16x32_bf16 v[104:107], v[144:147], v[184:187], v[104:107]
    ds_read_b128 v[144:147], v3 offset:28672
    v_mfma_f32_16x16x32_bf16 v[104:107], v[148:151], v[188:191], v[104:107]
    ds_read_b128 v[148:151], v3 offset:40960
    v_mfma_f32_16x16x32_bf16 v[36:39], v[152:155], v[160:163], v[36:39]
    v_mfma_f32_16x16x32_bf16 v[36:39], v[156:159], v[164:167], v[36:39]
    v_mfma_f32_16x16x32_bf16 v[60:63], v[152:155], v[168:171], v[60:63]
    v_mfma_f32_16x16x32_bf16 v[60:63], v[156:159], v[172:175], v[60:63]
    v_mfma_f32_16x16x32_bf16 v[84:87], v[152:155], v[176:179], v[84:87]
    v_mfma_f32_16x16x32_bf16 v[84:87], v[156:159], v[180:183], v[84:87]
    v_mfma_f32_16x16x32_bf16 v[108:111], v[152:155], v[184:187], v[108:111]
    ds_read_b128 v[152:155], v3 offset:29696
    v_mfma_f32_16x16x32_bf16 v[108:111], v[156:159], v[188:191], v[108:111]
    ds_read_b128 v[156:159], v3 offset:41984
    s_waitcnt lgkmcnt(15)
    v_mfma_f32_16x16x32_bf16 v[16:19], v[112:115], v[192:195], v[16:19]
    v_mfma_f32_16x16x32_bf16 v[16:19], v[116:119], v[196:199], v[16:19]
    v_mfma_f32_16x16x32_bf16 v[40:43], v[112:115], v[200:203], v[40:43]
    s_waitcnt lgkmcnt(14)
    v_mfma_f32_16x16x32_bf16 v[40:43], v[116:119], v[204:207], v[40:43]
    s_waitcnt lgkmcnt(13)
    v_mfma_f32_16x16x32_bf16 v[64:67], v[112:115], v[208:211], v[64:67]
    s_waitcnt lgkmcnt(12)
    v_mfma_f32_16x16x32_bf16 v[64:67], v[116:119], v[212:215], v[64:67]
    s_waitcnt lgkmcnt(11)
    v_mfma_f32_16x16x32_bf16 v[88:91], v[112:115], v[216:219], v[88:91]
    s_waitcnt lgkmcnt(10)
    v_mfma_f32_16x16x32_bf16 v[88:91], v[116:119], v[220:223], v[88:91]
    s_waitcnt lgkmcnt(9)
    v_mfma_f32_16x16x32_bf16 v[20:23], v[120:123], v[192:195], v[20:23]
    s_waitcnt lgkmcnt(8)
    v_mfma_f32_16x16x32_bf16 v[20:23], v[124:127], v[196:199], v[20:23]
    v_mfma_f32_16x16x32_bf16 v[44:47], v[120:123], v[200:203], v[44:47]
    v_mfma_f32_16x16x32_bf16 v[44:47], v[124:127], v[204:207], v[44:47]
    v_mfma_f32_16x16x32_bf16 v[68:71], v[120:123], v[208:211], v[68:71]
    v_mfma_f32_16x16x32_bf16 v[68:71], v[124:127], v[212:215], v[68:71]
    v_mfma_f32_16x16x32_bf16 v[92:95], v[120:123], v[216:219], v[92:95]
    v_mfma_f32_16x16x32_bf16 v[92:95], v[124:127], v[220:223], v[92:95]
    s_waitcnt lgkmcnt(7)
    v_mfma_f32_16x16x32_bf16 v[24:27], v[128:131], v[192:195], v[24:27]
    s_waitcnt lgkmcnt(6)
    v_mfma_f32_16x16x32_bf16 v[24:27], v[132:135], v[196:199], v[24:27]
    v_mfma_f32_16x16x32_bf16 v[48:51], v[128:131], v[200:203], v[48:51]
    s_waitcnt lgkmcnt(0)
    s_barrier
    v_mfma_f32_16x16x32_bf16 v[48:51], v[132:135], v[204:207], v[48:51]
    ds_read_b128 v[160:163], v2 offset:0
    v_mfma_f32_16x16x32_bf16 v[72:75], v[128:131], v[208:211], v[72:75]
    ds_read_b128 v[112:115], v3 offset:49152
    v_mfma_f32_16x16x32_bf16 v[72:75], v[132:135], v[212:215], v[72:75]
    ds_read_b128 v[164:167], v2 offset:8192
    v_mfma_f32_16x16x32_bf16 v[96:99], v[128:131], v[216:219], v[96:99]
    ds_read_b128 v[116:119], v3 offset:61440
    v_mfma_f32_16x16x32_bf16 v[96:99], v[132:135], v[220:223], v[96:99]
    ds_read_b128 v[168:171], v2 offset:1024
    v_mfma_f32_16x16x32_bf16 v[28:31], v[136:139], v[192:195], v[28:31]
    ds_read_b128 v[172:175], v2 offset:9216
    v_mfma_f32_16x16x32_bf16 v[28:31], v[140:143], v[196:199], v[28:31]
    ds_read_b128 v[176:179], v2 offset:2048
    v_mfma_f32_16x16x32_bf16 v[52:55], v[136:139], v[200:203], v[52:55]
    ds_read_b128 v[180:183], v2 offset:10240
    v_mfma_f32_16x16x32_bf16 v[52:55], v[140:143], v[204:207], v[52:55]
    ds_read_b128 v[184:187], v2 offset:3072
    v_mfma_f32_16x16x32_bf16 v[76:79], v[136:139], v[208:211], v[76:79]
    ds_read_b128 v[188:191], v2 offset:11264
    v_mfma_f32_16x16x32_bf16 v[76:79], v[140:143], v[212:215], v[76:79]
    ds_read_b128 v[120:123], v3 offset:50176
    v_mfma_f32_16x16x32_bf16 v[100:103], v[136:139], v[216:219], v[100:103]
    ds_read_b128 v[124:127], v3 offset:62464
    v_mfma_f32_16x16x32_bf16 v[100:103], v[140:143], v[220:223], v[100:103]
    ds_read_b128 v[128:131], v3 offset:51200
    v_mfma_f32_16x16x32_bf16 v[32:35], v[144:147], v[192:195], v[32:35]
    ds_read_b128 v[132:135], v3 offset:63488
    v_mfma_f32_16x16x32_bf16 v[32:35], v[148:151], v[196:199], v[32:35]
    ds_read_b128 v[136:139], v3 offset:52224
    v_mfma_f32_16x16x32_bf16 v[56:59], v[144:147], v[200:203], v[56:59]
    ds_read_b128 v[140:143], v3 offset:64512
    v_mfma_f32_16x16x32_bf16 v[56:59], v[148:151], v[204:207], v[56:59]
    v_mfma_f32_16x16x32_bf16 v[80:83], v[144:147], v[208:211], v[80:83]
    v_mfma_f32_16x16x32_bf16 v[80:83], v[148:151], v[212:215], v[80:83]
    v_mfma_f32_16x16x32_bf16 v[104:107], v[144:147], v[216:219], v[104:107]
    ds_read_b128 v[144:147], v3 offset:53248
    v_mfma_f32_16x16x32_bf16 v[104:107], v[148:151], v[220:223], v[104:107]
    ds_read_b128 v[148:151], v4 offset:0
    v_mfma_f32_16x16x32_bf16 v[36:39], v[152:155], v[192:195], v[36:39]
    v_mfma_f32_16x16x32_bf16 v[36:39], v[156:159], v[196:199], v[36:39]
    v_mfma_f32_16x16x32_bf16 v[60:63], v[152:155], v[200:203], v[60:63]
    v_mfma_f32_16x16x32_bf16 v[60:63], v[156:159], v[204:207], v[60:63]
    v_mfma_f32_16x16x32_bf16 v[84:87], v[152:155], v[208:211], v[84:87]
    v_mfma_f32_16x16x32_bf16 v[84:87], v[156:159], v[212:215], v[84:87]
    v_mfma_f32_16x16x32_bf16 v[108:111], v[152:155], v[216:219], v[108:111]
    ds_read_b128 v[152:155], v3 offset:54272
    v_mfma_f32_16x16x32_bf16 v[108:111], v[156:159], v[220:223], v[108:111]
    ds_read_b128 v[156:159], v4 offset:1024
    s_waitcnt lgkmcnt(15)
    v_mfma_f32_16x16x32_bf16 v[16:19], v[112:115], v[160:163], v[16:19]
    v_mfma_f32_16x16x32_bf16 v[16:19], v[116:119], v[164:167], v[16:19]
    v_mfma_f32_16x16x32_bf16 v[40:43], v[112:115], v[168:171], v[40:43]
    s_waitcnt lgkmcnt(14)
    v_mfma_f32_16x16x32_bf16 v[40:43], v[116:119], v[172:175], v[40:43]
    s_waitcnt lgkmcnt(13)
    v_mfma_f32_16x16x32_bf16 v[64:67], v[112:115], v[176:179], v[64:67]
    s_waitcnt lgkmcnt(12)
    v_mfma_f32_16x16x32_bf16 v[64:67], v[116:119], v[180:183], v[64:67]
    s_waitcnt lgkmcnt(11)
    v_mfma_f32_16x16x32_bf16 v[88:91], v[112:115], v[184:187], v[88:91]
    s_waitcnt lgkmcnt(10)
    v_mfma_f32_16x16x32_bf16 v[88:91], v[116:119], v[188:191], v[88:91]
    s_waitcnt lgkmcnt(9)
    v_mfma_f32_16x16x32_bf16 v[20:23], v[120:123], v[160:163], v[20:23]
    s_waitcnt lgkmcnt(8)
    v_mfma_f32_16x16x32_bf16 v[20:23], v[124:127], v[164:167], v[20:23]
    v_mfma_f32_16x16x32_bf16 v[44:47], v[120:123], v[168:171], v[44:47]
    v_mfma_f32_16x16x32_bf16 v[44:47], v[124:127], v[172:175], v[44:47]
    v_mfma_f32_16x16x32_bf16 v[68:71], v[120:123], v[176:179], v[68:71]
    v_mfma_f32_16x16x32_bf16 v[68:71], v[124:127], v[180:183], v[68:71]
    v_mfma_f32_16x16x32_bf16 v[92:95], v[120:123], v[184:187], v[92:95]
    v_mfma_f32_16x16x32_bf16 v[92:95], v[124:127], v[188:191], v[92:95]
    s_waitcnt lgkmcnt(7)
    v_mfma_f32_16x16x32_bf16 v[24:27], v[128:131], v[160:163], v[24:27]
    s_waitcnt lgkmcnt(6)
    v_mfma_f32_16x16x32_bf16 v[24:27], v[132:135], v[164:167], v[24:27]
    v_mfma_f32_16x16x32_bf16 v[48:51], v[128:131], v[168:171], v[48:51]
    s_waitcnt lgkmcnt(0)
    s_barrier
    v_mfma_f32_16x16x32_bf16 v[48:51], v[132:135], v[172:175], v[48:51]
    ds_read_b128 v[192:195], v2 offset:16384
    v_mfma_f32_16x16x32_bf16 v[72:75], v[128:131], v[176:179], v[72:75]
    ds_read_b128 v[112:115], v3 offset:0
    v_mfma_f32_16x16x32_bf16 v[72:75], v[132:135], v[180:183], v[72:75]
    ds_read_b128 v[196:199], v2 offset:24576
    ds_read_b32 v224, v7 offset:0
    ds_read_b32 v225, v7 offset:64
    ds_read_b32 v226, v7 offset:128
    ds_read_b32 v227, v7 offset:192
    v_mfma_f32_16x16x32_bf16 v[96:99], v[128:131], v[184:187], v[96:99]
    ds_read_b128 v[116:119], v3 offset:12288
    v_mfma_f32_16x16x32_bf16 v[96:99], v[132:135], v[188:191], v[96:99]
    ds_read_b128 v[200:203], v2 offset:17408
    v_mfma_f32_16x16x32_bf16 v[28:31], v[136:139], v[160:163], v[28:31]
    ds_read_b128 v[204:207], v2 offset:25600
    ds_read_b128 v[240:243], v8 offset:128
    v_mfma_f32_16x16x32_bf16 v[28:31], v[140:143], v[164:167], v[28:31]
    ds_read_b128 v[208:211], v2 offset:18432
    v_mfma_f32_16x16x32_bf16 v[52:55], v[136:139], v[168:171], v[52:55]
    ds_read_b128 v[212:215], v2 offset:26624
    v_mfma_f32_16x16x32_bf16 v[52:55], v[140:143], v[172:175], v[52:55]
    ds_read_b128 v[216:219], v2 offset:19456
    v_mfma_f32_16x16x32_bf16 v[76:79], v[136:139], v[176:179], v[76:79]
    ds_read_b128 v[220:223], v2 offset:27648
    v_mfma_f32_16x16x32_bf16 v[76:79], v[140:143], v[180:183], v[76:79]
    ds_read_b128 v[120:123], v3 offset:1024
    v_mfma_f32_16x16x32_bf16 v[100:103], v[136:139], v[184:187], v[100:103]
    ds_read_b128 v[124:127], v3 offset:13312
    v_mfma_f32_16x16x32_bf16 v[100:103], v[140:143], v[188:191], v[100:103]
    ds_read_b128 v[128:131], v3 offset:2048
    v_mfma_f32_16x16x32_bf16 v[32:35], v[144:147], v[160:163], v[32:35]
    ds_read_b128 v[132:135], v3 offset:14336
    v_mfma_f32_16x16x32_bf16 v[32:35], v[148:151], v[164:167], v[32:35]
    ds_read_b128 v[136:139], v3 offset:3072
    v_mfma_f32_16x16x32_bf16 v[56:59], v[144:147], v[168:171], v[56:59]
    ds_read_b128 v[140:143], v3 offset:15360
    s_waitcnt lgkmcnt(10)
    v_fmac_f32 v24, v240, v224
    v_mfma_f32_16x16x32_bf16 v[56:59], v[148:151], v[172:175], v[56:59]
    v_fmac_f32 v25, v241, v224
    v_mfma_f32_16x16x32_bf16 v[80:83], v[144:147], v[176:179], v[80:83]
    ds_read_b128 v[248:251], v8 offset:256
    v_fmac_f32 v26, v242, v224
    v_mfma_f32_16x16x32_bf16 v[80:83], v[148:151], v[180:183], v[80:83]
    v_fmac_f32 v27, v243, v224
    v_mfma_f32_16x16x32_bf16 v[104:107], v[144:147], v[184:187], v[104:107]
    ds_read_b128 v[144:147], v3 offset:4096
    v_fmac_f32 v48, v240, v225
    v_mfma_f32_16x16x32_bf16 v[104:107], v[148:151], v[188:191], v[104:107]
    ds_read_b128 v[148:151], v3 offset:16384
    v_fmac_f32 v49, v241, v225
    v_mfma_f32_16x16x32_bf16 v[36:39], v[152:155], v[160:163], v[36:39]
    v_fmac_f32 v50, v242, v225
    v_mfma_f32_16x16x32_bf16 v[36:39], v[156:159], v[164:167], v[36:39]
    v_fmac_f32 v51, v243, v225
    v_mfma_f32_16x16x32_bf16 v[60:63], v[152:155], v[168:171], v[60:63]
    ds_read_b128 v[252:255], v8 offset:320
    v_fmac_f32 v72, v240, v226
    v_mfma_f32_16x16x32_bf16 v[60:63], v[156:159], v[172:175], v[60:63]
    v_fmac_f32 v73, v241, v226
    v_mfma_f32_16x16x32_bf16 v[84:87], v[152:155], v[176:179], v[84:87]
    v_fmac_f32 v74, v242, v226
    v_mfma_f32_16x16x32_bf16 v[84:87], v[156:159], v[180:183], v[84:87]
    v_fmac_f32 v75, v243, v226
    v_mfma_f32_16x16x32_bf16 v[108:111], v[152:155], v[184:187], v[108:111]
    ds_read_b128 v[152:155], v3 offset:5120
    v_fmac_f32 v96, v240, v227
    v_mfma_f32_16x16x32_bf16 v[108:111], v[156:159], v[188:191], v[108:111]
    ds_read_b128 v[156:159], v3 offset:17408
    v_fmac_f32 v97, v241, v227
    v_mfma_f32_16x16x32_bf16 v[16:19], v[112:115], v[192:195], v[16:19]
    ds_read_b128 v[244:247], v8 offset:192
    v_fmac_f32 v98, v242, v227
    v_mfma_f32_16x16x32_bf16 v[16:19], v[116:119], v[196:199], v[16:19]
    v_fmac_f32 v99, v243, v227
    v_mfma_f32_16x16x32_bf16 v[40:43], v[112:115], v[200:203], v[40:43]
    s_waitcnt lgkmcnt(6)
    v_fmac_f32 v32, v248, v224
    v_fmac_f32 v33, v249, v224
    v_mfma_f32_16x16x32_bf16 v[40:43], v[116:119], v[204:207], v[40:43]
    v_fmac_f32 v34, v250, v224
    v_mfma_f32_16x16x32_bf16 v[64:67], v[112:115], v[208:211], v[64:67]
    v_fmac_f32 v35, v251, v224
    v_mfma_f32_16x16x32_bf16 v[64:67], v[116:119], v[212:215], v[64:67]
    v_fmac_f32 v56, v248, v225
    v_mfma_f32_16x16x32_bf16 v[88:91], v[112:115], v[216:219], v[88:91]
    ds_read_b128 v[232:235], v8 offset:0
    v_fmac_f32 v57, v249, v225
    v_mfma_f32_16x16x32_bf16 v[88:91], v[116:119], v[220:223], v[88:91]
    v_fmac_f32 v58, v250, v225
    v_mfma_f32_16x16x32_bf16 v[20:23], v[120:123], v[192:195], v[20:23]
    v_fmac_f32 v59, v251, v225
    v_mfma_f32_16x16x32_bf16 v[20:23], v[124:127], v[196:199], v[20:23]
    v_fmac_f32 v80, v248, v226
    v_mfma_f32_16x16x32_bf16 v[44:47], v[120:123], v[200:203], v[44:47]
    v_fmac_f32 v81, v249, v226
    v_mfma_f32_16x16x32_bf16 v[44:47], v[124:127], v[204:207], v[44:47]
    v_fmac_f32 v82, v250, v226
    v_mfma_f32_16x16x32_bf16 v[68:71], v[120:123], v[208:211], v[68:71]
    ds_read_b128 v[236:239], v8 offset:64
    v_fmac_f32 v83, v251, v226
    v_mfma_f32_16x16x32_bf16 v[68:71], v[124:127], v[212:215], v[68:71]
    v_fmac_f32 v104, v248, v227
    v_mfma_f32_16x16x32_bf16 v[92:95], v[120:123], v[216:219], v[92:95]
    v_fmac_f32 v105, v249, v227
    v_mfma_f32_16x16x32_bf16 v[92:95], v[124:127], v[220:223], v[92:95]
    v_fmac_f32 v106, v250, v227
    v_mfma_f32_16x16x32_bf16 v[24:27], v[128:131], v[192:195], v[24:27]
    v_fmac_f32 v107, v251, v227
    v_mfma_f32_16x16x32_bf16 v[24:27], v[132:135], v[196:199], v[24:27]
    s_waitcnt lgkmcnt(5)
    v_fmac_f32 v36, v252, v224
    v_fmac_f32 v37, v253, v224
    v_mfma_f32_16x16x32_bf16 v[48:51], v[128:131], v[200:203], v[48:51]
    v_fmac_f32 v38, v254, v224
    s_waitcnt lgkmcnt(3)
    s_barrier
    v_mfma_f32_16x16x32_bf16 v[48:51], v[132:135], v[204:207], v[48:51]
    ds_read_b128 v[160:163], v2 offset:32768
    v_fmac_f32 v39, v255, v224
    v_mfma_f32_16x16x32_bf16 v[72:75], v[128:131], v[208:211], v[72:75]
    ds_read_b128 v[112:115], v3 offset:24576
    v_fmac_f32 v60, v252, v225
    v_mfma_f32_16x16x32_bf16 v[72:75], v[132:135], v[212:215], v[72:75]
    ds_read_b128 v[164:167], v2 offset:40960
    v_fmac_f32 v61, v253, v225
    v_mfma_f32_16x16x32_bf16 v[96:99], v[128:131], v[216:219], v[96:99]
    ds_read_b128 v[116:119], v3 offset:26624
    v_fmac_f32 v62, v254, v225
    v_mfma_f32_16x16x32_bf16 v[96:99], v[132:135], v[220:223], v[96:99]
    ds_read_b128 v[168:171], v2 offset:33792
    v_fmac_f32 v63, v255, v225
    v_mfma_f32_16x16x32_bf16 v[28:31], v[136:139], v[192:195], v[28:31]
    ds_read_b128 v[172:175], v2 offset:41984
    v_fmac_f32 v84, v252, v226
    v_mfma_f32_16x16x32_bf16 v[28:31], v[140:143], v[196:199], v[28:31]
    ds_read_b128 v[176:179], v2 offset:34816
    v_fmac_f32 v85, v253, v226
    v_mfma_f32_16x16x32_bf16 v[52:55], v[136:139], v[200:203], v[52:55]
    ds_read_b128 v[180:183], v2 offset:43008
    v_fmac_f32 v86, v254, v226
    v_mfma_f32_16x16x32_bf16 v[52:55], v[140:143], v[204:207], v[52:55]
    ds_read_b128 v[184:187], v2 offset:35840
    v_fmac_f32 v87, v255, v226
    v_mfma_f32_16x16x32_bf16 v[76:79], v[136:139], v[208:211], v[76:79]
    ds_read_b128 v[188:191], v2 offset:44032
    v_fmac_f32 v108, v252, v227
    v_mfma_f32_16x16x32_bf16 v[76:79], v[140:143], v[212:215], v[76:79]
    ds_read_b128 v[120:123], v3 offset:25600
    v_fmac_f32 v109, v253, v227
    v_mfma_f32_16x16x32_bf16 v[100:103], v[136:139], v[216:219], v[100:103]
    ds_read_b128 v[124:127], v3 offset:27648
    v_fmac_f32 v110, v254, v227
    v_mfma_f32_16x16x32_bf16 v[100:103], v[140:143], v[220:223], v[100:103]
    ds_read_b128 v[128:131], v3 offset:28672
    v_fmac_f32 v111, v255, v227
    v_mfma_f32_16x16x32_bf16 v[32:35], v[144:147], v[192:195], v[32:35]
    ds_read_b128 v[132:135], v3 offset:36864
    v_mfma_f32_16x16x32_bf16 v[32:35], v[148:151], v[196:199], v[32:35]
    ds_read_b128 v[136:139], v3 offset:29696
    s_waitcnt lgkmcnt(15)
    v_fmac_f32 v28, v244, v224
    v_mfma_f32_16x16x32_bf16 v[56:59], v[144:147], v[200:203], v[56:59]
    ds_read_b128 v[140:143], v3 offset:37888
    v_fmac_f32 v29, v245, v224
    v_mfma_f32_16x16x32_bf16 v[56:59], v[148:151], v[204:207], v[56:59]
    v_fmac_f32 v30, v246, v224
    v_mfma_f32_16x16x32_bf16 v[80:83], v[144:147], v[208:211], v[80:83]
    v_fmac_f32 v31, v247, v224
    v_mfma_f32_16x16x32_bf16 v[80:83], v[148:151], v[212:215], v[80:83]
    v_fmac_f32 v52, v244, v225
    v_mfma_f32_16x16x32_bf16 v[104:107], v[144:147], v[216:219], v[104:107]
    ds_read_b128 v[144:147], v3 offset:38912
    v_fmac_f32 v53, v245, v225
    v_mfma_f32_16x16x32_bf16 v[104:107], v[148:151], v[220:223], v[104:107]
    ds_read_b128 v[148:151], v3 offset:40960
    v_fmac_f32 v54, v246, v225
    v_mfma_f32_16x16x32_bf16 v[36:39], v[152:155], v[192:195], v[36:39]
    v_fmac_f32 v55, v247, v225
    v_mfma_f32_16x16x32_bf16 v[36:39], v[156:159], v[196:199], v[36:39]
    v_fmac_f32 v76, v244, v226
    v_mfma_f32_16x16x32_bf16 v[60:63], v[152:155], v[200:203], v[60:63]
    v_fmac_f32 v77, v245, v226
    v_mfma_f32_16x16x32_bf16 v[60:63], v[156:159], v[204:207], v[60:63]
    v_fmac_f32 v78, v246, v226
    v_mfma_f32_16x16x32_bf16 v[84:87], v[152:155], v[208:211], v[84:87]
    v_fmac_f32 v79, v247, v226
    v_mfma_f32_16x16x32_bf16 v[84:87], v[156:159], v[212:215], v[84:87]
    v_fmac_f32 v100, v244, v227
    v_mfma_f32_16x16x32_bf16 v[108:111], v[152:155], v[216:219], v[108:111]
    ds_read_b128 v[152:155], v3 offset:39936
    v_fmac_f32 v101, v245, v227
    v_mfma_f32_16x16x32_bf16 v[108:111], v[156:159], v[220:223], v[108:111]
    ds_read_b128 v[156:159], v3 offset:41984
    v_fmac_f32 v102, v246, v227
    s_waitcnt lgkmcnt(15)
    v_mfma_f32_16x16x32_bf16 v[32:35], v[112:115], v[160:163], v[32:35]
    v_fmac_f32 v103, v247, v227
    v_mfma_f32_16x16x32_bf16 v[32:35], v[116:119], v[164:167], v[32:35]
    s_barrier
    v_mfma_f32_16x16x32_bf16 v[56:59], v[112:115], v[168:171], v[56:59]
    ds_read_b128 v[192:195], v2 offset:49152
    s_waitcnt lgkmcnt(15)
    v_mfma_f32_16x16x32_bf16 v[56:59], v[116:119], v[172:175], v[56:59]
    ds_read_b128 v[196:199], v2 offset:57344
    s_waitcnt lgkmcnt(15)
    v_mfma_f32_16x16x32_bf16 v[80:83], v[112:115], v[176:179], v[80:83]
    ds_read_b128 v[200:203], v2 offset:50176
    s_waitcnt lgkmcnt(15)
    v_mfma_f32_16x16x32_bf16 v[80:83], v[116:119], v[180:183], v[80:83]
    ds_read_b128 v[204:207], v2 offset:58368
    s_waitcnt lgkmcnt(15)
    v_mfma_f32_16x16x32_bf16 v[104:107], v[112:115], v[184:187], v[104:107]
    ds_read_b128 v[208:211], v2 offset:51200
    s_waitcnt lgkmcnt(15)
    v_mfma_f32_16x16x32_bf16 v[104:107], v[116:119], v[188:191], v[104:107]
    ds_read_b128 v[212:215], v2 offset:59392
    s_waitcnt lgkmcnt(15)
    v_mfma_f32_16x16x32_bf16 v[36:39], v[120:123], v[160:163], v[36:39]
    ds_read_b128 v[216:219], v2 offset:52224
    s_waitcnt lgkmcnt(15)
    v_mfma_f32_16x16x32_bf16 v[36:39], v[124:127], v[164:167], v[36:39]
    ds_read_b128 v[220:223], v2 offset:60416
    v_mfma_f32_16x16x32_bf16 v[60:63], v[120:123], v[168:171], v[60:63]
    v_mfma_f32_16x16x32_bf16 v[60:63], v[124:127], v[172:175], v[60:63]
    v_mfma_f32_16x16x32_bf16 v[84:87], v[120:123], v[176:179], v[84:87]
    v_mfma_f32_16x16x32_bf16 v[84:87], v[124:127], v[180:183], v[84:87]
    v_mfma_f32_16x16x32_bf16 v[108:111], v[120:123], v[184:187], v[108:111]
    v_mfma_f32_16x16x32_bf16 v[108:111], v[124:127], v[188:191], v[108:111]
    s_waitcnt lgkmcnt(7)
    v_mfma_f32_16x16x32_bf16 v[32:35], v[128:131], v[192:195], v[32:35]
    s_waitcnt lgkmcnt(6)
    v_mfma_f32_16x16x32_bf16 v[32:35], v[132:135], v[196:199], v[32:35]
    s_barrier
    s_waitcnt lgkmcnt(5)
    v_mfma_f32_16x16x32_bf16 v[56:59], v[128:131], v[200:203], v[56:59]
    ds_read_b128 v[160:163], v2 offset:0
    s_waitcnt lgkmcnt(5)
    v_mfma_f32_16x16x32_bf16 v[56:59], v[132:135], v[204:207], v[56:59]
    ds_read_b128 v[164:167], v2 offset:8192
    s_waitcnt lgkmcnt(5)
    v_mfma_f32_16x16x32_bf16 v[80:83], v[128:131], v[208:211], v[80:83]
    ds_read_b128 v[168:171], v2 offset:1024
    s_waitcnt lgkmcnt(5)
    v_mfma_f32_16x16x32_bf16 v[80:83], v[132:135], v[212:215], v[80:83]
    ds_read_b128 v[172:175], v2 offset:9216
    s_waitcnt lgkmcnt(5)
    v_mfma_f32_16x16x32_bf16 v[104:107], v[128:131], v[216:219], v[104:107]
    ds_read_b128 v[176:179], v2 offset:2048
    s_waitcnt lgkmcnt(5)
    v_mfma_f32_16x16x32_bf16 v[104:107], v[132:135], v[220:223], v[104:107]
    ds_read_b128 v[180:183], v2 offset:10240
    v_mfma_f32_16x16x32_bf16 v[36:39], v[136:139], v[192:195], v[36:39]
    ds_read_b128 v[184:187], v2 offset:3072
    v_mfma_f32_16x16x32_bf16 v[36:39], v[140:143], v[196:199], v[36:39]
    ds_read_b128 v[188:191], v2 offset:11264
    v_mfma_f32_16x16x32_bf16 v[60:63], v[136:139], v[200:203], v[60:63]
    v_mfma_f32_16x16x32_bf16 v[60:63], v[140:143], v[204:207], v[60:63]
    v_mfma_f32_16x16x32_bf16 v[84:87], v[136:139], v[208:211], v[84:87]
    v_mfma_f32_16x16x32_bf16 v[84:87], v[140:143], v[212:215], v[84:87]
    v_mfma_f32_16x16x32_bf16 v[108:111], v[136:139], v[216:219], v[108:111]
    v_mfma_f32_16x16x32_bf16 v[108:111], v[140:143], v[220:223], v[108:111]
    s_waitcnt lgkmcnt(7)
    v_mfma_f32_16x16x32_bf16 v[32:35], v[144:147], v[160:163], v[32:35]
    s_waitcnt lgkmcnt(6)
    v_mfma_f32_16x16x32_bf16 v[32:35], v[148:151], v[164:167], v[32:35]
    s_barrier
    s_waitcnt lgkmcnt(5)
    v_mfma_f32_16x16x32_bf16 v[56:59], v[144:147], v[168:171], v[56:59]
    ds_read_b128 v[192:195], v2 offset:16384
    s_waitcnt lgkmcnt(5)
    v_mfma_f32_16x16x32_bf16 v[56:59], v[148:151], v[172:175], v[56:59]
    ds_read_b128 v[112:115], v3 offset:49152
    s_waitcnt lgkmcnt(5)
    v_mfma_f32_16x16x32_bf16 v[80:83], v[144:147], v[176:179], v[80:83]
    ds_read_b128 v[196:199], v2 offset:24576
    s_waitcnt lgkmcnt(5)
    v_mfma_f32_16x16x32_bf16 v[80:83], v[148:151], v[180:183], v[80:83]
    ds_read_b128 v[116:119], v3 offset:51200
    s_waitcnt lgkmcnt(5)
    v_mfma_f32_16x16x32_bf16 v[104:107], v[144:147], v[184:187], v[104:107]
    ds_read_b128 v[200:203], v2 offset:17408
    s_waitcnt lgkmcnt(5)
    v_mfma_f32_16x16x32_bf16 v[104:107], v[148:151], v[188:191], v[104:107]
    ds_read_b128 v[204:207], v2 offset:25600
    v_mfma_f32_16x16x32_bf16 v[36:39], v[152:155], v[160:163], v[36:39]
    ds_read_b128 v[208:211], v2 offset:18432
    v_mfma_f32_16x16x32_bf16 v[36:39], v[156:159], v[164:167], v[36:39]
    ds_read_b128 v[212:215], v2 offset:26624
    v_mfma_f32_16x16x32_bf16 v[60:63], v[152:155], v[168:171], v[60:63]
    ds_read_b128 v[216:219], v2 offset:19456
    v_mfma_f32_16x16x32_bf16 v[60:63], v[156:159], v[172:175], v[60:63]
    ds_read_b128 v[220:223], v2 offset:27648
    v_mfma_f32_16x16x32_bf16 v[84:87], v[152:155], v[176:179], v[84:87]
    ds_read_b128 v[120:123], v3 offset:50176
    v_mfma_f32_16x16x32_bf16 v[84:87], v[156:159], v[180:183], v[84:87]
    ds_read_b128 v[124:127], v3 offset:52224
    v_mfma_f32_16x16x32_bf16 v[108:111], v[152:155], v[184:187], v[108:111]
    ds_read_b128 v[128:131], v3 offset:53248
    v_mfma_f32_16x16x32_bf16 v[108:111], v[156:159], v[188:191], v[108:111]
    ds_read_b128 v[132:135], v3 offset:61440
    s_waitcnt lgkmcnt(12)
    v_mfma_f32_16x16x32_bf16 v[32:35], v[112:115], v[192:195], v[32:35]
    ds_read_b128 v[136:139], v3 offset:54272
    s_waitcnt lgkmcnt(11)
    v_mfma_f32_16x16x32_bf16 v[32:35], v[116:119], v[196:199], v[32:35]
    ds_read_b128 v[140:143], v3 offset:62464
    s_waitcnt lgkmcnt(11)
    v_mfma_f32_16x16x32_bf16 v[56:59], v[112:115], v[200:203], v[56:59]
    ds_read_b128 v[144:147], v3 offset:63488
    ds_read_b32 v248, v7 offset:5120
    ds_read_b32 v249, v7 offset:5632
    ds_read_b32 v250, v7 offset:5184
    ds_read_b32 v251, v7 offset:5696
    ds_read_b32 v252, v7 offset:5248
    ds_read_b32 v253, v7 offset:5760
    ds_read_b32 v254, v7 offset:5312
    ds_read_b32 v255, v7 offset:5824
    s_waitcnt lgkmcnt(15)
    v_mfma_f32_16x16x32_bf16 v[56:59], v[116:119], v[204:207], v[56:59]
    ds_read_b128 v[148:151], v4 offset:0
    v_mfma_f32_16x16x32_bf16 v[80:83], v[112:115], v[208:211], v[80:83]
    ds_read_b128 v[152:155], v3 offset:64512
    v_mfma_f32_16x16x32_bf16 v[80:83], v[116:119], v[212:215], v[80:83]
    ds_read_b128 v[156:159], v4 offset:1024
    v_mfma_f32_16x16x32_bf16 v[104:107], v[112:115], v[216:219], v[104:107]
    v_mfma_f32_16x16x32_bf16 v[104:107], v[116:119], v[220:223], v[104:107]
    s_waitcnt lgkmcnt(15)
    v_mfma_f32_16x16x32_bf16 v[36:39], v[120:123], v[192:195], v[36:39]
    v_mfma_f32_16x16x32_bf16 v[36:39], v[124:127], v[196:199], v[36:39]
    v_mfma_f32_16x16x32_bf16 v[60:63], v[120:123], v[200:203], v[60:63]
    v_mfma_f32_16x16x32_bf16 v[60:63], v[124:127], v[204:207], v[60:63]
    v_mfma_f32_16x16x32_bf16 v[84:87], v[120:123], v[208:211], v[84:87]
    v_mfma_f32_16x16x32_bf16 v[84:87], v[124:127], v[212:215], v[84:87]
    v_mfma_f32_16x16x32_bf16 v[108:111], v[120:123], v[216:219], v[108:111]
    v_mfma_f32_16x16x32_bf16 v[108:111], v[124:127], v[220:223], v[108:111]
    s_waitcnt lgkmcnt(3)
    s_nop 0
    v_pk_mul_f32 v[36:37], v[32:33], v[36:37]
    v_pk_mul_f32 v[38:39], v[34:35], v[38:39]
    v_pk_mul_f32 v[32:33], v[32:33], v[248:249] op_sel_hi:[1,0]
    v_pk_mul_f32 v[34:35], v[34:35], v[248:249] op_sel_hi:[1,0]
    v_pk_mul_f32 v[60:61], v[56:57], v[60:61]
    v_pk_mul_f32 v[62:63], v[58:59], v[62:63]
    v_pk_mul_f32 v[56:57], v[56:57], v[250:251] op_sel_hi:[1,0]
    v_pk_mul_f32 v[58:59], v[58:59], v[250:251] op_sel_hi:[1,0]
    v_exp_f32 v32, -v32
    v_exp_f32 v33, -v33
    v_exp_f32 v34, -v34
    v_exp_f32 v35, -v35
    v_exp_f32 v56, -v56
    v_exp_f32 v57, -v57
    v_exp_f32 v58, -v58
    v_exp_f32 v59, -v59
    v_pk_fma_f32 v[32:33], v[32:33], v[248:249], v[248:249] op_sel:[0,1,1] op_sel_hi:[1,1,1]
    v_pk_fma_f32 v[34:35], v[34:35], v[248:249], v[248:249] op_sel:[0,1,1] op_sel_hi:[1,1,1]
    v_pk_fma_f32 v[56:57], v[56:57], v[250:251], v[250:251] op_sel:[0,1,1] op_sel_hi:[1,1,1]
    v_pk_fma_f32 v[58:59], v[58:59], v[250:251], v[250:251] op_sel:[0,1,1] op_sel_hi:[1,1,1]
    v_rcp_f32 v32, v32
    v_rcp_f32 v33, v33
    v_rcp_f32 v34, v34
    v_rcp_f32 v35, v35
    v_rcp_f32 v56, v56
    v_rcp_f32 v57, v57
    v_rcp_f32 v58, v58
    v_rcp_f32 v59, v59
    v_pk_mul_f32 v[32:33], v[32:33], v[36:37]
    v_pk_mul_f32 v[34:35], v[34:35], v[38:39]
    v_pk_mul_f32 v[56:57], v[56:57], v[60:61]
    v_pk_mul_f32 v[58:59], v[58:59], v[62:63]
    v_cvt_pk_bf16_f32 v36, v32, v33
    v_cvt_pk_bf16_f32 v37, v34, v35
    v_cvt_pk_bf16_f32 v60, v56, v57
    v_cvt_pk_bf16_f32 v61, v58, v59
    buffer_store_dwordx2 v[36:37], v10, s[8:11], s24 offen offset:0 sc1
    buffer_store_dwordx2 v[60:61], v10, s[8:11], s24 offen offset:1024 sc1
    v_pk_mul_f32 v[84:85], v[80:81], v[84:85]
    v_pk_mul_f32 v[86:87], v[82:83], v[86:87]
    v_pk_mul_f32 v[80:81], v[80:81], v[252:253] op_sel_hi:[1,0]
    v_pk_mul_f32 v[82:83], v[82:83], v[252:253] op_sel_hi:[1,0]
    v_pk_mul_f32 v[108:109], v[104:105], v[108:109]
    v_pk_mul_f32 v[110:111], v[106:107], v[110:111]
    v_pk_mul_f32 v[104:105], v[104:105], v[254:255] op_sel_hi:[1,0]
    v_pk_mul_f32 v[106:107], v[106:107], v[254:255] op_sel_hi:[1,0]
    v_exp_f32 v80, -v80
    v_exp_f32 v81, -v81
    v_exp_f32 v82, -v82
    v_exp_f32 v83, -v83
    v_exp_f32 v104, -v104
    v_exp_f32 v105, -v105
    v_exp_f32 v106, -v106
    v_exp_f32 v107, -v107
    v_pk_fma_f32 v[80:81], v[80:81], v[252:253], v[252:253] op_sel:[0,1,1] op_sel_hi:[1,1,1]
    v_pk_fma_f32 v[82:83], v[82:83], v[252:253], v[252:253] op_sel:[0,1,1] op_sel_hi:[1,1,1]
    v_pk_fma_f32 v[104:105], v[104:105], v[254:255], v[254:255] op_sel:[0,1,1] op_sel_hi:[1,1,1]
    v_pk_fma_f32 v[106:107], v[106:107], v[254:255], v[254:255] op_sel:[0,1,1] op_sel_hi:[1,1,1]
    v_rcp_f32 v80, v80
    v_rcp_f32 v81, v81
    v_rcp_f32 v82, v82
    v_rcp_f32 v83, v83
    v_rcp_f32 v104, v104
    v_rcp_f32 v105, v105
    v_rcp_f32 v106, v106
    v_rcp_f32 v107, v107
    v_pk_mul_f32 v[80:81], v[80:81], v[84:85]
    v_pk_mul_f32 v[82:83], v[82:83], v[86:87]
    v_pk_mul_f32 v[104:105], v[104:105], v[108:109]
    v_pk_mul_f32 v[106:107], v[106:107], v[110:111]
    v_cvt_pk_bf16_f32 v84, v80, v81
    v_cvt_pk_bf16_f32 v85, v82, v83
    v_cvt_pk_bf16_f32 v108, v104, v105
    v_cvt_pk_bf16_f32 v109, v106, v107
    buffer_store_dwordx2 v[84:85], v10, s[8:11], s24 offen offset:2048 sc1
    buffer_store_dwordx2 v[108:109], v10, s[8:11], s24 offen offset:3072 sc1
    v_mfma_f32_16x16x32_bf16 v[24:27], v[128:131], v[192:195], v[24:27]
    v_mfma_f32_16x16x32_bf16 v[24:27], v[132:135], v[196:199], v[24:27]
    v_mfma_f32_16x16x32_bf16 v[48:51], v[128:131], v[200:203], v[48:51]
    s_waitcnt lgkmcnt(0)
    s_barrier
    v_mfma_f32_16x16x32_bf16 v[48:51], v[132:135], v[204:207], v[48:51]
    ds_read_b128 v[112:115], v3 offset:0
    v_mfma_f32_16x16x32_bf16 v[72:75], v[128:131], v[208:211], v[72:75]
    ds_read_b128 v[116:119], v3 offset:2048
    v_fmac_f32 v16, v232, v224
    v_mfma_f32_16x16x32_bf16 v[72:75], v[132:135], v[212:215], v[72:75]
    ds_read_b128 v[120:123], v3 offset:1024
    v_fmac_f32 v17, v233, v224
    v_mfma_f32_16x16x32_bf16 v[96:99], v[128:131], v[216:219], v[96:99]
    ds_read_b128 v[124:127], v3 offset:3072
    v_fmac_f32 v18, v234, v224
    v_mfma_f32_16x16x32_bf16 v[96:99], v[132:135], v[220:223], v[96:99]
    ds_read_b128 v[128:131], v3 offset:4096
    v_fmac_f32 v19, v235, v224
    v_mfma_f32_16x16x32_bf16 v[28:31], v[136:139], v[192:195], v[28:31]
    ds_read_b128 v[192:195], v2 offset:49152
    v_fmac_f32 v40, v232, v225
    v_mfma_f32_16x16x32_bf16 v[28:31], v[140:143], v[196:199], v[28:31]
    ds_read_b128 v[196:199], v2 offset:57344
    v_fmac_f32 v41, v233, v225
    v_mfma_f32_16x16x32_bf16 v[52:55], v[136:139], v[200:203], v[52:55]
    ds_read_b128 v[200:203], v2 offset:50176
    v_fmac_f32 v42, v234, v225
    v_mfma_f32_16x16x32_bf16 v[52:55], v[140:143], v[204:207], v[52:55]
    ds_read_b128 v[204:207], v2 offset:58368
    v_fmac_f32 v43, v235, v225
    v_mfma_f32_16x16x32_bf16 v[76:79], v[136:139], v[208:211], v[76:79]
    ds_read_b128 v[208:211], v2 offset:51200
    v_fmac_f32 v64, v232, v226
    v_mfma_f32_16x16x32_bf16 v[76:79], v[140:143], v[212:215], v[76:79]
    ds_read_b128 v[212:215], v2 offset:59392
    v_fmac_f32 v65, v233, v226
    v_mfma_f32_16x16x32_bf16 v[100:103], v[136:139], v[216:219], v[100:103]
    ds_read_b128 v[216:219], v2 offset:52224
    v_fmac_f32 v66, v234, v226
    v_mfma_f32_16x16x32_bf16 v[100:103], v[140:143], v[220:223], v[100:103]
    ds_read_b128 v[220:223], v2 offset:60416
    v_fmac_f32 v67, v235, v226
    v_mfma_f32_16x16x32_bf16 v[24:27], v[144:147], v[160:163], v[24:27]
    ds_read_b128 v[132:135], v3 offset:12288
    v_fmac_f32 v88, v232, v227
    v_mfma_f32_16x16x32_bf16 v[24:27], v[148:151], v[164:167], v[24:27]
    ds_read_b128 v[136:139], v3 offset:5120
    v_fmac_f32 v89, v233, v227
    v_mfma_f32_16x16x32_bf16 v[48:51], v[144:147], v[168:171], v[48:51]
    ds_read_b128 v[140:143], v3 offset:13312
    v_fmac_f32 v90, v234, v227
    v_mfma_f32_16x16x32_bf16 v[48:51], v[148:151], v[172:175], v[48:51]
    v_fmac_f32 v91, v235, v227
    v_mfma_f32_16x16x32_bf16 v[72:75], v[144:147], v[176:179], v[72:75]
    v_fmac_f32 v20, v236, v224
    v_mfma_f32_16x16x32_bf16 v[72:75], v[148:151], v[180:183], v[72:75]
    v_fmac_f32 v21, v237, v224
    v_mfma_f32_16x16x32_bf16 v[96:99], v[144:147], v[184:187], v[96:99]
    ds_read_b128 v[144:147], v3 offset:14336
    v_fmac_f32 v22, v238, v224
    v_mfma_f32_16x16x32_bf16 v[96:99], v[148:151], v[188:191], v[96:99]
    ds_read_b128 v[148:151], v3 offset:16384
    v_fmac_f32 v23, v239, v224
    v_mfma_f32_16x16x32_bf16 v[28:31], v[152:155], v[160:163], v[28:31]
    ds_read_b128 v[160:163], v2 offset:32768
    v_fmac_f32 v44, v236, v225
    v_mfma_f32_16x16x32_bf16 v[28:31], v[156:159], v[164:167], v[28:31]
    ds_read_b128 v[164:167], v2 offset:40960
    v_fmac_f32 v45, v237, v225
    v_mfma_f32_16x16x32_bf16 v[52:55], v[152:155], v[168:171], v[52:55]
    ds_read_b128 v[168:171], v2 offset:33792
    v_fmac_f32 v46, v238, v225
    v_mfma_f32_16x16x32_bf16 v[52:55], v[156:159], v[172:175], v[52:55]
    ds_read_b128 v[172:175], v2 offset:41984
    v_fmac_f32 v47, v239, v225
    v_mfma_f32_16x16x32_bf16 v[76:79], v[152:155], v[176:179], v[76:79]
    ds_read_b128 v[176:179], v2 offset:34816
    v_fmac_f32 v68, v236, v226
    v_mfma_f32_16x16x32_bf16 v[76:79], v[156:159], v[180:183], v[76:79]
    ds_read_b128 v[180:183], v2 offset:43008
    v_fmac_f32 v69, v237, v226
    v_mfma_f32_16x16x32_bf16 v[100:103], v[152:155], v[184:187], v[100:103]
    ds_read_b128 v[184:187], v2 offset:35840
    v_fmac_f32 v70, v238, v226
    v_mfma_f32_16x16x32_bf16 v[100:103], v[156:159], v[188:191], v[100:103]
    ds_read_b128 v[188:191], v2 offset:44032
    v_fmac_f32 v71, v239, v226
    s_waitcnt lgkmcnt(15)
    v_mfma_f32_16x16x32_bf16 v[24:27], v[112:115], v[192:195], v[24:27]
    ds_read_b128 v[152:155], v3 offset:15360
    v_fmac_f32 v92, v236, v227
    v_mfma_f32_16x16x32_bf16 v[24:27], v[116:119], v[196:199], v[24:27]
    ds_read_b128 v[156:159], v3 offset:17408
    v_fmac_f32 v93, v237, v227
    v_mfma_f32_16x16x32_bf16 v[48:51], v[112:115], v[200:203], v[48:51]
    v_fmac_f32 v94, v238, v227
    v_mfma_f32_16x16x32_bf16 v[48:51], v[116:119], v[204:207], v[48:51]
    v_fmac_f32 v95, v239, v227
    v_mfma_f32_16x16x32_bf16 v[72:75], v[112:115], v[208:211], v[72:75]
    v_mfma_f32_16x16x32_bf16 v[72:75], v[116:119], v[212:215], v[72:75]
    s_waitcnt lgkmcnt(15)
    v_mfma_f32_16x16x32_bf16 v[96:99], v[112:115], v[216:219], v[96:99]
    v_mfma_f32_16x16x32_bf16 v[96:99], v[116:119], v[220:223], v[96:99]
    s_waitcnt vmcnt(0)
    s_waitcnt lgkmcnt(0)
    s_barrier
    v_mfma_f32_16x16x32_bf16 v[28:31], v[120:123], v[192:195], v[28:31]
    ds_read_b128 v[112:115], v3 offset:24576
    v_mfma_f32_16x16x32_bf16 v[28:31], v[124:127], v[196:199], v[28:31]
    ds_read_b128 v[116:119], v3 offset:26624
    v_mfma_f32_16x16x32_bf16 v[52:55], v[120:123], v[200:203], v[52:55]
    v_mfma_f32_16x16x32_bf16 v[52:55], v[124:127], v[204:207], v[52:55]
    v_mfma_f32_16x16x32_bf16 v[76:79], v[120:123], v[208:211], v[76:79]
    v_mfma_f32_16x16x32_bf16 v[76:79], v[124:127], v[212:215], v[76:79]
    v_mfma_f32_16x16x32_bf16 v[100:103], v[120:123], v[216:219], v[100:103]
    ds_read_b128 v[120:123], v3 offset:25600
    v_mfma_f32_16x16x32_bf16 v[100:103], v[124:127], v[220:223], v[100:103]
    ds_read_b128 v[124:127], v3 offset:27648
    v_mfma_f32_16x16x32_bf16 v[24:27], v[128:131], v[160:163], v[24:27]
    v_mfma_f32_16x16x32_bf16 v[24:27], v[132:135], v[164:167], v[24:27]
    v_mfma_f32_16x16x32_bf16 v[48:51], v[128:131], v[168:171], v[48:51]
    v_mfma_f32_16x16x32_bf16 v[48:51], v[132:135], v[172:175], v[48:51]
    v_mfma_f32_16x16x32_bf16 v[72:75], v[128:131], v[176:179], v[72:75]
    v_mfma_f32_16x16x32_bf16 v[72:75], v[132:135], v[180:183], v[72:75]
    v_mfma_f32_16x16x32_bf16 v[96:99], v[128:131], v[184:187], v[96:99]
    ds_read_b128 v[128:131], v3 offset:28672
    v_mfma_f32_16x16x32_bf16 v[96:99], v[132:135], v[188:191], v[96:99]
    ds_read_b128 v[132:135], v3 offset:36864
    v_mfma_f32_16x16x32_bf16 v[28:31], v[136:139], v[160:163], v[28:31]
    v_mfma_f32_16x16x32_bf16 v[28:31], v[140:143], v[164:167], v[28:31]
    v_mfma_f32_16x16x32_bf16 v[52:55], v[136:139], v[168:171], v[52:55]
    v_mfma_f32_16x16x32_bf16 v[52:55], v[140:143], v[172:175], v[52:55]
    v_mfma_f32_16x16x32_bf16 v[76:79], v[136:139], v[176:179], v[76:79]
    v_mfma_f32_16x16x32_bf16 v[76:79], v[140:143], v[180:183], v[76:79]
    v_mfma_f32_16x16x32_bf16 v[100:103], v[136:139], v[184:187], v[100:103]
    ds_read_b128 v[136:139], v3 offset:29696
    v_mfma_f32_16x16x32_bf16 v[100:103], v[140:143], v[188:191], v[100:103]
    ds_read_b128 v[140:143], v3 offset:37888
    v_pk_mul_f32 v[28:29], v[24:25], v[28:29]
    v_pk_mul_f32 v[30:31], v[26:27], v[30:31]
    v_pk_mul_f32 v[24:25], v[24:25], v[248:249] op_sel_hi:[1,0]
    v_pk_mul_f32 v[26:27], v[26:27], v[248:249] op_sel_hi:[1,0]
    v_pk_mul_f32 v[52:53], v[48:49], v[52:53]
    v_pk_mul_f32 v[54:55], v[50:51], v[54:55]
    v_pk_mul_f32 v[48:49], v[48:49], v[250:251] op_sel_hi:[1,0]
    v_pk_mul_f32 v[50:51], v[50:51], v[250:251] op_sel_hi:[1,0]
    v_exp_f32 v24, -v24
    v_exp_f32 v25, -v25
    v_exp_f32 v26, -v26
    v_exp_f32 v27, -v27
    v_exp_f32 v48, -v48
    v_exp_f32 v49, -v49
    v_exp_f32 v50, -v50
    v_exp_f32 v51, -v51
    v_pk_fma_f32 v[24:25], v[24:25], v[248:249], v[248:249] op_sel:[0,1,1] op_sel_hi:[1,1,1]
    v_pk_fma_f32 v[26:27], v[26:27], v[248:249], v[248:249] op_sel:[0,1,1] op_sel_hi:[1,1,1]
    v_pk_fma_f32 v[48:49], v[48:49], v[250:251], v[250:251] op_sel:[0,1,1] op_sel_hi:[1,1,1]
    v_pk_fma_f32 v[50:51], v[50:51], v[250:251], v[250:251] op_sel:[0,1,1] op_sel_hi:[1,1,1]
    v_rcp_f32 v24, v24
    v_rcp_f32 v25, v25
    v_rcp_f32 v26, v26
    v_rcp_f32 v27, v27
    v_rcp_f32 v48, v48
    v_rcp_f32 v49, v49
    v_rcp_f32 v50, v50
    v_rcp_f32 v51, v51
    v_pk_mul_f32 v[24:25], v[24:25], v[28:29]
    v_pk_mul_f32 v[26:27], v[26:27], v[30:31]
    v_pk_mul_f32 v[48:49], v[48:49], v[52:53]
    v_pk_mul_f32 v[50:51], v[50:51], v[54:55]
    v_cvt_pk_bf16_f32 v28, v24, v25
    v_cvt_pk_bf16_f32 v29, v26, v27
    v_cvt_pk_bf16_f32 v52, v48, v49
    v_cvt_pk_bf16_f32 v53, v50, v51
    buffer_store_dwordx2 v[28:29], v10, s[8:11], s25 offen offset:0 sc1
    buffer_store_dwordx2 v[52:53], v10, s[8:11], s25 offen offset:1024 sc1
    v_pk_mul_f32 v[76:77], v[72:73], v[76:77]
    v_pk_mul_f32 v[78:79], v[74:75], v[78:79]
    v_pk_mul_f32 v[72:73], v[72:73], v[252:253] op_sel_hi:[1,0]
    v_pk_mul_f32 v[74:75], v[74:75], v[252:253] op_sel_hi:[1,0]
    v_pk_mul_f32 v[100:101], v[96:97], v[100:101]
    v_pk_mul_f32 v[102:103], v[98:99], v[102:103]
    v_pk_mul_f32 v[96:97], v[96:97], v[254:255] op_sel_hi:[1,0]
    v_pk_mul_f32 v[98:99], v[98:99], v[254:255] op_sel_hi:[1,0]
    v_exp_f32 v72, -v72
    v_exp_f32 v73, -v73
    v_exp_f32 v74, -v74
    v_exp_f32 v75, -v75
    v_exp_f32 v96, -v96
    v_exp_f32 v97, -v97
    v_exp_f32 v98, -v98
    v_exp_f32 v99, -v99
    v_pk_fma_f32 v[72:73], v[72:73], v[252:253], v[252:253] op_sel:[0,1,1] op_sel_hi:[1,1,1]
    v_pk_fma_f32 v[74:75], v[74:75], v[252:253], v[252:253] op_sel:[0,1,1] op_sel_hi:[1,1,1]
    v_pk_fma_f32 v[96:97], v[96:97], v[254:255], v[254:255] op_sel:[0,1,1] op_sel_hi:[1,1,1]
    v_pk_fma_f32 v[98:99], v[98:99], v[254:255], v[254:255] op_sel:[0,1,1] op_sel_hi:[1,1,1]
    v_rcp_f32 v72, v72
    v_rcp_f32 v73, v73
    v_rcp_f32 v74, v74
    v_rcp_f32 v75, v75
    v_rcp_f32 v96, v96
    v_rcp_f32 v97, v97
    v_rcp_f32 v98, v98
    v_rcp_f32 v99, v99
    v_pk_mul_f32 v[72:73], v[72:73], v[76:77]
    v_pk_mul_f32 v[74:75], v[74:75], v[78:79]
    v_pk_mul_f32 v[96:97], v[96:97], v[100:101]
    v_pk_mul_f32 v[98:99], v[98:99], v[102:103]
    v_cvt_pk_bf16_f32 v76, v72, v73
    v_cvt_pk_bf16_f32 v77, v74, v75
    v_cvt_pk_bf16_f32 v100, v96, v97
    v_cvt_pk_bf16_f32 v101, v98, v99
    buffer_store_dwordx2 v[76:77], v10, s[8:11], s25 offen offset:2048 sc1
    buffer_store_dwordx2 v[100:101], v10, s[8:11], s25 offen offset:3072 sc1
    v_mfma_f32_16x16x32_bf16 v[16:19], v[144:147], v[160:163], v[16:19]
    v_mfma_f32_16x16x32_bf16 v[16:19], v[148:151], v[164:167], v[16:19]
    v_mfma_f32_16x16x32_bf16 v[40:43], v[144:147], v[168:171], v[40:43]
    v_mfma_f32_16x16x32_bf16 v[40:43], v[148:151], v[172:175], v[40:43]
    v_mfma_f32_16x16x32_bf16 v[64:67], v[144:147], v[176:179], v[64:67]
    v_mfma_f32_16x16x32_bf16 v[64:67], v[148:151], v[180:183], v[64:67]
    v_mfma_f32_16x16x32_bf16 v[88:91], v[144:147], v[184:187], v[88:91]
    ds_read_b128 v[144:147], v3 offset:38912
    v_mfma_f32_16x16x32_bf16 v[88:91], v[148:151], v[188:191], v[88:91]
    ds_read_b128 v[148:151], v3 offset:40960
    v_mfma_f32_16x16x32_bf16 v[20:23], v[152:155], v[160:163], v[20:23]
    ds_read_b128 v[160:163], v2 offset:0
    v_mfma_f32_16x16x32_bf16 v[20:23], v[156:159], v[164:167], v[20:23]
    ds_read_b128 v[164:167], v2 offset:8192
    v_mfma_f32_16x16x32_bf16 v[44:47], v[152:155], v[168:171], v[44:47]
    ds_read_b128 v[168:171], v2 offset:1024
    v_mfma_f32_16x16x32_bf16 v[44:47], v[156:159], v[172:175], v[44:47]
    ds_read_b128 v[172:175], v2 offset:9216
    v_mfma_f32_16x16x32_bf16 v[68:71], v[152:155], v[176:179], v[68:71]
    ds_read_b128 v[176:179], v2 offset:2048
    v_mfma_f32_16x16x32_bf16 v[68:71], v[156:159], v[180:183], v[68:71]
    ds_read_b128 v[180:183], v2 offset:10240
    v_mfma_f32_16x16x32_bf16 v[92:95], v[152:155], v[184:187], v[92:95]
    ds_read_b128 v[184:187], v2 offset:3072
    v_mfma_f32_16x16x32_bf16 v[92:95], v[156:159], v[188:191], v[92:95]
    ds_read_b128 v[188:191], v2 offset:11264
    s_waitcnt lgkmcnt(15)
    v_mfma_f32_16x16x32_bf16 v[16:19], v[112:115], v[192:195], v[16:19]
    ds_read_b128 v[152:155], v3 offset:39936
    v_mfma_f32_16x16x32_bf16 v[16:19], v[116:119], v[196:199], v[16:19]
    ds_read_b128 v[156:159], v3 offset:41984
    v_mfma_f32_16x16x32_bf16 v[40:43], v[112:115], v[200:203], v[40:43]
    v_mfma_f32_16x16x32_bf16 v[40:43], v[116:119], v[204:207], v[40:43]
    v_mfma_f32_16x16x32_bf16 v[64:67], v[112:115], v[208:211], v[64:67]
    v_mfma_f32_16x16x32_bf16 v[64:67], v[116:119], v[212:215], v[64:67]
    v_mfma_f32_16x16x32_bf16 v[88:91], v[112:115], v[216:219], v[88:91]
    v_mfma_f32_16x16x32_bf16 v[88:91], v[116:119], v[220:223], v[88:91]
    s_barrier
    v_mfma_f32_16x16x32_bf16 v[20:23], v[120:123], v[192:195], v[20:23]
    ds_read_b128 v[192:195], v2 offset:16384
    s_waitcnt lgkmcnt(15)
    v_mfma_f32_16x16x32_bf16 v[20:23], v[124:127], v[196:199], v[20:23]
    ds_read_b128 v[196:199], v2 offset:24576
    v_mfma_f32_16x16x32_bf16 v[44:47], v[120:123], v[200:203], v[44:47]
    ds_read_b128 v[200:203], v2 offset:17408
    v_mfma_f32_16x16x32_bf16 v[44:47], v[124:127], v[204:207], v[44:47]
    ds_read_b128 v[204:207], v2 offset:25600
    v_mfma_f32_16x16x32_bf16 v[68:71], v[120:123], v[208:211], v[68:71]
    ds_read_b128 v[208:211], v2 offset:18432
    v_mfma_f32_16x16x32_bf16 v[68:71], v[124:127], v[212:215], v[68:71]
    ds_read_b128 v[212:215], v2 offset:26624
    v_mfma_f32_16x16x32_bf16 v[92:95], v[120:123], v[216:219], v[92:95]
    ds_read_b128 v[216:219], v2 offset:19456
    v_mfma_f32_16x16x32_bf16 v[92:95], v[124:127], v[220:223], v[92:95]
    ds_read_b128 v[220:223], v2 offset:27648
    s_waitcnt lgkmcnt(8)
    s_barrier
    v_mfma_f32_16x16x32_bf16 v[16:19], v[128:131], v[160:163], v[16:19]
    v_mfma_f32_16x16x32_bf16 v[16:19], v[132:135], v[164:167], v[16:19]
    v_mfma_f32_16x16x32_bf16 v[40:43], v[128:131], v[168:171], v[40:43]
    v_mfma_f32_16x16x32_bf16 v[40:43], v[132:135], v[172:175], v[40:43]
    v_mfma_f32_16x16x32_bf16 v[64:67], v[128:131], v[176:179], v[64:67]
    v_mfma_f32_16x16x32_bf16 v[64:67], v[132:135], v[180:183], v[64:67]
    v_mfma_f32_16x16x32_bf16 v[88:91], v[128:131], v[184:187], v[88:91]
    v_mfma_f32_16x16x32_bf16 v[88:91], v[132:135], v[188:191], v[88:91]
    v_mfma_f32_16x16x32_bf16 v[20:23], v[136:139], v[160:163], v[20:23]
    v_mfma_f32_16x16x32_bf16 v[20:23], v[140:143], v[164:167], v[20:23]
    v_mfma_f32_16x16x32_bf16 v[44:47], v[136:139], v[168:171], v[44:47]
    v_mfma_f32_16x16x32_bf16 v[44:47], v[140:143], v[172:175], v[44:47]
    v_mfma_f32_16x16x32_bf16 v[68:71], v[136:139], v[176:179], v[68:71]
    v_mfma_f32_16x16x32_bf16 v[68:71], v[140:143], v[180:183], v[68:71]
    v_mfma_f32_16x16x32_bf16 v[92:95], v[136:139], v[184:187], v[92:95]
    v_mfma_f32_16x16x32_bf16 v[92:95], v[140:143], v[188:191], v[92:95]
    s_waitcnt lgkmcnt(7)
    v_mfma_f32_16x16x32_bf16 v[16:19], v[144:147], v[192:195], v[16:19]
    s_waitcnt lgkmcnt(6)
    v_mfma_f32_16x16x32_bf16 v[16:19], v[148:151], v[196:199], v[16:19]
    s_waitcnt vmcnt(0)
    s_waitcnt lgkmcnt(0)
    s_barrier
    v_mfma_f32_16x16x32_bf16 v[40:43], v[144:147], v[200:203], v[40:43]
    v_mfma_f32_16x16x32_bf16 v[40:43], v[148:151], v[204:207], v[40:43]
    v_mfma_f32_16x16x32_bf16 v[64:67], v[144:147], v[208:211], v[64:67]
    v_mfma_f32_16x16x32_bf16 v[64:67], v[148:151], v[212:215], v[64:67]
    v_mfma_f32_16x16x32_bf16 v[88:91], v[144:147], v[216:219], v[88:91]
    v_mfma_f32_16x16x32_bf16 v[88:91], v[148:151], v[220:223], v[88:91]
    v_mfma_f32_16x16x32_bf16 v[20:23], v[152:155], v[192:195], v[20:23]
    v_mfma_f32_16x16x32_bf16 v[20:23], v[156:159], v[196:199], v[20:23]
    v_mfma_f32_16x16x32_bf16 v[44:47], v[152:155], v[200:203], v[44:47]
    v_mfma_f32_16x16x32_bf16 v[44:47], v[156:159], v[204:207], v[44:47]
    v_mfma_f32_16x16x32_bf16 v[68:71], v[152:155], v[208:211], v[68:71]
    v_mfma_f32_16x16x32_bf16 v[68:71], v[156:159], v[212:215], v[68:71]
    v_mfma_f32_16x16x32_bf16 v[92:95], v[152:155], v[216:219], v[92:95]
    v_mfma_f32_16x16x32_bf16 v[92:95], v[156:159], v[220:223], v[92:95]
    s_nop 1
    v_pk_mul_f32 v[20:21], v[16:17], v[20:21]
    v_pk_mul_f32 v[22:23], v[18:19], v[22:23]
    v_pk_mul_f32 v[16:17], v[16:17], v[248:249] op_sel_hi:[1,0]
    v_pk_mul_f32 v[18:19], v[18:19], v[248:249] op_sel_hi:[1,0]
    v_pk_mul_f32 v[44:45], v[40:41], v[44:45]
    v_pk_mul_f32 v[46:47], v[42:43], v[46:47]
    v_pk_mul_f32 v[40:41], v[40:41], v[250:251] op_sel_hi:[1,0]
    v_pk_mul_f32 v[42:43], v[42:43], v[250:251] op_sel_hi:[1,0]
    v_exp_f32 v16, -v16
    v_exp_f32 v17, -v17
    v_exp_f32 v18, -v18
    v_exp_f32 v19, -v19
    v_exp_f32 v40, -v40
    v_exp_f32 v41, -v41
    v_exp_f32 v42, -v42
    v_exp_f32 v43, -v43
    v_pk_fma_f32 v[16:17], v[16:17], v[248:249], v[248:249] op_sel:[0,1,1] op_sel_hi:[1,1,1]
    v_pk_fma_f32 v[18:19], v[18:19], v[248:249], v[248:249] op_sel:[0,1,1] op_sel_hi:[1,1,1]
    v_pk_fma_f32 v[40:41], v[40:41], v[250:251], v[250:251] op_sel:[0,1,1] op_sel_hi:[1,1,1]
    v_pk_fma_f32 v[42:43], v[42:43], v[250:251], v[250:251] op_sel:[0,1,1] op_sel_hi:[1,1,1]
    v_rcp_f32 v16, v16
    v_rcp_f32 v17, v17
    v_rcp_f32 v18, v18
    v_rcp_f32 v19, v19
    v_rcp_f32 v40, v40
    v_rcp_f32 v41, v41
    v_rcp_f32 v42, v42
    v_rcp_f32 v43, v43
    v_pk_mul_f32 v[16:17], v[16:17], v[20:21]
    v_pk_mul_f32 v[18:19], v[18:19], v[22:23]
    v_pk_mul_f32 v[40:41], v[40:41], v[44:45]
    v_pk_mul_f32 v[42:43], v[42:43], v[46:47]
    v_cvt_pk_bf16_f32 v20, v16, v17
    v_cvt_pk_bf16_f32 v21, v18, v19
    v_cvt_pk_bf16_f32 v44, v40, v41
    v_cvt_pk_bf16_f32 v45, v42, v43
    buffer_store_dwordx2 v[20:21], v10, s[8:11], s26 offen offset:0 sc1
    buffer_store_dwordx2 v[44:45], v10, s[8:11], s26 offen offset:1024 sc1
    v_pk_mul_f32 v[68:69], v[64:65], v[68:69]
    v_pk_mul_f32 v[70:71], v[66:67], v[70:71]
    v_pk_mul_f32 v[64:65], v[64:65], v[252:253] op_sel_hi:[1,0]
    v_pk_mul_f32 v[66:67], v[66:67], v[252:253] op_sel_hi:[1,0]
    v_pk_mul_f32 v[92:93], v[88:89], v[92:93]
    v_pk_mul_f32 v[94:95], v[90:91], v[94:95]
    v_pk_mul_f32 v[88:89], v[88:89], v[254:255] op_sel_hi:[1,0]
    v_pk_mul_f32 v[90:91], v[90:91], v[254:255] op_sel_hi:[1,0]
    v_exp_f32 v64, -v64
    v_exp_f32 v65, -v65
    v_exp_f32 v66, -v66
    v_exp_f32 v67, -v67
    v_exp_f32 v88, -v88
    v_exp_f32 v89, -v89
    v_exp_f32 v90, -v90
    v_exp_f32 v91, -v91
    v_pk_fma_f32 v[64:65], v[64:65], v[252:253], v[252:253] op_sel:[0,1,1] op_sel_hi:[1,1,1]
    v_pk_fma_f32 v[66:67], v[66:67], v[252:253], v[252:253] op_sel:[0,1,1] op_sel_hi:[1,1,1]
    v_pk_fma_f32 v[88:89], v[88:89], v[254:255], v[254:255] op_sel:[0,1,1] op_sel_hi:[1,1,1]
    v_pk_fma_f32 v[90:91], v[90:91], v[254:255], v[254:255] op_sel:[0,1,1] op_sel_hi:[1,1,1]
    v_rcp_f32 v64, v64
    v_rcp_f32 v65, v65
    v_rcp_f32 v66, v66
    v_rcp_f32 v67, v67
    v_rcp_f32 v88, v88
    v_rcp_f32 v89, v89
    v_rcp_f32 v90, v90
    v_rcp_f32 v91, v91
    v_pk_mul_f32 v[64:65], v[64:65], v[68:69]
    v_pk_mul_f32 v[66:67], v[66:67], v[70:71]
    v_pk_mul_f32 v[88:89], v[88:89], v[92:93]
    v_pk_mul_f32 v[90:91], v[90:91], v[94:95]
    v_cvt_pk_bf16_f32 v68, v64, v65
    v_cvt_pk_bf16_f32 v69, v66, v67
    v_cvt_pk_bf16_f32 v92, v88, v89
    v_cvt_pk_bf16_f32 v93, v90, v91
    buffer_store_dwordx2 v[68:69], v10, s[8:11], s26 offen offset:2048 sc1
    buffer_store_dwordx2 v[92:93], v10, s[8:11], s26 offen offset:3072 sc1
    s_barrier
    s_setprio 3
    s_mul_i32 s51, s19, 28672
    s_lshl_b32 s22, s17, 8
    s_add_u32 s51, s51, s22
    s_add_u32 s51, s51, 20480
    s_sub_u32 s50, s51, 4096
    s_cmp_lt_u32 s16, 2
    s_cbranch_scc1 x_load
    s_cmp_lg_u32 s16, 3
    s_cbranch_scc1 x3_1001
    s_mov_b32 s74, 300000
poll_1002:
    s_mov_b32 s75, 0
    s_atomic_add s75, s[4:5], s50 glc
    s_waitcnt lgkmcnt(0)
    s_cmp_ge_u32 s75, 16
    s_cbranch_scc1 poll_1002_x
    s_sub_u32 s74, s74, 1
    s_cmp_lg_u32 s74, 0
    s_cbranch_scc1 poll_1002
poll_1002_x:
x3_1001:
    s_waitcnt vmcnt(0)
    s_barrier
    s_cmp_lg_u32 s16, 3
    s_cbranch_scc1 x3_1003
    s_mov_b32 s72, 1
    s_atomic_add s72, s[4:5], s51
x3_1003:
    s_barrier
    s_cmp_lg_u32 s19, 0
    s_cbranch_scc1 xp_1004
    s_lshr_b32 s36, s2, 3
    s_lshl_b32 s36, s36, 1
    s_add_u32 s36, s36, s16
    s_sub_u32 s36, s36, 2
    s_lshl_b32 s36, s36, 10
    s_mov_b32 s37, main_kernel_end-main_kernel-1088
    s_min_u32 s36, s36, s37
    v_add_u32 v20, s36, v1
    global_load_dwordx4 v[24:27], v20, s[86:87]
xp_1004:
    s_barrier
    s_cmp_lg_u32 s16, 3
    s_cbranch_scc1 x3_1005
    s_mov_b32 s74, 300000
poll_1006:
    s_mov_b32 s75, 0
    s_atomic_add s75, s[4:5], s51 glc
    s_waitcnt lgkmcnt(0)
    s_cmp_ge_u32 s75, 16
    s_cbranch_scc1 poll_1006_x
    s_sub_u32 s74, s74, 1
    s_cmp_lg_u32 s74, 0
    s_cbranch_scc1 poll_1006
poll_1006_x:
x_ok:
x3_1005:
    s_barrier
    s_barrier
    s_barrier
    s_barrier
    s_barrier
    s_cmp_lg_u32 s19, 0
    s_cbranch_scc1 xp_1007
    s_lshr_b32 s36, s2, 3
    s_lshl_b32 s36, s36, 1
    s_add_u32 s36, s36, s16
    s_sub_u32 s36, s36, 2
    s_lshl_b32 s36, s36, 10
    s_mov_b32 s37, main_kernel_end-main_kernel-1088
    s_min_u32 s36, s36, s37
    v_add_u32 v20, s36, v1
    global_load_dwordx4 v[24:27], v20, s[86:87]
xp_1007:
    s_barrier
    s_barrier
    s_barrier
    s_waitcnt vmcnt(0)
    s_barrier
x_join:
    s_setprio 0
    s_cmp_lg_u32 s19, 0
    s_cbranch_scc1 main_kernel_end
    s_mov_b32 s19, 1
    s_branch main_kernel_cloop
main_kernel_end:
    s_endpgm
.section .rodata,"a"
.p2align 6
.amdhsa_kernel main_kernel
  .amdhsa_next_free_vgpr 256
  .amdhsa_next_free_sgpr 102
  .amdhsa_accum_offset 256
  .amdhsa_group_segment_fixed_size 0
  .amdhsa_kernarg_size 80
  .amdhsa_user_sgpr_count 2
  .amdhsa_user_sgpr_kernarg_segment_ptr 1
  .amdhsa_system_sgpr_workgroup_id_x 1
.end_amdhsa_kernel
```
